```python
import torch

def _softmax(x, axis=-1):
    return torch.softmax(x, dim=axis)
def _gelu(x):
    return torch.nn.functional.gelu(x, approximate="tanh")
def _silu(x):
    return torch.nn.functional.silu(x)
def _sigmoid(x):
    return torch.sigmoid(x)
def _layernorm(x, axis=-1, eps=1e-5):
    m = x.mean(dim=axis, keepdim=True)
    v = x.var(dim=axis, keepdim=True, unbiased=False)
    return (x - m) / torch.sqrt(v + eps)
def _scatter_add(tgt, idx, src, axis=0):
    return tgt.clone().index_add_(axis, idx, src)
def _segment_sum(src, seg, n):
    out = torch.zeros((n,) + src.shape[1:], dtype=src.dtype)
    return out.index_add_(0, seg, src)
def _pad(x, pw):
    flat = tuple(v for pair in reversed(pw) for v in pair)
    return torch.nn.functional.pad(x, flat)

kernel_name = 'standalone__window_attn_swin_v2__vision'

def setup_inputs():

    _w = (lambda a: (lambda t: t.to(torch.bfloat16) if t.is_floating_point() else t)(torch.as_tensor(a)))
    win = 7
    H = W = (512 // win) * win
    C = 96
    nh = 4
    shift = win // 2
    coords = torch.stack(torch.meshgrid(torch.arange(win), torch.arange(win), indexing="ij"), -1).reshape(-1, 2)
    rel = coords[:, None, :] - coords[None, :, :]
    rel_idx = ((rel[..., 0] + win - 1) * (2 * win - 1) + (rel[..., 1] + win - 1)).to(torch.int64)
    tab = torch.stack(torch.meshgrid(torch.arange(1 - win, win), torch.arange(1 - win, win), indexing="ij"), -1).reshape(-1, 2).to(float)
    tab = (lambda _x: torch.sign(torch.as_tensor(_x)))(tab) * (lambda _x: torch.log1p(torch.as_tensor(_x)))(torch.abs(tab))
    img = torch.zeros((H, W), dtype=torch.int64)
    cnt = 0
    for hs in (slice(0, H - win), slice(H - win, H - shift), slice(H - shift, H)):
        for ws in (slice(0, W - win), slice(W - win, W - shift), slice(W - shift, W)):
            img[hs, ws] = cnt; cnt += 1
    mw = img.reshape(H // win, win, W // win, win).permute(0, 2, 1, 3).reshape(-1, win * win)
    mask = (mw[:, :, None] != mw[:, None, :]).to(float) * (-100.0)
    return {
        "x": _w((lambda *s: torch.randn(*s, dtype=torch.bfloat16) * 0.05)(1, H, W, C)),
        "wqkv": _w((lambda *s: torch.randn(*s, dtype=torch.bfloat16) * 1.6)(C, 3 * C)),
        "wo": _w((lambda *s: torch.randn(*s, dtype=torch.bfloat16) * 0.05)(C, C)),
        "logit_scale": _w((lambda *s: torch.randn(*s, dtype=torch.bfloat16) * 1.6)(nh)),
        "cpb_w1": _w((lambda *s: torch.randn(*s, dtype=torch.bfloat16) * 0.8)(2, 4 * nh)),
        "cpb_w2": _w((lambda *s: torch.randn(*s, dtype=torch.bfloat16) * 0.8)(4 * nh, nh)),
        "rel_coords": _w(tab),
        "rel_idx": _w(rel_idx),
        "attn_mask": _w(mask),
    }

def reference(x, wqkv, wo, logit_scale, cpb_w1, cpb_w2, rel_coords, rel_idx, attn_mask):
    B, H, W, C = x.shape
    win = 7
    nh = 4
    hd = C // nh
    shift = win // 2
    ww = win * win
    nH, nW = H // win, W // win
    xs = torch.roll(x, (-shift, -shift), (1, 2))
    xw = (lambda x, *d: x.permute(*d))(xs.reshape(B, nH, win, nW, win, C), 0, 1, 3, 2, 4, 5).reshape(B * nH * nW, ww, C)
    qkv = (lambda x, *d: x.permute(*d))((xw @ wqkv).reshape(B * nH * nW, ww, 3, nh, hd), 2, 0, 3, 1, 4)
    q, k, v = qkv[0], qkv[1], qkv[2]
    qn = q * (torch.einsum("bhqd,bhqd->bhq", q, q)[..., None] + 1e-12) ** -0.5
    kn = k * (torch.einsum("bhkd,bhkd->bhk", k, k)[..., None] + 1e-12) ** -0.5
    logits = torch.einsum("bhqd,bhkd->bhqk", qn, kn)
    tau = torch.exp(torch.clip(logit_scale, -100.0, 4.6052))
    logits = logits * tau[None, :, None, None]
    hcpb = rel_coords @ cpb_w1
    hcpb = torch.where(hcpb > 0, hcpb, hcpb * 0)
    bias_tab = 16.0 * _sigmoid(hcpb @ cpb_w2)
    bias = (lambda x, *d: x.permute(*d))(bias_tab[rel_idx], 2, 0, 1)
    logits = logits.reshape(B, nH * nW, nh, ww, ww) + bias[None, None, :, :, :] + attn_mask[None, :, None, :, :]
    p = _softmax(logits.reshape(B * nH * nW, nh, ww, ww), axis=-1)
    o = (lambda x, *d: x.permute(*d))(torch.einsum("bhqk,bhkd->bhqd", p, v), 0, 2, 1, 3).reshape(B * nH * nW, ww, C) @ wo
    o = (lambda x, *d: x.permute(*d))(o.reshape(B, nH, nW, win, win, C), 0, 1, 3, 2, 4, 5).reshape(B, H, W, C)
    o = torch.roll(o, (shift, shift), (1, 2))
    return _layernorm(o, axis=-1)
```

```asm
; @launch grid=(256,1,1) block=(512,1,1) lds=156160
.amdgcn_target "amdgcn-amd-amdhsa--gfx950"
.text
.globl standalone__window_attn_swin_v2__vision_kernel
.p2align 8
.type standalone__window_attn_swin_v2__vision_kernel,@function
standalone__window_attn_swin_v2__vision_kernel:
    s_cmp_ge_u32 s2, 256
    s_cbranch_scc1 L_END
    v_lshrrev_b32 v4, 6, v0
    v_and_b32 v0, 63, v0
    v_readfirstlane_b32 s25, v4
    s_load_dwordx16 s[52:67], s[0:1], 0
    s_load_dwordx2 s[68:69], s[0:1], 72
    s_getpc_b64 s[16:17]
L_PC:
    s_add_u32 s16, s16, L_TABLE-L_PC
    s_addc_u32 s17, s17, 0
    s_and_b32 s17, s17, 0xffff
    s_mov_b32 s18, 58368
    s_mov_b32 s19, 0x20000
    v_lshlrev_b32 v1, 4, v0
    v_lshlrev_b32 v3, 3, v0
    s_and_b32 s20, s25, 3
    s_cmp_ge_u32 s2, 247
    s_cselect_b32 s21, 1, 0
    s_cselect_b32 s70, 247, 0
    s_cmp_ge_u32 s2, 251
    s_cselect_b32 s21, 2, s21
    s_cselect_b32 s70, 251, s70
    s_cmp_ge_u32 s2, 255
    s_cselect_b32 s21, 3, s21
    s_cselect_b32 s70, 255, s70
    s_sub_u32 s70, s2, s70
    s_mul_i32 s71, s70, 21
    s_mul_i32 s72, s70, 20
    s_add_u32 s72, s72, 244
    s_cmp_lt_u32 s70, 244
    s_cselect_b32 s22, s71, s72
    s_cselect_b32 s23, 21, 20
    s_mul_i32 s71, s70, 18
    s_cmp_eq_u32 s21, 0
    s_cselect_b32 s22, s22, s71
    s_cselect_b32 s23, s23, 18
    s_cmp_eq_u32 s21, 3
    s_cselect_b32 s23, 1, s23
    s_cmp_ge_u32 s25, 4
    s_cbranch_scc1 L_O_PRO
    s_mov_b32 s76, 0
    s_mov_b32 s77, 4096
    s_mov_b32 s78, 8192
    s_lshl_b32 s70, s20, 10
    s_add_u32 s79, s70, 14336
    buffer_load_dwordx4 v[192:195], v1, s[16:19], s76 offen offset:0
    buffer_load_dwordx4 v[196:199], v1, s[16:19], s76 offen offset:1024
    buffer_load_dwordx4 v[200:203], v1, s[16:19], s76 offen offset:2048
    buffer_load_dwordx4 v[204:207], v1, s[16:19], s76 offen offset:3072
    s_lshl_b32 s71, s21, 12
    s_add_u32 s72, s71, 38912
    buffer_load_dwordx4 v[236:239], v1, s[16:19], s72 offen offset:0
    s_lshl_b32 s72, s20, 10
    s_add_u32 s71, s71, s72
    s_add_u32 s71, s71, 22528
    buffer_load_dwordx4 v[248:251], v1, s[16:19], s71 offen offset:0
    buffer_load_dwordx4 v[184:187], v1, s[16:19], s79 offen offset:0
    buffer_load_dwordx4 v[152:155], v1, s[16:19], s77 offen offset:3072
    buffer_load_dwordx4 v[156:159], v1, s[16:19], s78 offen offset:0
    buffer_load_dwordx4 v[160:163], v1, s[16:19], s78 offen offset:1024
    s_add_u32 s71, s79, -4096
    buffer_load_dwordx4 v[164:167], v1, s[16:19], s71 offen offset:0
    buffer_load_dwordx4 v[172:175], v1, s[16:19], s77 offen offset:0
    buffer_load_dwordx4 v[176:179], v1, s[16:19], s77 offen offset:1024
    buffer_load_dwordx4 v[180:183], v1, s[16:19], s77 offen offset:2048
    s_waitcnt lgkmcnt(0)
    s_mov_b32 s12, s54
    s_and_b32 s13, s55, 0xffff
    s_mov_b32 s14, 55296
    s_mov_b32 s15, 0x20000
    s_mul_i32 s70, s20, 13
    s_min_u32 s71, s20, 2
    s_add_u32 s70, s70, s71
    s_lshl_b32 s70, s70, 10
    s_add_u32 s71, s70, 27648
    s_mov_b32 m0, s71
    s_nop 0
    buffer_load_dwordx4 v1, s[12:15], s70 offen offset:0 lds
    buffer_load_dwordx4 v1, s[12:15], s70 offen offset:1024 lds
    buffer_load_dwordx4 v1, s[12:15], s70 offen offset:2048 lds
    buffer_load_dwordx4 v1, s[12:15], s70 offen offset:3072 lds
    s_add_u32 s70, s70, 4096
    s_add_u32 s71, s71, 4096
    s_mov_b32 m0, s71
    s_nop 0
    buffer_load_dwordx4 v1, s[12:15], s70 offen offset:0 lds
    buffer_load_dwordx4 v1, s[12:15], s70 offen offset:1024 lds
    buffer_load_dwordx4 v1, s[12:15], s70 offen offset:2048 lds
    buffer_load_dwordx4 v1, s[12:15], s70 offen offset:3072 lds
    s_add_u32 s70, s70, 4096
    s_add_u32 s71, s71, 4096
    s_mov_b32 m0, s71
    s_nop 0
    buffer_load_dwordx4 v1, s[12:15], s70 offen offset:0 lds
    buffer_load_dwordx4 v1, s[12:15], s70 offen offset:1024 lds
    buffer_load_dwordx4 v1, s[12:15], s70 offen offset:2048 lds
    buffer_load_dwordx4 v1, s[12:15], s70 offen offset:3072 lds
    s_add_u32 s70, s70, 4096
    s_add_u32 s71, s71, 4096
    s_mov_b32 m0, s71
    s_nop 0
    buffer_load_dwordx4 v1, s[12:15], s70 offen offset:0 lds
    s_add_u32 s70, s70, 1024
    s_add_u32 s71, s71, 1024
    s_cmp_lt_u32 s20, 2
    s_cselect_b32 s71, s71, 155136
    s_cselect_b32 s70, s70, 0x7f000000
    s_mov_b32 m0, s71
    s_nop 0
    buffer_load_dwordx4 v1, s[12:15], s70 offen lds
    s_mov_b32 s37, 1344
    s_mov_b32 s38, 294912
    s_cmp_eq_u32 s21, 1
    s_cselect_b32 s38, 576, s38
    s_cmp_eq_u32 s21, 2
    s_cselect_b32 s38, 294336, s38
    s_cselect_b32 s37, 686784, s37
    s_cmp_eq_u32 s21, 3
    s_cselect_b32 s38, 0, s38
    s_lshl_b32 s70, s20, 4
    s_mov_b64 s[44:45], 0xffff
    s_lshl_b64 s[44:45], s[44:45], s70
    s_mul_hi_u32 s71, s22, 59652324
    s_mul_i32 s72, s71, 72
    s_sub_u32 s72, s22, s72
    s_sub_u32 s35, 72, s72
    s_mul_i32 s71, s71, 686784
    s_mul_i32 s72, s72, s37
    s_add_u32 s34, s71, s72
    s_add_u32 s34, s34, s38
    s_mov_b32 s39, 590016
    s_mov_b32 s36, 0
    s_cmp_lt_u32 s36, s23
    s_cselect_b32 s31, s34, 0x7f000000
    s_add_u32 s36, s36, 1
    s_add_u32 s34, s34, s37
    s_sub_u32 s35, s35, 1
    s_cmp_eq_u32 s35, 0
    s_cselect_b32 s70, s39, 0
    s_cselect_b32 s35, 72, s35
    s_add_u32 s34, s34, s70
    s_cmp_lt_u32 s36, s23
    s_cselect_b32 s32, s34, 0x7f000000
    s_add_u32 s36, s36, 1
    s_add_u32 s34, s34, s37
    s_sub_u32 s35, s35, 1
    s_cmp_eq_u32 s35, 0
    s_cselect_b32 s70, s39, 0
    s_cselect_b32 s35, 72, s35
    s_add_u32 s34, s34, s70
    s_sub_u32 s47, 0, s23
    s_and_b32 s47, s47, 3
    s_add_u32 s48, s23, s47
    s_mov_b32 s46, 0x2a8cbccc
    s_mov_b32 s42, 0x00010001
    s_mov_b32 s43, 0x00010001
    s_mov_b32 s4, s52
    s_and_b32 s5, s53, 0xffff
    s_mov_b32 s6, 50135232
    s_mov_b32 s7, 0x20000
    s_mov_b32 s80, s58
    s_and_b32 s81, s59, 0xffff
    s_mov_b32 s82, 8
    s_mov_b32 s83, 0x20000
    v_and_b32 v253, 3, v0
    v_lshlrev_b32 v253, 1, v253
    buffer_load_ushort v252, v253, s[80:83], 0 offen
    s_min_u32 s74, s20, 2
    s_lshl_b32 s75, s74, 6
    s_waitcnt vmcnt(24)
    v_add_u32 v240, 0, v237
    v_subrev_u32 v240, s47, v240
    v_add_u32 v241, s22, v240
    s_mov_b32 s71, 59652324
    v_mul_hi_u32 v242, v241, s71
    v_mul_u32_u24 v243, 72, v242
    v_sub_u32 v241, v241, v243
    s_mov_b32 s72, 686784
    v_mul_lo_u32 v242, v242, s72
    v_mul_lo_u32 v241, v241, s37
    v_add3_u32 v246, v241, v242, s38
    v_add3_u32 v246, v246, v236, s75
    v_mov_b32 v241, 0x7f000000
    v_cmp_gt_u32 vcc, s23, v240
    s_nop 1
    v_cndmask_b32 v244, v241, v246, vcc
    s_lshl_b32 s70, s74, 10
    s_add_u32 s70, s70, 148992
    s_mov_b32 m0, s70
    s_nop 0
    buffer_load_dwordx4 v244, s[4:7], 0 offen lds
    v_add_u32 v240, 16, v237
    v_subrev_u32 v240, s47, v240
    v_add_u32 v241, s22, v240
    s_mov_b32 s71, 59652324
    v_mul_hi_u32 v242, v241, s71
    v_mul_u32_u24 v243, 72, v242
    v_sub_u32 v241, v241, v243
    s_mov_b32 s72, 686784
    v_mul_lo_u32 v242, v242, s72
    v_mul_lo_u32 v241, v241, s37
    v_add3_u32 v246, v241, v242, s38
    v_add3_u32 v246, v246, v236, s75
    v_mov_b32 v241, 0x7f000000
    v_cmp_gt_u32 vcc, s23, v240
    s_nop 1
    v_cndmask_b32 v245, v241, v246, vcc
    s_lshl_b32 s70, s74, 10
    s_add_u32 s70, s70, 152064
    s_mov_b32 m0, s70
    s_nop 0
    buffer_load_dwordx4 v245, s[4:7], 0 offen lds
    s_mov_b32 s27, 0
    s_lshl_b32 s73, s20, 10
    s_add_u32 s73, s73, s27
    s_mov_b32 m0, s73
    s_waitcnt vmcnt(25)
    buffer_load_dwordx4 v248, s[4:7], s31 offen lds
    s_add_u32 s73, s73, 4096
    s_mov_b32 m0, s73
    s_nop 0
    buffer_load_dwordx4 v249, s[4:7], s31 offen lds
    s_add_u32 s73, s27, 8192
    s_mov_b32 m0, s73
    s_mov_b64 exec, s[44:45]
    buffer_load_dwordx4 v250, s[4:7], s31 offen lds
    s_mov_b64 exec, -1
    s_mov_b32 s27, 9216
    s_lshl_b32 s73, s20, 10
    s_add_u32 s73, s73, s27
    s_mov_b32 m0, s73
    s_nop 0
    buffer_load_dwordx4 v248, s[4:7], s32 offen lds
    s_add_u32 s73, s73, 4096
    s_mov_b32 m0, s73
    s_nop 0
    buffer_load_dwordx4 v249, s[4:7], s32 offen lds
    s_add_u32 s73, s27, 8192
    s_mov_b32 m0, s73
    s_mov_b64 exec, s[44:45]
    buffer_load_dwordx4 v250, s[4:7], s32 offen lds
    s_mov_b64 exec, -1
    s_waitcnt vmcnt(26)
    v_sub_u32 v64, v164, v152
    v_sub_u32 v65, v164, v153
    v_sub_u32 v66, v164, v154
    v_sub_u32 v67, v164, v155
    v_sub_u32 v68, v165, v152
    v_sub_u32 v69, v165, v153
    v_sub_u32 v70, v165, v154
    v_sub_u32 v71, v165, v155
    v_sub_u32 v72, v166, v152
    v_sub_u32 v73, v166, v153
    v_sub_u32 v74, v166, v154
    v_sub_u32 v75, v166, v155
    v_sub_u32 v76, v164, v156
    v_sub_u32 v77, v164, v157
    v_sub_u32 v78, v164, v158
    v_sub_u32 v79, v164, v159
    v_sub_u32 v80, v165, v156
    v_sub_u32 v81, v165, v157
    v_sub_u32 v82, v165, v158
    v_sub_u32 v83, v165, v159
    v_sub_u32 v84, v166, v156
    v_sub_u32 v85, v166, v157
    v_sub_u32 v86, v166, v158
    v_sub_u32 v87, v166, v159
    v_sub_u32 v88, v164, v160
    v_sub_u32 v89, v164, v161
    v_sub_u32 v90, v164, v162
    v_sub_u32 v91, v164, v163
    v_sub_u32 v92, v165, v160
    v_sub_u32 v93, v165, v161
    v_sub_u32 v94, v165, v162
    v_sub_u32 v95, v165, v163
    v_sub_u32 v96, v166, v160
    v_sub_u32 v97, v166, v161
    v_sub_u32 v98, v166, v162
    v_sub_u32 v99, v166, v163
    v_subrev_u32 v100, 336, v164
    v_subrev_u32 v102, 336, v165
    v_subrev_u32 v104, 336, v166
    v_mov_b32 v106, v167
    s_waitcnt vmcnt(8)
    v_lshlrev_b32 v252, 16, v252
    v_min_f32 v252, 0x40930000, v252
    v_max_f32 v252, 0xc2c80000, v252
    v_mul_f32 v252, 0x3fb8aa3b, v252
    v_exp_f32 v252, v252
    s_nop 0
    v_cvt_pk_bf16_f32 v252, v252, v252
    v_lshlrev_b32 v252, 16, v252
    v_mul_f32 v252, 0x3fb8aa3b, v252
    s_nop 0
    v_readlane_b32 s40, v252, s20
    s_nop 2
    s_cmp_gt_u32 s40, 0x426c0000
    s_cselect_b32 s41, 1, 0
    s_waitcnt vmcnt(6)
    s_barrier
    ds_read_b128 v[208:211], v187 offset:0
    ds_read_b128 v[220:223], v187 offset:2304
    ds_read_b128 v[212:215], v187 offset:192
    ds_read_b128 v[224:227], v187 offset:2496
    ds_read_b128 v[216:219], v187 offset:384
    ds_read_b128 v[228:231], v187 offset:2688
    v_add_u32 v235, 148992, v1
    v_mov_b32 v189, 0
    v_mov_b32 v191, 0
    s_lshl_b32 s70, s20, 11
    s_add_u32 s71, s70, 128000
    s_add_u32 s70, s70, 136704
    v_add_u32 v233, s70, v3
    v_add_u32 v232, s70, v1
    v_add_u32 v234, s71, v175
    v_mov_b32 v255, v174
    v_mov_b32 v239, v174
    v_mov_b32 v243, 0
    ds_read_b32 v64, v64
    ds_read_b32 v65, v65
    ds_read_b32 v66, v66
    ds_read_b32 v67, v67
    ds_read_b32 v68, v68
    ds_read_b32 v69, v69
    ds_read_b32 v70, v70
    ds_read_b32 v71, v71
    ds_read_b32 v72, v72
    ds_read_b32 v73, v73
    ds_read_b32 v74, v74
    ds_read_b32 v75, v75
    ds_read_b32 v76, v76
    ds_read_b32 v77, v77
    ds_read_b32 v78, v78
    ds_read_b32 v79, v79
    ds_read_b32 v80, v80
    s_waitcnt lgkmcnt(15)
    v_mfma_f32_16x16x32_bf16 v[8:11], v[208:211], v[192:195], 0
    ds_read_b32 v81, v81
    ds_read_b32 v82, v82
    v_mfma_f32_16x16x32_bf16 v[20:23], v[208:211], v[196:199], 0
    ds_read_b128 v[208:211], v187 offset:18432
    ds_read_b32 v83, v83
    v_mfma_f32_16x16x32_bf16 v[12:15], v[220:223], v[192:195], 0
    ds_read_b32 v84, v84
    ds_read_b32 v85, v85
    v_mfma_f32_16x16x32_bf16 v[24:27], v[220:223], v[196:199], 0
    ds_read_b128 v[220:223], v187 offset:20736
    v_cvt_pk_bf16_f32 v5, v10, v11
    v_mfma_f32_16x16x32_bf16 v[20:23], v[212:215], v[200:203], v[20:23]
    v_cvt_pk_bf16_f32 v4, v8, v9
    ds_read_b32 v86, v86
    v_mfma_f32_16x16x32_bf16 v[32:35], v[212:215], v[204:207], 0
    ds_read_b128 v[212:215], v187 offset:18624
    v_cvt_pk_bf16_f32 v6, v12, v13
    v_mfma_f32_16x16x32_bf16 v[24:27], v[224:227], v[200:203], v[24:27]
    v_cvt_pk_bf16_f32 v7, v14, v15
    ds_read_b32 v87, v87
    v_mfma_f32_16x16x32_bf16 v[36:39], v[224:227], v[204:207], 0
    ds_read_b128 v[224:227], v187 offset:20928
    v_cvt_pk_bf16_f32 v17, v22, v23
    v_mfma_f32_16x16x32_bf16 v[44:47], v[216:219], v[192:195], 0
    v_cvt_pk_bf16_f32 v29, v34, v35
    v_cvt_pk_bf16_f32 v16, v20, v21
    v_mfma_f32_16x16x32_bf16 v[56:59], v[216:219], v[196:199], 0
    ds_read_b128 v[216:219], v187 offset:18816
    v_cvt_pk_bf16_f32 v18, v24, v25
    v_mfma_f32_16x16x32_bf16 v[48:51], v[228:231], v[192:195], 0
    v_cvt_pk_bf16_f32 v19, v26, v27
    v_cvt_pk_bf16_f32 v30, v36, v37
    v_mfma_f32_16x16x32_bf16 v[60:63], v[228:231], v[196:199], 0
    ds_read_b128 v[228:231], v187 offset:21120
    v_cvt_pk_bf16_f32 v31, v38, v39
    s_waitcnt lgkmcnt(10)
    v_mfma_f32_16x16x32_bf16 v[12:15], v[208:211], v[192:195], 0
    v_cvt_pk_bf16_f32 v41, v46, v47
    v_cvt_pk_bf16_f32 v53, v58, v59
    v_mfma_f32_16x16x32_bf16 v[24:27], v[208:211], v[196:199], 0
    ds_read_b128 v[208:211], v187 offset:36864
    v_cvt_pk_bf16_f32 v42, v48, v49
    s_waitcnt lgkmcnt(7)
    v_mfma_f32_16x16x32_bf16 v[112:115], v[220:223], v[192:195], 0
    v_cvt_pk_bf16_f32 v43, v50, v51
    v_cvt_pk_bf16_f32 v54, v60, v61
    v_mfma_f32_16x16x32_bf16 v[116:119], v[220:223], v[196:199], 0
    ds_read_b128 v[220:223], v187 offset:39168
    v_cvt_pk_bf16_f32 v55, v62, v63
    s_waitcnt lgkmcnt(6)
    v_mfma_f32_16x16x32_bf16 v[24:27], v[212:215], v[200:203], v[24:27]
    v_cvt_pk_bf16_f32 v8, v12, v13
    v_cvt_pk_bf16_f32 v28, v32, v33
    v_mfma_f32_16x16x32_bf16 v[36:39], v[212:215], v[204:207], 0
    ds_read_b128 v[212:215], v187 offset:37056
    v_cvt_pk_bf16_f32 v10, v112, v113
    s_waitcnt lgkmcnt(5)
    v_mfma_f32_16x16x32_bf16 v[116:119], v[224:227], v[200:203], v[116:119]
    v_cvt_pk_bf16_f32 v11, v114, v115
    v_cvt_pk_bf16_f32 v9, v14, v15
    v_mfma_f32_16x16x32_bf16 v[120:123], v[224:227], v[204:207], 0
    ds_read_b128 v[224:227], v187 offset:39360
    v_cvt_pk_bf16_f32 v20, v24, v25
    s_waitcnt lgkmcnt(5)
    v_mfma_f32_16x16x32_bf16 v[48:51], v[216:219], v[192:195], 0
    v_cvt_pk_bf16_f32 v21, v26, v27
    v_cvt_pk_bf16_f32 v32, v36, v37
    v_mfma_f32_16x16x32_bf16 v[60:63], v[216:219], v[196:199], 0
    ds_read_b128 v[216:219], v187 offset:37248
    v_cvt_pk_bf16_f32 v22, v116, v117
    s_waitcnt lgkmcnt(5)
    v_mfma_f32_16x16x32_bf16 v[124:127], v[228:231], v[192:195], 0
    v_cvt_pk_bf16_f32 v23, v118, v119
    v_cvt_pk_bf16_f32 v34, v120, v121
    v_mfma_f32_16x16x32_bf16 v[128:131], v[228:231], v[196:199], 0
    ds_read_b128 v[228:231], v187 offset:39552
    v_cvt_pk_bf16_f32 v35, v122, v123
    s_waitcnt lgkmcnt(5)
    v_mfma_f32_16x16x32_bf16 v[112:115], v[208:211], v[192:195], 0
    v_cvt_pk_bf16_f32 v33, v38, v39
    v_cvt_pk_bf16_f32 v52, v56, v57
    v_mfma_f32_16x16x32_bf16 v[116:119], v[208:211], v[196:199], 0
    ds_read_b128 v[208:211], v235 offset:0
    v_cvt_pk_bf16_f32 v46, v124, v125
    s_waitcnt lgkmcnt(5)
    v_mfma_f32_16x16x32_bf16 v[132:135], v[220:223], v[192:195], 0
    v_cvt_pk_bf16_f32 v47, v126, v127
    v_cvt_pk_bf16_f32 v58, v128, v129
    v_mfma_f32_16x16x32_bf16 v[136:139], v[220:223], v[196:199], 0
    ds_read_b128 v[220:223], v235 offset:3072
    v_cvt_pk_bf16_f32 v59, v130, v131
    s_waitcnt lgkmcnt(5)
    v_mfma_f32_16x16x32_bf16 v[116:119], v[212:215], v[200:203], v[116:119]
    v_cvt_pk_bf16_f32 v12, v112, v113
    v_cvt_pk_bf16_f32 v13, v114, v115
    v_mfma_f32_16x16x32_bf16 v[120:123], v[212:215], v[204:207], 0
    ds_read_b128 v[212:215], v235 offset:1024
    v_cvt_pk_bf16_f32 v14, v132, v133
    s_waitcnt lgkmcnt(5)
    v_mfma_f32_16x16x32_bf16 v[136:139], v[224:227], v[200:203], v[136:139]
    v_cvt_pk_bf16_f32 v15, v134, v135
    v_cvt_pk_bf16_f32 v40, v44, v45
    v_mfma_f32_16x16x32_bf16 v[140:143], v[224:227], v[204:207], 0
    ds_read_b128 v[224:227], v235 offset:4096
    v_cvt_pk_bf16_f32 v24, v116, v117
    s_waitcnt lgkmcnt(5)
    v_mfma_f32_16x16x32_bf16 v[124:127], v[216:219], v[192:195], 0
    v_cvt_pk_bf16_f32 v25, v118, v119
    v_cvt_pk_bf16_f32 v36, v120, v121
    v_mfma_f32_16x16x32_bf16 v[128:131], v[216:219], v[196:199], 0
    ds_read_b128 v[216:219], v235 offset:2048
    v_cvt_pk_bf16_f32 v37, v122, v123
    s_waitcnt lgkmcnt(5)
    v_mfma_f32_16x16x32_bf16 v[144:147], v[228:231], v[192:195], 0
    v_cvt_pk_bf16_f32 v26, v136, v137
    v_cvt_pk_bf16_f32 v27, v138, v139
    v_mfma_f32_16x16x32_bf16 v[148:151], v[228:231], v[196:199], 0
    ds_read_b128 v[228:231], v235 offset:5120
    v_cvt_pk_bf16_f32 v38, v140, v141
    s_waitcnt lgkmcnt(5)
    v_mfma_f32_16x16x32_bf16 v[192:195], v[4:7], v[208:211], 0
    v_cvt_pk_bf16_f32 v39, v142, v143
    v_cvt_pk_bf16_f32 v56, v60, v61
    v_mfma_f32_16x16x32_bf16 v[196:199], v[16:19], v[208:211], 0
    v_cvt_pk_bf16_f32 v57, v62, v63
    v_cvt_pk_bf16_f32 v44, v48, v49
    s_waitcnt lgkmcnt(4)
    v_mfma_f32_16x16x32_bf16 v[112:115], v[4:7], v[220:223], 0
    v_cvt_pk_bf16_f32 v45, v50, v51
    v_cvt_pk_bf16_f32 v60, v128, v129
    v_mfma_f32_16x16x32_bf16 v[116:119], v[16:19], v[220:223], 0
    v_cvt_pk_bf16_f32 v61, v130, v131
    v_cvt_pk_bf16_f32 v62, v148, v149
    v_mfma_f32_16x16x32_bf16 v[200:203], v[28:31], v[208:211], 0
    v_cvt_pk_bf16_f32 v63, v150, v151
    v_cvt_pk_bf16_f32 v48, v124, v125
    s_waitcnt lgkmcnt(3)
    v_mfma_f32_16x16x32_bf16 v[192:195], v[8:11], v[212:215], v[192:195]
    v_cvt_pk_bf16_f32 v49, v126, v127
    v_cvt_pk_bf16_f32 v50, v144, v145
    v_mfma_f32_16x16x32_bf16 v[196:199], v[20:23], v[212:215], v[196:199]
    v_cvt_pk_bf16_f32 v51, v146, v147
    ds_read_b32 v88, v88
    v_mfma_f32_16x16x32_bf16 v[120:123], v[28:31], v[220:223], 0
    ds_read_b32 v89, v89
    ds_read_b32 v90, v90
    s_waitcnt lgkmcnt(5)
    v_mfma_f32_16x16x32_bf16 v[112:115], v[8:11], v[224:227], v[112:115]
    ds_read_b32 v91, v91
    ds_read_b32 v92, v92
    v_mfma_f32_16x16x32_bf16 v[116:119], v[20:23], v[224:227], v[116:119]
    ds_read_b32 v93, v93
    ds_read_b32 v94, v94
    v_mfma_f32_16x16x32_bf16 v[200:203], v[32:35], v[212:215], v[200:203]
    ds_read_b32 v95, v95
    ds_read_b32 v96, v96
    s_waitcnt lgkmcnt(10)
    v_mfma_f32_16x16x32_bf16 v[192:195], v[12:15], v[216:219], v[192:195]
    ds_read_b32 v97, v97
    ds_read_b32 v98, v98
    v_mfma_f32_16x16x32_bf16 v[196:199], v[24:27], v[216:219], v[196:199]
    ds_read_b32 v99, v99
    ds_read_b32 v100, v100
    v_mfma_f32_16x16x32_bf16 v[120:123], v[32:35], v[224:227], v[120:123]
    ds_read_b32 v102, v102
    ds_read_b32 v104, v104
    s_waitcnt lgkmcnt(15)
    v_mfma_f32_16x16x32_bf16 v[112:115], v[12:15], v[228:231], v[112:115]
    v_fma_f32 v132, v192, v192, s46
    ds_read_b32 v106, v106
    v_mfma_f32_16x16x32_bf16 v[116:119], v[24:27], v[228:231], v[116:119]
    v_fma_f32 v133, v198, v198, s46
    v_fmac_f32 v132, v193, v193
    v_mfma_f32_16x16x32_bf16 v[248:251], v[208:211], v[52:55], v[176:179]
    v_fmac_f32 v133, v199, v199
    v_fmac_f32 v132, v194, v194
    v_mfma_f32_16x16x32_bf16 v[200:203], v[36:39], v[216:219], v[200:203]
    v_fma_f32 v138, v112, v112, s46
    v_fmac_f32 v132, v195, v195
    v_mfma_f32_16x16x32_bf16 v[120:123], v[36:39], v[228:231], v[120:123]
    v_fma_f32 v139, v118, v118, s46
    v_fmac_f32 v138, v113, v113
    v_mfma_f32_16x16x32_bf16 v[244:247], v[208:211], v[40:43], 0
    v_fmac_f32 v139, v119, v119
    v_fmac_f32 v138, v114, v114
    v_mfma_f32_16x16x32_bf16 v[248:251], v[212:215], v[56:59], v[248:251]
    v_fmac_f32 v133, v200, v200
    v_fmac_f32 v138, v115, v115
    v_mfma_f32_16x16x32_bf16 v[244:247], v[212:215], v[44:47], v[244:247]
    v_fmac_f32 v139, v120, v120
    v_fmac_f32 v133, v201, v201
    v_mfma_f32_16x16x32_bf16 v[248:251], v[216:219], v[60:63], v[248:251]
    v_fmac_f32 v139, v121, v121
    v_fmac_f32 v132, v196, v196
    v_mfma_f32_16x16x32_bf16 v[244:247], v[216:219], v[48:51], v[244:247]
    v_fmac_f32 v133, v202, v202
    v_fmac_f32 v138, v116, v116
    v_fmac_f32 v139, v122, v122
    v_fmac_f32 v132, v197, v197
    v_fmac_f32 v133, v203, v203
    v_fmac_f32 v138, v117, v117
    v_fmac_f32 v139, v123, v123
    v_cvt_pk_bf16_f32 v154, v248, v249
    v_cvt_pk_bf16_f32 v155, v250, v251
    v_cvt_pk_bf16_f32 v188, v132, v133
    v_cvt_pk_bf16_f32 v190, v138, v139
    v_cvt_pk_bf16_f32 v146, v244, v245
    v_cvt_pk_bf16_f32 v147, v246, v247
    v_mfma_f32_16x16x32_bf16 v[248:251], v[220:223], v[52:55], v[176:179]
    v_mov_b32 v139, v174
    v_mov_b32 v163, 0
    v_mfma_f32_16x16x32_bf16 v[244:247], v[220:223], v[40:43], 0
    v_mov_b32 v171, 0
    v_mov_b32 v110, 0
    v_mfma_f32_16x16x16_bf16 v[134:137], v[172:173], v[188:189], 0
    v_mfma_f32_16x16x16_bf16 v[140:143], v[172:173], v[190:191], 0
    v_mfma_f32_16x16x32_bf16 v[248:251], v[224:227], v[56:59], v[248:251]
    v_mfma_f32_16x16x32_bf16 v[244:247], v[224:227], v[44:47], v[244:247]
    v_mfma_f32_16x16x32_bf16 v[248:251], v[228:231], v[60:63], v[248:251]
    v_mfma_f32_16x16x32_bf16 v[244:247], v[228:231], v[48:51], v[244:247]
    s_nop 2
    v_rsq_f32 v134, v134
    v_rsq_f32 v140, v140
    v_rsq_f32 v141, v141
    v_mul_f32 v134, s40, v134
    v_mul_f32 v140, s40, v140
    v_rsq_f32 v135, v135
    v_mul_f32 v192, v134, v192
    v_mul_f32 v193, v134, v193
    v_mul_f32 v194, v134, v194
    v_mul_f32 v195, v134, v195
    v_mul_f32 v196, v134, v196
    v_mul_f32 v197, v134, v197
    v_mul_f32 v112, v140, v112
    v_mul_f32 v118, v141, v118
    v_mul_f32 v113, v140, v113
    v_mul_f32 v119, v141, v119
    v_mul_f32 v114, v140, v114
    v_mul_f32 v120, v141, v120
    v_mul_f32 v115, v140, v115
    v_mul_f32 v121, v141, v121
    v_mul_f32 v116, v140, v116
    v_mul_f32 v122, v141, v122
    v_mul_f32 v117, v140, v117
    v_mul_f32 v123, v141, v123
    v_cvt_pk_bf16_f32 v130, v248, v249
    v_cvt_pk_bf16_f32 v131, v250, v251
    v_mul_f32 v198, v135, v198
    v_mul_f32 v199, v135, v199
    v_mul_f32 v200, v135, v200
    v_mul_f32 v201, v135, v201
    v_mul_f32 v202, v135, v202
    v_mul_f32 v203, v135, v203
    v_cvt_pk_bf16_f32 v252, v192, v193
    v_cvt_pk_bf16_f32 v253, v194, v195
    v_cvt_pk_bf16_f32 v254, v196, v197
    v_cvt_pk_bf16_f32 v128, v244, v245
    v_cvt_pk_bf16_f32 v129, v246, v247
    v_cvt_pk_bf16_f32 v236, v112, v113
    v_cvt_pk_bf16_f32 v240, v118, v119
    v_cvt_pk_bf16_f32 v237, v114, v115
    v_cvt_pk_bf16_f32 v241, v120, v121
    v_cvt_pk_bf16_f32 v238, v116, v117
    v_cvt_pk_bf16_f32 v242, v122, v123
    ds_write_b64 v233, v[130:131] offset:1536
    v_cvt_pk_bf16_f32 v124, v198, v199
    v_cvt_pk_bf16_f32 v125, v200, v201
    v_cvt_pk_bf16_f32 v126, v202, v203
    ds_write_b128 v234, v[252:255] offset:0
    ds_write_b64 v233, v[128:129] offset:1024
    ds_write_b128 v232, v[240:243]
    ds_write_b128 v234, v[236:239] offset:1024
    v_mov_b32 v115, 0
    v_mov_b32 v131, v174
    v_mov_b32 v119, 0
    v_mov_b32 v135, v174
    v_mov_b32 v123, 0
    s_cmp_eq_u32 s21, 0
    s_waitcnt lgkmcnt(0)
    s_cbranch_scc1 L_NOMASK
    s_add_u32 s70, s21, 53
    s_lshl_b32 s70, s70, 10
    buffer_load_dwordx4 v[192:195], v1, s[16:19], s70 offen offset:0
    s_mov_b32 s71, 0xc31044fe
    s_waitcnt vmcnt(0)
    v_bfe_i32 v196, v192, 0, 1
    v_and_b32 v196, s71, v196
    v_add_f32 v64, v64, v196
    v_bfe_i32 v196, v192, 1, 1
    v_and_b32 v196, s71, v196
    v_add_f32 v65, v65, v196
    v_bfe_i32 v196, v192, 2, 1
    v_and_b32 v196, s71, v196
    v_add_f32 v66, v66, v196
    v_bfe_i32 v196, v192, 3, 1
    v_and_b32 v196, s71, v196
    v_add_f32 v67, v67, v196
    v_bfe_i32 v196, v192, 4, 1
    v_and_b32 v196, s71, v196
    v_add_f32 v68, v68, v196
    v_bfe_i32 v196, v192, 5, 1
    v_and_b32 v196, s71, v196
    v_add_f32 v69, v69, v196
    v_bfe_i32 v196, v192, 6, 1
    v_and_b32 v196, s71, v196
    v_add_f32 v70, v70, v196
    v_bfe_i32 v196, v192, 7, 1
    v_and_b32 v196, s71, v196
    v_add_f32 v71, v71, v196
    v_bfe_i32 v196, v192, 8, 1
    v_and_b32 v196, s71, v196
    v_add_f32 v72, v72, v196
    v_bfe_i32 v196, v192, 9, 1
    v_and_b32 v196, s71, v196
    v_add_f32 v73, v73, v196
    v_bfe_i32 v196, v192, 10, 1
    v_and_b32 v196, s71, v196
    v_add_f32 v74, v74, v196
    v_bfe_i32 v196, v192, 11, 1
    v_and_b32 v196, s71, v196
    v_add_f32 v75, v75, v196
    v_bfe_i32 v196, v192, 12, 1
    v_and_b32 v196, s71, v196
    v_add_f32 v76, v76, v196
    v_bfe_i32 v196, v192, 13, 1
    v_and_b32 v196, s71, v196
    v_add_f32 v77, v77, v196
    v_bfe_i32 v196, v192, 14, 1
    v_and_b32 v196, s71, v196
    v_add_f32 v78, v78, v196
    v_bfe_i32 v196, v192, 15, 1
    v_and_b32 v196, s71, v196
    v_add_f32 v79, v79, v196
    v_bfe_i32 v196, v192, 16, 1
    v_and_b32 v196, s71, v196
    v_add_f32 v80, v80, v196
    v_bfe_i32 v196, v192, 17, 1
    v_and_b32 v196, s71, v196
    v_add_f32 v81, v81, v196
    v_bfe_i32 v196, v192, 18, 1
    v_and_b32 v196, s71, v196
    v_add_f32 v82, v82, v196
    v_bfe_i32 v196, v192, 19, 1
    v_and_b32 v196, s71, v196
    v_add_f32 v83, v83, v196
    v_bfe_i32 v196, v192, 20, 1
    v_and_b32 v196, s71, v196
    v_add_f32 v84, v84, v196
    v_bfe_i32 v196, v192, 21, 1
    v_and_b32 v196, s71, v196
    v_add_f32 v85, v85, v196
    v_bfe_i32 v196, v192, 22, 1
    v_and_b32 v196, s71, v196
    v_add_f32 v86, v86, v196
    v_bfe_i32 v196, v192, 23, 1
    v_and_b32 v196, s71, v196
    v_add_f32 v87, v87, v196
    v_bfe_i32 v196, v192, 24, 1
    v_and_b32 v196, s71, v196
    v_add_f32 v88, v88, v196
    v_bfe_i32 v196, v192, 25, 1
    v_and_b32 v196, s71, v196
    v_add_f32 v89, v89, v196
    v_bfe_i32 v196, v192, 26, 1
    v_and_b32 v196, s71, v196
    v_add_f32 v90, v90, v196
    v_bfe_i32 v196, v192, 27, 1
    v_and_b32 v196, s71, v196
    v_add_f32 v91, v91, v196
    v_bfe_i32 v196, v192, 28, 1
    v_and_b32 v196, s71, v196
    v_add_f32 v92, v92, v196
    v_bfe_i32 v196, v192, 29, 1
    v_and_b32 v196, s71, v196
    v_add_f32 v93, v93, v196
    v_bfe_i32 v196, v192, 30, 1
    v_and_b32 v196, s71, v196
    v_add_f32 v94, v94, v196
    v_bfe_i32 v196, v192, 31, 1
    v_and_b32 v196, s71, v196
    v_add_f32 v95, v95, v196
    v_bfe_i32 v196, v193, 0, 1
    v_and_b32 v196, s71, v196
    v_add_f32 v96, v96, v196
    v_bfe_i32 v196, v193, 1, 1
    v_and_b32 v196, s71, v196
    v_add_f32 v97, v97, v196
    v_bfe_i32 v196, v193, 2, 1
    v_and_b32 v196, s71, v196
    v_add_f32 v98, v98, v196
    v_bfe_i32 v196, v193, 3, 1
    v_and_b32 v196, s71, v196
    v_add_f32 v99, v99, v196
    v_bfe_i32 v196, v193, 4, 1
    v_and_b32 v196, s71, v196
    v_add_f32 v100, v100, v196
    v_bfe_i32 v196, v193, 5, 1
    v_and_b32 v196, s71, v196
    v_add_f32 v102, v102, v196
    v_bfe_i32 v196, v193, 6, 1
    v_and_b32 v196, s71, v196
    v_add_f32 v104, v104, v196
    v_bfe_i32 v196, v193, 7, 1
    v_and_b32 v196, s71, v196
    v_add_f32 v106, v106, v196
    s_nop 1
L_NOMASK:
    s_mov_b32 s24, s47
    s_mov_b32 s26, 0
    s_mul_i32 s77, s20, 3328
    s_add_u32 s77, s77, 101376
    s_mov_b32 s78, 13312
    s_lshl_b32 s70, s47, 6
    s_lshl_b32 s71, s47, 2
    v_add_u32 v103, s77, v183
    v_add_u32 v105, s70, v184
    v_add_u32 v101, 0, v1
    v_cmp_eq_u32 vcc, s71, v0
    s_nop 1
    v_cndmask_b32 v127, v180, v110, vcc
    s_waitcnt vmcnt(0) lgkmcnt(0)
    s_barrier
    ds_read_b128 v[192:195], v101 offset:0
    ds_read_b128 v[196:199], v101 offset:1024
    ds_read_b128 v[200:203], v101 offset:2048
    s_waitcnt lgkmcnt(2)
    v_mfma_f32_16x16x32_bf16 v[204:207], v[4:7], v[192:195], 0
    v_mfma_f32_16x16x32_bf16 v[208:211], v[16:19], v[192:195], 0
    v_mfma_f32_16x16x32_bf16 v[212:215], v[28:31], v[192:195], 0
    s_waitcnt lgkmcnt(1)
    v_mfma_f32_16x16x32_bf16 v[204:207], v[8:11], v[196:199], v[204:207]
    v_mfma_f32_16x16x32_bf16 v[208:211], v[20:23], v[196:199], v[208:211]
    v_mfma_f32_16x16x32_bf16 v[212:215], v[32:35], v[196:199], v[212:215]
    s_waitcnt lgkmcnt(0)
    v_mfma_f32_16x16x32_bf16 v[204:207], v[12:15], v[200:203], v[204:207]
    v_mfma_f32_16x16x32_bf16 v[208:211], v[24:27], v[200:203], v[208:211]
    v_mfma_f32_16x16x32_bf16 v[212:215], v[36:39], v[200:203], v[212:215]
    s_lshl_b32 s70, s41, 2
    s_add_u32 s70, s70, s47
    s_cmp_eq_u32 s70, 3
    s_nop 4
    s_cbranch_scc1 L_M_BODY3_F
    s_cmp_eq_u32 s70, 2
    s_cbranch_scc1 L_M_BODY2_F
    s_cmp_eq_u32 s70, 0
    s_cbranch_scc1 L_M_BODY0_F
    s_cmp_eq_u32 s70, 1
    s_cbranch_scc1 L_M_BODY1_F
    s_cmp_eq_u32 s70, 4
    s_cbranch_scc1 L_M_BODY0_S
    s_cmp_eq_u32 s70, 5
    s_cbranch_scc1 L_M_BODY1_S
    s_cmp_eq_u32 s70, 6
    s_cbranch_scc1 L_M_BODY2_S
    s_branch L_M_BODY3_S
L_M_LOOP_F:
    s_waitcnt lgkmcnt(0)
    s_barrier
L_M_BODY0_F:
    v_mfma_f32_16x16x32_bf16 v[244:247], v[192:195], v[40:43], 0
    s_add_u32 s26, s26, 9216
    s_cmp_eq_u32 s26, 73728
    v_mfma_f32_16x16x32_bf16 v[248:251], v[192:195], v[52:55], v[176:179]
    ds_read_b128 v[192:195], v101 offset:3072
    v_mfma_f32_16x16x32_bf16 v[244:247], v[196:199], v[44:47], v[244:247]
    s_cselect_b32 s26, 0, s26
    s_add_u32 s24, s24, 1
    v_mfma_f32_16x16x32_bf16 v[248:251], v[196:199], v[56:59], v[248:251]
    ds_read_b128 v[196:199], v101 offset:4096
    v_mfma_f32_16x16x32_bf16 v[244:247], v[200:203], v[48:51], v[244:247]
    v_fma_f32 v217, v210, v210, s46
    v_fma_f32 v216, v204, v204, s46
    v_mfma_f32_16x16x32_bf16 v[248:251], v[200:203], v[60:63], v[248:251]
    ds_read_b128 v[200:203], v101 offset:5120
    v_fmac_f32 v216, v205, v205
    v_fmac_f32 v216, v206, v206
    v_fmac_f32 v216, v207, v207
    v_fmac_f32 v216, v208, v208
    v_cvt_pk_bf16_f32 v141, v246, v247
    v_cvt_pk_bf16_f32 v140, v244, v245
    v_fmac_f32 v216, v209, v209
    v_cvt_pk_bf16_f32 v149, v250, v251
    v_cvt_pk_bf16_f32 v148, v248, v249
    v_fmac_f32 v217, v211, v211
    v_fmac_f32 v217, v212, v212
    v_fmac_f32 v217, v213, v213
    v_fmac_f32 v217, v214, v214
    v_fmac_f32 v217, v215, v215
    v_cvt_pk_bf16_f32 v188, v216, v217
    s_nop 1
    v_mfma_f32_16x16x16_bf16 v[218:221], v[172:173], v[188:189], 0
    s_waitcnt lgkmcnt(2)
    v_mfma_f32_16x16x32_bf16 v[224:227], v[4:7], v[192:195], 0
    v_mfma_f32_16x16x32_bf16 v[228:231], v[16:19], v[192:195], 0
    v_mfma_f32_16x16x32_bf16 v[244:247], v[192:195], v[40:43], 0
    v_mfma_f32_16x16x32_bf16 v[232:235], v[28:31], v[192:195], 0
    v_mfma_f32_16x16x32_bf16 v[248:251], v[192:195], v[52:55], v[176:179]
    ds_read_b128 v[192:195], v101 offset:6144
    s_waitcnt lgkmcnt(2)
    v_mfma_f32_16x16x32_bf16 v[224:227], v[8:11], v[196:199], v[224:227]
    v_rsq_f32 v219, v219
    v_mfma_f32_16x16x32_bf16 v[232:235], v[32:35], v[196:199], v[232:235]
    v_rsq_f32 v218, v218
    v_mfma_f32_16x16x32_bf16 v[228:231], v[20:23], v[196:199], v[228:231]
    v_mul_f32 v218, s40, v218
    v_mul_f32 v204, v218, v204
    s_waitcnt lgkmcnt(1)
    v_mfma_f32_16x16x32_bf16 v[224:227], v[12:15], v[200:203], v[224:227]
    v_mul_f32 v210, v219, v210
    v_mul_f32 v212, v219, v212
    v_mfma_f32_16x16x32_bf16 v[232:235], v[36:39], v[200:203], v[232:235]
    v_mul_f32 v205, v218, v205
    v_mul_f32 v211, v219, v211
    v_mfma_f32_16x16x32_bf16 v[244:247], v[196:199], v[44:47], v[244:247]
    v_mul_f32 v206, v218, v206
    v_mul_f32 v213, v219, v213
    v_mfma_f32_16x16x32_bf16 v[244:247], v[200:203], v[48:51], v[244:247]
    v_mul_f32 v207, v218, v207
    v_mul_f32 v214, v219, v214
    v_mfma_f32_16x16x32_bf16 v[248:251], v[196:199], v[56:59], v[248:251]
    ds_read_b128 v[196:199], v101 offset:7168
    v_mfma_f32_16x16x32_bf16 v[248:251], v[200:203], v[60:63], v[248:251]
    v_mul_f32 v215, v219, v215
    v_cvt_pk_bf16_f32 v129, v206, v207
    v_mfma_f32_16x16x32_bf16 v[228:231], v[24:27], v[200:203], v[228:231]
    ds_read_b128 v[200:203], v101 offset:8192
    v_mul_f32 v208, v218, v208
    v_mul_f32 v209, v218, v209
    v_cvt_pk_bf16_f32 v112, v210, v211
    v_cvt_pk_bf16_f32 v128, v204, v205
    s_waitcnt lgkmcnt(2)
    v_mfma_f32_16x16x32_bf16 v[204:207], v[4:7], v[192:195], 0
    v_cvt_pk_bf16_f32 v114, v214, v215
    v_cvt_pk_bf16_f32 v113, v212, v213
    v_mfma_f32_16x16x32_bf16 v[212:215], v[28:31], v[192:195], 0
    v_cvt_pk_bf16_f32 v130, v208, v209
    v_cvt_pk_bf16_f32 v150, v248, v249
    v_mfma_f32_16x16x32_bf16 v[208:211], v[16:19], v[192:195], 0
    v_cvt_pk_bf16_f32 v143, v246, v247
    v_fma_f32 v237, v230, v230, s46
    v_fma_f32 v236, v224, v224, s46
    v_cvt_pk_bf16_f32 v142, v244, v245
    v_mfma_f32_16x16x32_bf16 v[244:247], v[192:195], v[40:43], 0
    v_fmac_f32 v236, v225, v225
    v_fmac_f32 v237, v231, v231
    v_cvt_pk_bf16_f32 v151, v250, v251
    v_mfma_f32_16x16x32_bf16 v[248:251], v[192:195], v[52:55], v[176:179]
    v_fmac_f32 v237, v232, v232
    v_fmac_f32 v237, v233, v233
    v_mfma_f32_16x16x32_bf16 v[192:195], v[112:115], v[128:131], v[64:67]
    v_fmac_f32 v236, v226, v226
    v_fmac_f32 v236, v227, v227
    s_waitcnt lgkmcnt(1)
    v_mfma_f32_16x16x32_bf16 v[208:211], v[20:23], v[196:199], v[208:211]
    v_fmac_f32 v236, v228, v228
    v_fmac_f32 v236, v229, v229
    v_mfma_f32_16x16x32_bf16 v[204:207], v[8:11], v[196:199], v[204:207]
    v_fmac_f32 v237, v234, v234
    v_fmac_f32 v237, v235, v235
    v_mfma_f32_16x16x32_bf16 v[244:247], v[196:199], v[44:47], v[244:247]
    v_cvt_pk_bf16_f32 v190, v236, v237
    v_exp_f32 v192, v192
    s_waitcnt lgkmcnt(0)
    v_mfma_f32_16x16x32_bf16 v[208:211], v[24:27], v[200:203], v[208:211]
    v_exp_f32 v194, v194
    v_mfma_f32_16x16x16_bf16 v[238:241], v[172:173], v[190:191], 0
    v_exp_f32 v193, v193
    v_mfma_f32_16x16x32_bf16 v[204:207], v[12:15], v[200:203], v[204:207]
    v_exp_f32 v195, v195
    v_mfma_f32_16x16x32_bf16 v[212:215], v[32:35], v[196:199], v[212:215]
    v_cvt_pk_bf16_f32 v157, v194, v195
    v_cvt_pk_bf16_f32 v156, v192, v193
    v_mfma_f32_16x16x32_bf16 v[212:215], v[36:39], v[200:203], v[212:215]
    v_fma_f32 v217, v210, v210, s46
    v_rsq_f32 v238, v238
    v_mfma_f32_16x16x32_bf16 v[248:251], v[196:199], v[56:59], v[248:251]
    v_rsq_f32 v239, v239
    v_mfma_f32_16x16x32_bf16 v[248:251], v[200:203], v[60:63], v[248:251]
    v_mul_f32 v238, s40, v238
    v_mul_f32 v224, v238, v224
    v_mfma_f32_16x16x32_bf16 v[244:247], v[200:203], v[48:51], v[244:247]
    v_mul_f32 v231, v239, v231
    v_mul_f32 v225, v238, v225
    v_mul_f32 v230, v239, v230
    v_mul_f32 v232, v239, v232
    v_mul_f32 v227, v238, v227
    v_mul_f32 v234, v239, v234
    v_mul_f32 v226, v238, v226
    v_mul_f32 v229, v238, v229
    v_mul_f32 v233, v239, v233
    v_cvt_pk_bf16_f32 v132, v224, v225
    v_mul_f32 v228, v238, v228
    v_mul_f32 v235, v239, v235
    v_cvt_pk_bf16_f32 v133, v226, v227
    v_cvt_pk_bf16_f32 v118, v234, v235
    v_cvt_pk_bf16_f32 v116, v230, v231
    v_cvt_pk_bf16_f32 v134, v228, v229
    v_cvt_pk_bf16_f32 v117, v232, v233
    v_cvt_pk_bf16_f32 v144, v244, v245
    v_cvt_pk_bf16_f32 v145, v246, v247
    v_mfma_f32_16x16x32_bf16 v[196:199], v[116:119], v[128:131], v[76:79]
    v_cvt_pk_bf16_f32 v153, v250, v251
    v_fma_f32 v216, v204, v204, s46
    v_cvt_pk_bf16_f32 v152, v248, v249
    v_fmac_f32 v216, v205, v205
    v_fmac_f32 v216, v206, v206
    v_fmac_f32 v217, v211, v211
    v_fmac_f32 v216, v207, v207
    v_fmac_f32 v217, v212, v212
    v_fmac_f32 v217, v213, v213
    v_fmac_f32 v216, v208, v208
    v_fmac_f32 v216, v209, v209
    v_fmac_f32 v217, v214, v214
    v_fmac_f32 v217, v215, v215
    v_cvt_pk_bf16_f32 v188, v216, v217
    v_exp_f32 v196, v196
    v_exp_f32 v197, v197
    v_mfma_f32_16x16x16_bf16 v[218:221], v[172:173], v[188:189], 0
    v_exp_f32 v198, v198
    v_exp_f32 v199, v199
    v_cvt_pk_bf16_f32 v158, v196, v197
    v_cvt_pk_bf16_f32 v159, v198, v199
    s_nop 1
    v_mfma_f32_16x16x32_bf16 v[244:247], v[140:143], v[156:159], 0
    s_nop 0
    v_rsq_f32 v218, v218
    v_mfma_f32_16x16x32_bf16 v[248:251], v[148:151], v[156:159], 0
    v_mul_f32 v218, s40, v218
    v_rsq_f32 v219, v219
    v_mul_f32 v204, v218, v204
    v_mul_f32 v206, v218, v206
    v_mul_f32 v211, v219, v211
    v_mul_f32 v205, v218, v205
    v_mul_f32 v210, v219, v210
    v_mul_f32 v208, v218, v208
    v_mul_f32 v212, v219, v212
    v_mul_f32 v209, v218, v209
    v_mul_f32 v214, v219, v214
    v_mul_f32 v207, v218, v207
    v_cvt_pk_bf16_f32 v136, v204, v205
    v_mul_f32 v213, v219, v213
    v_cvt_pk_bf16_f32 v120, v210, v211
    v_mul_f32 v215, v219, v215
    v_mfma_f32_16x16x32_bf16 v[216:219], v[124:127], v[128:131], v[100:103]
    v_cvt_pk_bf16_f32 v137, v206, v207
    ds_read_b128 v[204:207], v105
    v_cvt_pk_bf16_f32 v121, v212, v213
    v_cvt_pk_bf16_f32 v138, v208, v209
    v_cvt_pk_bf16_f32 v122, v214, v215
    v_add_u32 v101, s26, v1
    v_mfma_f32_16x16x32_bf16 v[196:199], v[116:119], v[136:139], v[84:87]
    s_nop 0
    v_exp_f32 v216, v216
    v_mfma_f32_16x16x32_bf16 v[200:203], v[120:123], v[128:131], v[88:91]
    v_cvt_pk_bf16_f32 v162, v216, 0
    v_mfma_f32_16x16x32_bf16 v[192:195], v[112:115], v[136:139], v[72:75]
    s_nop 2
    v_exp_f32 v196, v196
    v_exp_f32 v197, v197
    v_exp_f32 v198, v198
    v_exp_f32 v200, v200
    v_exp_f32 v202, v202
    v_exp_f32 v201, v201
    v_exp_f32 v203, v203
    v_cvt_pk_bf16_f32 v160, v200, v201
    v_cvt_pk_bf16_f32 v161, v202, v203
    v_mfma_f32_16x16x32_bf16 v[200:203], v[120:123], v[136:139], v[96:99]
    v_exp_f32 v194, v194
    s_waitcnt lgkmcnt(0)
    v_mfma_f32_16x16x32_bf16 v[228:231], v[204:207], v[116:119], v[106:109]
    v_exp_f32 v192, v192
    v_mfma_f32_16x16x32_bf16 v[236:239], v[204:207], v[124:127], v[106:109]
    v_exp_f32 v195, v195
    v_mfma_f32_16x16x32_bf16 v[224:227], v[204:207], v[112:115], v[106:109]
    v_exp_f32 v193, v193
    v_mfma_f32_16x16x32_bf16 v[232:235], v[204:207], v[120:123], v[106:109]
    v_exp_f32 v202, v202
    v_mfma_f32_16x16x32_bf16 v[244:247], v[144:147], v[160:163], v[244:247]
    v_exp_f32 v200, v200
    v_mfma_f32_16x16x32_bf16 v[248:251], v[152:155], v[160:163], v[248:251]
    v_exp_f32 v201, v201
    v_exp_f32 v199, v199
    v_bfi_b32 v208, v181, v228, v224
    v_mfma_f32_16x16x32_bf16 v[224:227], v[112:115], v[132:135], v[68:71]
    v_bfi_b32 v209, v181, v236, v232
    v_bfi_b32 v208, v182, v209, v208
    v_mfma_f32_16x16x32_bf16 v[232:235], v[120:123], v[132:135], v[92:95]
    v_exp_f32 v208, v208
    v_mfma_f32_16x16x32_bf16 v[228:231], v[116:119], v[132:135], v[80:83]
    v_cvt_pk_bf16_f32 v240, v208, 0
    ds_write_b16 v185, v240
    ds_read2_b64 v[168:171], v186 offset0:8 offset1:12
    ds_read2_b64 v[164:167], v186 offset0:0 offset1:4
    v_mfma_f32_16x16x32_bf16 v[236:239], v[124:127], v[132:135], v[102:105]
    v_rcp_f32 v220, v250
    v_exp_f32 v225, v225
    v_mul_f32 v247, v220, v247
    v_mul_f32 v244, v220, v244
    v_mul_f32 v245, v220, v245
    v_mul_f32 v246, v220, v246
    v_cvt_pk_bf16_f32 v217, v244, v245
    v_cvt_pk_bf16_f32 v218, v246, v247
    ds_write2_b32 v103, v217, v218 offset0:0 offset1:64
    v_mul_f32 v249, v220, v249
    v_mul_f32 v248, v220, v248
    v_cvt_pk_bf16_f32 v219, v248, v249
    ds_write_b32 v103, v219 offset:512
    v_mfma_f32_16x16x32_bf16 v[216:219], v[124:127], v[136:139], v[104:107]
    v_exp_f32 v224, v224
    v_exp_f32 v226, v226
    v_exp_f32 v227, v227
    v_exp_f32 v232, v232
    v_exp_f32 v231, v231
    v_exp_f32 v230, v230
    v_exp_f32 v228, v228
    s_waitcnt lgkmcnt(2)
    v_mfma_f32_16x16x32_bf16 v[204:207], v[140:143], v[164:167], 0
    v_exp_f32 v229, v229
    v_mfma_f32_16x16x32_bf16 v[208:211], v[148:151], v[164:167], 0
    v_exp_f32 v235, v235
    v_mfma_f32_16x16x32_bf16 v[204:207], v[144:147], v[168:171], v[204:207]
    v_exp_f32 v233, v233
    v_mfma_f32_16x16x32_bf16 v[208:211], v[152:155], v[168:171], v[208:211]
    v_exp_f32 v234, v234
    v_exp_f32 v236, v236
    v_cvt_pk_bf16_f32 v166, v228, v229
    v_cvt_pk_bf16_f32 v167, v230, v231
    v_cvt_pk_bf16_f32 v164, v224, v225
    v_cvt_pk_bf16_f32 v165, v226, v227
    v_cvt_pk_bf16_f32 v169, v234, v235
    v_cvt_pk_bf16_f32 v170, v236, 0
    v_rcp_f32 v252, v210
    v_cvt_pk_bf16_f32 v168, v232, v233
    v_mul_f32 v204, v252, v204
    v_mul_f32 v206, v252, v206
    v_mul_f32 v205, v252, v205
    v_mul_f32 v207, v252, v207
    v_mul_f32 v208, v252, v208
    v_cvt_pk_bf16_f32 v253, v204, v205
    v_mul_f32 v209, v252, v209
    v_cvt_pk_bf16_f32 v254, v206, v207
    v_mfma_f32_16x16x32_bf16 v[204:207], v[140:143], v[164:167], 0
    v_cvt_pk_bf16_f32 v255, v208, v209
    s_mov_b64 exec, s[42:43]
    ds_write2_b32 v103, v253, v254 offset0:48 offset1:112
    ds_write_b32 v103, v255 offset:704
    s_mov_b64 exec, -1
    v_mfma_f32_16x16x32_bf16 v[204:207], v[144:147], v[168:171], v[204:207]
    v_exp_f32 v216, v216
    v_mfma_f32_16x16x32_bf16 v[208:211], v[148:151], v[164:167], 0
    v_cvt_pk_bf16_f32 v157, v194, v195
    v_exp_f32 v203, v203
    v_mfma_f32_16x16x32_bf16 v[208:211], v[152:155], v[168:171], v[208:211]
    v_cvt_pk_bf16_f32 v160, v200, v201
    v_cvt_pk_bf16_f32 v158, v196, v197
    v_cvt_pk_bf16_f32 v156, v192, v193
    ds_read_b128 v[192:195], v101 offset:0
    v_cvt_pk_bf16_f32 v159, v198, v199
    ds_read_b128 v[196:199], v101 offset:1024
    v_cvt_pk_bf16_f32 v161, v202, v203
    v_mfma_f32_16x16x32_bf16 v[248:251], v[148:151], v[156:159], 0
    ds_read_b128 v[200:203], v101 offset:2048
    v_mfma_f32_16x16x32_bf16 v[244:247], v[140:143], v[156:159], 0
    v_rcp_f32 v240, v210
    v_cvt_pk_bf16_f32 v162, v216, 0
    v_mul_f32 v204, v240, v204
    v_mul_f32 v208, v240, v208
    v_mfma_f32_16x16x32_bf16 v[248:251], v[152:155], v[160:163], v[248:251]
    v_mul_f32 v206, v240, v206
    v_mul_f32 v205, v240, v205
    v_mfma_f32_16x16x32_bf16 v[244:247], v[144:147], v[160:163], v[244:247]
    v_mul_f32 v209, v240, v209
    v_mul_f32 v207, v240, v207
    v_cvt_pk_bf16_f32 v238, v206, v207
    v_cvt_pk_bf16_f32 v237, v204, v205
    ds_write2_b32 v103, v237, v238 offset0:16 offset1:80
    v_cvt_pk_bf16_f32 v239, v208, v209
    ds_write_b32 v103, v239 offset:576
    v_rcp_f32 v220, v250
    v_add_u32 v105, 64, v105
    v_mul_f32 v245, v220, v245
    s_waitcnt lgkmcnt(4)
    v_mfma_f32_16x16x32_bf16 v[208:211], v[16:19], v[192:195], 0
    v_mul_f32 v246, v220, v246
    v_mul_f32 v248, v220, v248
    s_waitcnt lgkmcnt(3)
    v_mfma_f32_16x16x32_bf16 v[208:211], v[20:23], v[196:199], v[208:211]
    v_mul_f32 v244, v220, v244
    v_mul_f32 v249, v220, v249
    v_mfma_f32_16x16x32_bf16 v[204:207], v[4:7], v[192:195], 0
    v_mul_f32 v247, v220, v247
    v_cvt_pk_bf16_f32 v218, v246, v247
    v_mfma_f32_16x16x32_bf16 v[204:207], v[8:11], v[196:199], v[204:207]
    v_cvt_pk_bf16_f32 v217, v244, v245
    ds_write2_b32 v103, v217, v218 offset0:32 offset1:96
    v_mfma_f32_16x16x32_bf16 v[212:215], v[28:31], v[192:195], 0
    v_cvt_pk_bf16_f32 v219, v248, v249
    ds_write_b32 v103, v219 offset:640
    v_mfma_f32_16x16x32_bf16 v[212:215], v[32:35], v[196:199], v[212:215]
    v_mov_b32_dpp v127, v127 row_ror:4 row_mask:0xf bank_mask:0xf
    v_add_u32 v103, s78, v103
    s_sub_u32 s78, 0, s78
    s_waitcnt lgkmcnt(4)
    v_mfma_f32_16x16x32_bf16 v[208:211], v[24:27], v[200:203], v[208:211]
    v_mfma_f32_16x16x32_bf16 v[212:215], v[36:39], v[200:203], v[212:215]
    v_mfma_f32_16x16x32_bf16 v[204:207], v[12:15], v[200:203], v[204:207]
    s_waitcnt lgkmcnt(0)
    s_barrier
L_M_BODY1_F:
    v_mfma_f32_16x16x32_bf16 v[244:247], v[192:195], v[40:43], 0
    s_add_u32 s26, s26, 9216
    s_cmp_eq_u32 s26, 73728
    v_mfma_f32_16x16x32_bf16 v[248:251], v[192:195], v[52:55], v[176:179]
    ds_read_b128 v[192:195], v101 offset:3072
    v_mfma_f32_16x16x32_bf16 v[244:247], v[196:199], v[44:47], v[244:247]
    s_cselect_b32 s26, 0, s26
    s_add_u32 s24, s24, 1
    v_mfma_f32_16x16x32_bf16 v[248:251], v[196:199], v[56:59], v[248:251]
    ds_read_b128 v[196:199], v101 offset:4096
    v_mfma_f32_16x16x32_bf16 v[244:247], v[200:203], v[48:51], v[244:247]
    v_fma_f32 v217, v210, v210, s46
    v_fma_f32 v216, v204, v204, s46
    v_mfma_f32_16x16x32_bf16 v[248:251], v[200:203], v[60:63], v[248:251]
    ds_read_b128 v[200:203], v101 offset:5120
    v_fmac_f32 v216, v205, v205
    v_fmac_f32 v216, v206, v206
    v_fmac_f32 v216, v207, v207
    v_fmac_f32 v216, v208, v208
    v_cvt_pk_bf16_f32 v141, v246, v247
    v_cvt_pk_bf16_f32 v140, v244, v245
    v_fmac_f32 v216, v209, v209
    v_cvt_pk_bf16_f32 v149, v250, v251
    v_cvt_pk_bf16_f32 v148, v248, v249
    v_fmac_f32 v217, v211, v211
    v_fmac_f32 v217, v212, v212
    v_fmac_f32 v217, v213, v213
    v_fmac_f32 v217, v214, v214
    v_fmac_f32 v217, v215, v215
    v_cvt_pk_bf16_f32 v188, v216, v217
    s_nop 1
    v_mfma_f32_16x16x16_bf16 v[218:221], v[172:173], v[188:189], 0
    s_waitcnt lgkmcnt(2)
    v_mfma_f32_16x16x32_bf16 v[224:227], v[4:7], v[192:195], 0
    v_mfma_f32_16x16x32_bf16 v[228:231], v[16:19], v[192:195], 0
    v_mfma_f32_16x16x32_bf16 v[244:247], v[192:195], v[40:43], 0
    v_mfma_f32_16x16x32_bf16 v[232:235], v[28:31], v[192:195], 0
    v_mfma_f32_16x16x32_bf16 v[248:251], v[192:195], v[52:55], v[176:179]
    ds_read_b128 v[192:195], v101 offset:6144
    s_waitcnt lgkmcnt(2)
    v_mfma_f32_16x16x32_bf16 v[224:227], v[8:11], v[196:199], v[224:227]
    v_rsq_f32 v219, v219
    v_mfma_f32_16x16x32_bf16 v[232:235], v[32:35], v[196:199], v[232:235]
    v_rsq_f32 v218, v218
    v_mfma_f32_16x16x32_bf16 v[228:231], v[20:23], v[196:199], v[228:231]
    v_mul_f32 v218, s40, v218
    v_mul_f32 v204, v218, v204
    s_waitcnt lgkmcnt(1)
    v_mfma_f32_16x16x32_bf16 v[224:227], v[12:15], v[200:203], v[224:227]
    v_mul_f32 v210, v219, v210
    v_mul_f32 v212, v219, v212
    v_mfma_f32_16x16x32_bf16 v[232:235], v[36:39], v[200:203], v[232:235]
    v_mul_f32 v205, v218, v205
    v_mul_f32 v211, v219, v211
    v_mfma_f32_16x16x32_bf16 v[244:247], v[196:199], v[44:47], v[244:247]
    v_mul_f32 v206, v218, v206
    v_mul_f32 v213, v219, v213
    v_mfma_f32_16x16x32_bf16 v[244:247], v[200:203], v[48:51], v[244:247]
    v_mul_f32 v207, v218, v207
    v_mul_f32 v214, v219, v214
    v_mfma_f32_16x16x32_bf16 v[248:251], v[196:199], v[56:59], v[248:251]
    ds_read_b128 v[196:199], v101 offset:7168
    v_mfma_f32_16x16x32_bf16 v[248:251], v[200:203], v[60:63], v[248:251]
    v_mul_f32 v215, v219, v215
    v_cvt_pk_bf16_f32 v129, v206, v207
    v_mfma_f32_16x16x32_bf16 v[228:231], v[24:27], v[200:203], v[228:231]
    ds_read_b128 v[200:203], v101 offset:8192
    v_mul_f32 v208, v218, v208
    v_mul_f32 v209, v218, v209
    v_cvt_pk_bf16_f32 v112, v210, v211
    v_cvt_pk_bf16_f32 v128, v204, v205
    s_waitcnt lgkmcnt(2)
    v_mfma_f32_16x16x32_bf16 v[204:207], v[4:7], v[192:195], 0
    v_cvt_pk_bf16_f32 v114, v214, v215
    v_cvt_pk_bf16_f32 v113, v212, v213
    v_mfma_f32_16x16x32_bf16 v[212:215], v[28:31], v[192:195], 0
    v_cvt_pk_bf16_f32 v130, v208, v209
    v_cvt_pk_bf16_f32 v150, v248, v249
    v_mfma_f32_16x16x32_bf16 v[208:211], v[16:19], v[192:195], 0
    v_cvt_pk_bf16_f32 v143, v246, v247
    v_fma_f32 v237, v230, v230, s46
    v_fma_f32 v236, v224, v224, s46
    v_cvt_pk_bf16_f32 v142, v244, v245
    v_mfma_f32_16x16x32_bf16 v[244:247], v[192:195], v[40:43], 0
    v_fmac_f32 v236, v225, v225
    v_fmac_f32 v237, v231, v231
    v_cvt_pk_bf16_f32 v151, v250, v251
    v_mfma_f32_16x16x32_bf16 v[248:251], v[192:195], v[52:55], v[176:179]
    v_fmac_f32 v237, v232, v232
    v_fmac_f32 v237, v233, v233
    v_mfma_f32_16x16x32_bf16 v[192:195], v[112:115], v[128:131], v[64:67]
    v_fmac_f32 v236, v226, v226
    v_fmac_f32 v236, v227, v227
    s_waitcnt lgkmcnt(1)
    v_mfma_f32_16x16x32_bf16 v[208:211], v[20:23], v[196:199], v[208:211]
    v_fmac_f32 v236, v228, v228
    v_fmac_f32 v236, v229, v229
    v_mfma_f32_16x16x32_bf16 v[204:207], v[8:11], v[196:199], v[204:207]
    v_fmac_f32 v237, v234, v234
    v_fmac_f32 v237, v235, v235
    v_mfma_f32_16x16x32_bf16 v[244:247], v[196:199], v[44:47], v[244:247]
    v_cvt_pk_bf16_f32 v190, v236, v237
    v_exp_f32 v192, v192
    s_waitcnt lgkmcnt(0)
    v_mfma_f32_16x16x32_bf16 v[208:211], v[24:27], v[200:203], v[208:211]
    v_exp_f32 v194, v194
    v_mfma_f32_16x16x16_bf16 v[238:241], v[172:173], v[190:191], 0
    v_exp_f32 v193, v193
    v_mfma_f32_16x16x32_bf16 v[204:207], v[12:15], v[200:203], v[204:207]
    v_exp_f32 v195, v195
    v_mfma_f32_16x16x32_bf16 v[212:215], v[32:35], v[196:199], v[212:215]
    v_cvt_pk_bf16_f32 v157, v194, v195
    v_cvt_pk_bf16_f32 v156, v192, v193
    v_mfma_f32_16x16x32_bf16 v[212:215], v[36:39], v[200:203], v[212:215]
    v_fma_f32 v217, v210, v210, s46
    v_rsq_f32 v238, v238
    v_mfma_f32_16x16x32_bf16 v[248:251], v[196:199], v[56:59], v[248:251]
    v_rsq_f32 v239, v239
    v_mfma_f32_16x16x32_bf16 v[248:251], v[200:203], v[60:63], v[248:251]
    v_mul_f32 v238, s40, v238
    v_mul_f32 v224, v238, v224
    v_mfma_f32_16x16x32_bf16 v[244:247], v[200:203], v[48:51], v[244:247]
    v_mul_f32 v231, v239, v231
    v_mul_f32 v225, v238, v225
    v_mul_f32 v230, v239, v230
    v_mul_f32 v232, v239, v232
    v_mul_f32 v227, v238, v227
    v_mul_f32 v234, v239, v234
    v_mul_f32 v226, v238, v226
    v_mul_f32 v229, v238, v229
    v_mul_f32 v233, v239, v233
    v_cvt_pk_bf16_f32 v132, v224, v225
    v_mul_f32 v228, v238, v228
    v_mul_f32 v235, v239, v235
    v_cvt_pk_bf16_f32 v133, v226, v227
    v_cvt_pk_bf16_f32 v118, v234, v235
    v_cvt_pk_bf16_f32 v116, v230, v231
    v_cvt_pk_bf16_f32 v134, v228, v229
    v_cvt_pk_bf16_f32 v117, v232, v233
    v_cvt_pk_bf16_f32 v144, v244, v245
    v_cvt_pk_bf16_f32 v145, v246, v247
    v_mfma_f32_16x16x32_bf16 v[196:199], v[116:119], v[128:131], v[76:79]
    v_cvt_pk_bf16_f32 v153, v250, v251
    v_fma_f32 v216, v204, v204, s46
    v_cvt_pk_bf16_f32 v152, v248, v249
    v_fmac_f32 v216, v205, v205
    v_fmac_f32 v216, v206, v206
    v_fmac_f32 v217, v211, v211
    v_fmac_f32 v216, v207, v207
    v_fmac_f32 v217, v212, v212
    v_fmac_f32 v217, v213, v213
    v_fmac_f32 v216, v208, v208
    v_fmac_f32 v216, v209, v209
    v_fmac_f32 v217, v214, v214
    v_fmac_f32 v217, v215, v215
    v_cvt_pk_bf16_f32 v188, v216, v217
    v_exp_f32 v196, v196
    v_exp_f32 v197, v197
    v_mfma_f32_16x16x16_bf16 v[218:221], v[172:173], v[188:189], 0
    v_exp_f32 v198, v198
    v_exp_f32 v199, v199
    v_cvt_pk_bf16_f32 v158, v196, v197
    v_cvt_pk_bf16_f32 v159, v198, v199
    s_nop 1
    v_mfma_f32_16x16x32_bf16 v[244:247], v[140:143], v[156:159], 0
    s_nop 0
    v_rsq_f32 v218, v218
    v_mfma_f32_16x16x32_bf16 v[248:251], v[148:151], v[156:159], 0
    v_mul_f32 v218, s40, v218
    v_rsq_f32 v219, v219
    v_mul_f32 v204, v218, v204
    v_mul_f32 v206, v218, v206
    v_mul_f32 v211, v219, v211
    v_mul_f32 v205, v218, v205
    v_mul_f32 v210, v219, v210
    v_mul_f32 v208, v218, v208
    v_mul_f32 v212, v219, v212
    v_mul_f32 v209, v218, v209
    v_mul_f32 v214, v219, v214
    v_mul_f32 v207, v218, v207
    v_cvt_pk_bf16_f32 v136, v204, v205
    v_mul_f32 v213, v219, v213
    v_cvt_pk_bf16_f32 v120, v210, v211
    v_mul_f32 v215, v219, v215
    v_mfma_f32_16x16x32_bf16 v[216:219], v[124:127], v[128:131], v[100:103]
    v_cvt_pk_bf16_f32 v137, v206, v207
    ds_read_b128 v[204:207], v105
    v_cvt_pk_bf16_f32 v121, v212, v213
    v_cvt_pk_bf16_f32 v138, v208, v209
    v_cvt_pk_bf16_f32 v122, v214, v215
    v_add_u32 v101, s26, v1
    v_mfma_f32_16x16x32_bf16 v[196:199], v[116:119], v[136:139], v[84:87]
    s_nop 0
    v_exp_f32 v216, v216
    v_mfma_f32_16x16x32_bf16 v[200:203], v[120:123], v[128:131], v[88:91]
    v_cvt_pk_bf16_f32 v162, v216, 0
    v_mfma_f32_16x16x32_bf16 v[192:195], v[112:115], v[136:139], v[72:75]
    s_nop 2
    v_exp_f32 v196, v196
    v_exp_f32 v197, v197
    v_exp_f32 v198, v198
    v_exp_f32 v200, v200
    v_exp_f32 v202, v202
    v_exp_f32 v201, v201
    v_exp_f32 v203, v203
    v_cvt_pk_bf16_f32 v160, v200, v201
    v_cvt_pk_bf16_f32 v161, v202, v203
    v_mfma_f32_16x16x32_bf16 v[200:203], v[120:123], v[136:139], v[96:99]
    v_exp_f32 v194, v194
    s_waitcnt lgkmcnt(0)
    v_mfma_f32_16x16x32_bf16 v[228:231], v[204:207], v[116:119], v[106:109]
    v_exp_f32 v192, v192
    v_mfma_f32_16x16x32_bf16 v[236:239], v[204:207], v[124:127], v[106:109]
    v_exp_f32 v195, v195
    v_mfma_f32_16x16x32_bf16 v[224:227], v[204:207], v[112:115], v[106:109]
    v_exp_f32 v193, v193
    v_mfma_f32_16x16x32_bf16 v[232:235], v[204:207], v[120:123], v[106:109]
    v_exp_f32 v202, v202
    v_mfma_f32_16x16x32_bf16 v[244:247], v[144:147], v[160:163], v[244:247]
    v_exp_f32 v200, v200
    v_mfma_f32_16x16x32_bf16 v[248:251], v[152:155], v[160:163], v[248:251]
    v_exp_f32 v201, v201
    v_exp_f32 v199, v199
    v_bfi_b32 v208, v181, v228, v224
    v_mfma_f32_16x16x32_bf16 v[224:227], v[112:115], v[132:135], v[68:71]
    v_bfi_b32 v209, v181, v236, v232
    v_bfi_b32 v208, v182, v209, v208
    v_mfma_f32_16x16x32_bf16 v[232:235], v[120:123], v[132:135], v[92:95]
    v_exp_f32 v208, v208
    v_mfma_f32_16x16x32_bf16 v[228:231], v[116:119], v[132:135], v[80:83]
    v_cvt_pk_bf16_f32 v240, v208, 0
    ds_write_b16 v185, v240
    ds_read2_b64 v[168:171], v186 offset0:8 offset1:12
    ds_read2_b64 v[164:167], v186 offset0:0 offset1:4
    v_mfma_f32_16x16x32_bf16 v[236:239], v[124:127], v[132:135], v[102:105]
    v_rcp_f32 v220, v250
    v_exp_f32 v225, v225
    v_mul_f32 v247, v220, v247
    v_mul_f32 v244, v220, v244
    v_mul_f32 v245, v220, v245
    v_mul_f32 v246, v220, v246
    v_cvt_pk_bf16_f32 v217, v244, v245
    v_cvt_pk_bf16_f32 v218, v246, v247
    ds_write2_b32 v103, v217, v218 offset0:0 offset1:64
    v_mul_f32 v249, v220, v249
    v_mul_f32 v248, v220, v248
    v_cvt_pk_bf16_f32 v219, v248, v249
    ds_write_b32 v103, v219 offset:512
    v_mfma_f32_16x16x32_bf16 v[216:219], v[124:127], v[136:139], v[104:107]
    v_exp_f32 v224, v224
    v_exp_f32 v226, v226
    v_exp_f32 v227, v227
    v_exp_f32 v232, v232
    v_exp_f32 v231, v231
    v_exp_f32 v230, v230
    v_exp_f32 v228, v228
    s_waitcnt lgkmcnt(2)
    v_mfma_f32_16x16x32_bf16 v[204:207], v[140:143], v[164:167], 0
    v_exp_f32 v229, v229
    v_mfma_f32_16x16x32_bf16 v[208:211], v[148:151], v[164:167], 0
    v_exp_f32 v235, v235
    v_mfma_f32_16x16x32_bf16 v[204:207], v[144:147], v[168:171], v[204:207]
    v_exp_f32 v233, v233
    v_mfma_f32_16x16x32_bf16 v[208:211], v[152:155], v[168:171], v[208:211]
    v_exp_f32 v234, v234
    v_exp_f32 v236, v236
    v_cvt_pk_bf16_f32 v166, v228, v229
    v_cvt_pk_bf16_f32 v167, v230, v231
    v_cvt_pk_bf16_f32 v164, v224, v225
    v_cvt_pk_bf16_f32 v165, v226, v227
    v_cvt_pk_bf16_f32 v169, v234, v235
    v_cvt_pk_bf16_f32 v170, v236, 0
    v_rcp_f32 v252, v210
    v_cvt_pk_bf16_f32 v168, v232, v233
    v_mul_f32 v204, v252, v204
    v_mul_f32 v206, v252, v206
    v_mul_f32 v205, v252, v205
    v_mul_f32 v207, v252, v207
    v_mul_f32 v208, v252, v208
    v_cvt_pk_bf16_f32 v253, v204, v205
    v_mul_f32 v209, v252, v209
    v_cvt_pk_bf16_f32 v254, v206, v207
    v_mfma_f32_16x16x32_bf16 v[204:207], v[140:143], v[164:167], 0
    v_cvt_pk_bf16_f32 v255, v208, v209
    s_mov_b64 exec, s[42:43]
    ds_write2_b32 v103, v253, v254 offset0:48 offset1:112
    ds_write_b32 v103, v255 offset:704
    s_mov_b64 exec, -1
    v_mfma_f32_16x16x32_bf16 v[204:207], v[144:147], v[168:171], v[204:207]
    v_exp_f32 v216, v216
    v_mfma_f32_16x16x32_bf16 v[208:211], v[148:151], v[164:167], 0
    v_cvt_pk_bf16_f32 v157, v194, v195
    v_exp_f32 v203, v203
    v_mfma_f32_16x16x32_bf16 v[208:211], v[152:155], v[168:171], v[208:211]
    v_cvt_pk_bf16_f32 v160, v200, v201
    v_cvt_pk_bf16_f32 v158, v196, v197
    v_cvt_pk_bf16_f32 v156, v192, v193
    ds_read_b128 v[192:195], v101 offset:0
    v_cvt_pk_bf16_f32 v159, v198, v199
    ds_read_b128 v[196:199], v101 offset:1024
    v_cvt_pk_bf16_f32 v161, v202, v203
    v_mfma_f32_16x16x32_bf16 v[248:251], v[148:151], v[156:159], 0
    ds_read_b128 v[200:203], v101 offset:2048
    v_mfma_f32_16x16x32_bf16 v[244:247], v[140:143], v[156:159], 0
    v_rcp_f32 v240, v210
    v_cvt_pk_bf16_f32 v162, v216, 0
    v_mul_f32 v204, v240, v204
    v_mul_f32 v208, v240, v208
    v_mfma_f32_16x16x32_bf16 v[248:251], v[152:155], v[160:163], v[248:251]
    v_mul_f32 v206, v240, v206
    v_mul_f32 v205, v240, v205
    v_mfma_f32_16x16x32_bf16 v[244:247], v[144:147], v[160:163], v[244:247]
    v_mul_f32 v209, v240, v209
    v_mul_f32 v207, v240, v207
    v_cvt_pk_bf16_f32 v238, v206, v207
    v_cvt_pk_bf16_f32 v237, v204, v205
    ds_write2_b32 v103, v237, v238 offset0:16 offset1:80
    v_cvt_pk_bf16_f32 v239, v208, v209
    ds_write_b32 v103, v239 offset:576
    v_rcp_f32 v220, v250
    v_add_u32 v105, 64, v105
    v_mul_f32 v245, v220, v245
    s_waitcnt lgkmcnt(4)
    v_mfma_f32_16x16x32_bf16 v[208:211], v[16:19], v[192:195], 0
    v_mul_f32 v246, v220, v246
    v_mul_f32 v248, v220, v248
    s_waitcnt lgkmcnt(3)
    v_mfma_f32_16x16x32_bf16 v[208:211], v[20:23], v[196:199], v[208:211]
    v_mul_f32 v244, v220, v244
    v_mul_f32 v249, v220, v249
    v_mfma_f32_16x16x32_bf16 v[204:207], v[4:7], v[192:195], 0
    v_mul_f32 v247, v220, v247
    v_cvt_pk_bf16_f32 v218, v246, v247
    v_mfma_f32_16x16x32_bf16 v[204:207], v[8:11], v[196:199], v[204:207]
    v_cvt_pk_bf16_f32 v217, v244, v245
    ds_write2_b32 v103, v217, v218 offset0:32 offset1:96
    v_mfma_f32_16x16x32_bf16 v[212:215], v[28:31], v[192:195], 0
    v_cvt_pk_bf16_f32 v219, v248, v249
    ds_write_b32 v103, v219 offset:640
    v_mfma_f32_16x16x32_bf16 v[212:215], v[32:35], v[196:199], v[212:215]
    v_mov_b32_dpp v127, v127 row_ror:4 row_mask:0xf bank_mask:0xf
    v_add_u32 v103, s78, v103
    s_sub_u32 s78, 0, s78
    s_waitcnt lgkmcnt(4)
    v_mfma_f32_16x16x32_bf16 v[208:211], v[24:27], v[200:203], v[208:211]
    v_mfma_f32_16x16x32_bf16 v[212:215], v[36:39], v[200:203], v[212:215]
    v_mfma_f32_16x16x32_bf16 v[204:207], v[12:15], v[200:203], v[204:207]
    s_waitcnt lgkmcnt(0)
    s_barrier
L_M_BODY2_F:
    v_mfma_f32_16x16x32_bf16 v[244:247], v[192:195], v[40:43], 0
    s_add_u32 s26, s26, 9216
    s_cmp_eq_u32 s26, 73728
    v_mfma_f32_16x16x32_bf16 v[248:251], v[192:195], v[52:55], v[176:179]
    ds_read_b128 v[192:195], v101 offset:3072
    v_mfma_f32_16x16x32_bf16 v[244:247], v[196:199], v[44:47], v[244:247]
    s_cselect_b32 s26, 0, s26
    s_add_u32 s24, s24, 1
    v_mfma_f32_16x16x32_bf16 v[248:251], v[196:199], v[56:59], v[248:251]
    ds_read_b128 v[196:199], v101 offset:4096
    v_mfma_f32_16x16x32_bf16 v[244:247], v[200:203], v[48:51], v[244:247]
    v_fma_f32 v217, v210, v210, s46
    v_fma_f32 v216, v204, v204, s46
    v_mfma_f32_16x16x32_bf16 v[248:251], v[200:203], v[60:63], v[248:251]
    ds_read_b128 v[200:203], v101 offset:5120
    v_fmac_f32 v216, v205, v205
    v_fmac_f32 v216, v206, v206
    v_fmac_f32 v216, v207, v207
    v_fmac_f32 v216, v208, v208
    v_cvt_pk_bf16_f32 v141, v246, v247
    v_cvt_pk_bf16_f32 v140, v244, v245
    v_fmac_f32 v216, v209, v209
    v_cvt_pk_bf16_f32 v149, v250, v251
    v_cvt_pk_bf16_f32 v148, v248, v249
    v_fmac_f32 v217, v211, v211
    v_fmac_f32 v217, v212, v212
    v_fmac_f32 v217, v213, v213
    v_fmac_f32 v217, v214, v214
    v_fmac_f32 v217, v215, v215
    v_cvt_pk_bf16_f32 v188, v216, v217
    s_nop 1
    v_mfma_f32_16x16x16_bf16 v[218:221], v[172:173], v[188:189], 0
    s_waitcnt lgkmcnt(2)
    v_mfma_f32_16x16x32_bf16 v[224:227], v[4:7], v[192:195], 0
    v_mfma_f32_16x16x32_bf16 v[228:231], v[16:19], v[192:195], 0
    v_mfma_f32_16x16x32_bf16 v[244:247], v[192:195], v[40:43], 0
    v_mfma_f32_16x16x32_bf16 v[232:235], v[28:31], v[192:195], 0
    v_mfma_f32_16x16x32_bf16 v[248:251], v[192:195], v[52:55], v[176:179]
    ds_read_b128 v[192:195], v101 offset:6144
    s_waitcnt lgkmcnt(2)
    v_mfma_f32_16x16x32_bf16 v[224:227], v[8:11], v[196:199], v[224:227]
    v_rsq_f32 v219, v219
    v_mfma_f32_16x16x32_bf16 v[232:235], v[32:35], v[196:199], v[232:235]
    v_rsq_f32 v218, v218
    v_mfma_f32_16x16x32_bf16 v[228:231], v[20:23], v[196:199], v[228:231]
    v_mul_f32 v218, s40, v218
    v_mul_f32 v204, v218, v204
    s_waitcnt lgkmcnt(1)
    v_mfma_f32_16x16x32_bf16 v[224:227], v[12:15], v[200:203], v[224:227]
    v_mul_f32 v210, v219, v210
    v_mul_f32 v212, v219, v212
    v_mfma_f32_16x16x32_bf16 v[232:235], v[36:39], v[200:203], v[232:235]
    v_mul_f32 v205, v218, v205
    v_mul_f32 v211, v219, v211
    v_mfma_f32_16x16x32_bf16 v[244:247], v[196:199], v[44:47], v[244:247]
    v_mul_f32 v206, v218, v206
    v_mul_f32 v213, v219, v213
    v_mfma_f32_16x16x32_bf16 v[244:247], v[200:203], v[48:51], v[244:247]
    v_mul_f32 v207, v218, v207
    v_mul_f32 v214, v219, v214
    v_mfma_f32_16x16x32_bf16 v[248:251], v[196:199], v[56:59], v[248:251]
    ds_read_b128 v[196:199], v101 offset:7168
    v_mfma_f32_16x16x32_bf16 v[248:251], v[200:203], v[60:63], v[248:251]
    v_mul_f32 v215, v219, v215
    v_cvt_pk_bf16_f32 v129, v206, v207
    v_mfma_f32_16x16x32_bf16 v[228:231], v[24:27], v[200:203], v[228:231]
    ds_read_b128 v[200:203], v101 offset:8192
    v_mul_f32 v208, v218, v208
    v_mul_f32 v209, v218, v209
    v_cvt_pk_bf16_f32 v112, v210, v211
    v_cvt_pk_bf16_f32 v128, v204, v205
    s_waitcnt lgkmcnt(2)
    v_mfma_f32_16x16x32_bf16 v[204:207], v[4:7], v[192:195], 0
    v_cvt_pk_bf16_f32 v114, v214, v215
    v_cvt_pk_bf16_f32 v113, v212, v213
    v_mfma_f32_16x16x32_bf16 v[212:215], v[28:31], v[192:195], 0
    v_cvt_pk_bf16_f32 v130, v208, v209
    v_cvt_pk_bf16_f32 v150, v248, v249
    v_mfma_f32_16x16x32_bf16 v[208:211], v[16:19], v[192:195], 0
    v_cvt_pk_bf16_f32 v143, v246, v247
    v_fma_f32 v237, v230, v230, s46
    v_fma_f32 v236, v224, v224, s46
    v_cvt_pk_bf16_f32 v142, v244, v245
    v_mfma_f32_16x16x32_bf16 v[244:247], v[192:195], v[40:43], 0
    v_fmac_f32 v236, v225, v225
    v_fmac_f32 v237, v231, v231
    v_cvt_pk_bf16_f32 v151, v250, v251
    v_mfma_f32_16x16x32_bf16 v[248:251], v[192:195], v[52:55], v[176:179]
    v_fmac_f32 v237, v232, v232
    v_fmac_f32 v237, v233, v233
    v_mfma_f32_16x16x32_bf16 v[192:195], v[112:115], v[128:131], v[64:67]
    v_fmac_f32 v236, v226, v226
    v_fmac_f32 v236, v227, v227
    s_waitcnt lgkmcnt(1)
    v_mfma_f32_16x16x32_bf16 v[208:211], v[20:23], v[196:199], v[208:211]
    v_fmac_f32 v236, v228, v228
    v_fmac_f32 v236, v229, v229
    v_mfma_f32_16x16x32_bf16 v[204:207], v[8:11], v[196:199], v[204:207]
    v_fmac_f32 v237, v234, v234
    v_fmac_f32 v237, v235, v235
    v_mfma_f32_16x16x32_bf16 v[244:247], v[196:199], v[44:47], v[244:247]
    v_cvt_pk_bf16_f32 v190, v236, v237
    v_exp_f32 v192, v192
    s_waitcnt lgkmcnt(0)
    v_mfma_f32_16x16x32_bf16 v[208:211], v[24:27], v[200:203], v[208:211]
    v_exp_f32 v194, v194
    v_mfma_f32_16x16x16_bf16 v[238:241], v[172:173], v[190:191], 0
    v_exp_f32 v193, v193
    v_mfma_f32_16x16x32_bf16 v[204:207], v[12:15], v[200:203], v[204:207]
    v_exp_f32 v195, v195
    v_mfma_f32_16x16x32_bf16 v[212:215], v[32:35], v[196:199], v[212:215]
    v_cvt_pk_bf16_f32 v157, v194, v195
    v_cvt_pk_bf16_f32 v156, v192, v193
    v_mfma_f32_16x16x32_bf16 v[212:215], v[36:39], v[200:203], v[212:215]
    v_fma_f32 v217, v210, v210, s46
    v_rsq_f32 v238, v238
    v_mfma_f32_16x16x32_bf16 v[248:251], v[196:199], v[56:59], v[248:251]
    v_rsq_f32 v239, v239
    v_mfma_f32_16x16x32_bf16 v[248:251], v[200:203], v[60:63], v[248:251]
    v_mul_f32 v238, s40, v238
    v_mul_f32 v224, v238, v224
    v_mfma_f32_16x16x32_bf16 v[244:247], v[200:203], v[48:51], v[244:247]
    v_mul_f32 v231, v239, v231
    v_mul_f32 v225, v238, v225
    v_mul_f32 v230, v239, v230
    v_mul_f32 v232, v239, v232
    v_mul_f32 v227, v238, v227
    v_mul_f32 v234, v239, v234
    v_mul_f32 v226, v238, v226
    v_mul_f32 v229, v238, v229
    v_mul_f32 v233, v239, v233
    v_cvt_pk_bf16_f32 v132, v224, v225
    v_mul_f32 v228, v238, v228
    v_mul_f32 v235, v239, v235
    v_cvt_pk_bf16_f32 v133, v226, v227
    v_cvt_pk_bf16_f32 v118, v234, v235
    v_cvt_pk_bf16_f32 v116, v230, v231
    v_cvt_pk_bf16_f32 v134, v228, v229
    v_cvt_pk_bf16_f32 v117, v232, v233
    v_cvt_pk_bf16_f32 v144, v244, v245
    v_cvt_pk_bf16_f32 v145, v246, v247
    v_mfma_f32_16x16x32_bf16 v[196:199], v[116:119], v[128:131], v[76:79]
    v_cvt_pk_bf16_f32 v153, v250, v251
    v_fma_f32 v216, v204, v204, s46
    v_cvt_pk_bf16_f32 v152, v248, v249
    v_fmac_f32 v216, v205, v205
    v_fmac_f32 v216, v206, v206
    v_fmac_f32 v217, v211, v211
    v_fmac_f32 v216, v207, v207
    v_fmac_f32 v217, v212, v212
    v_fmac_f32 v217, v213, v213
    v_fmac_f32 v216, v208, v208
    v_fmac_f32 v216, v209, v209
    v_fmac_f32 v217, v214, v214
    v_fmac_f32 v217, v215, v215
    v_cvt_pk_bf16_f32 v188, v216, v217
    v_exp_f32 v196, v196
    v_exp_f32 v197, v197
    v_mfma_f32_16x16x16_bf16 v[218:221], v[172:173], v[188:189], 0
    v_exp_f32 v198, v198
    v_exp_f32 v199, v199
    v_cvt_pk_bf16_f32 v158, v196, v197
    v_cvt_pk_bf16_f32 v159, v198, v199
    s_nop 1
    v_mfma_f32_16x16x32_bf16 v[244:247], v[140:143], v[156:159], 0
    s_nop 0
    v_rsq_f32 v218, v218
    v_mfma_f32_16x16x32_bf16 v[248:251], v[148:151], v[156:159], 0
    v_mul_f32 v218, s40, v218
    v_rsq_f32 v219, v219
    v_mul_f32 v204, v218, v204
    v_mul_f32 v206, v218, v206
    v_mul_f32 v211, v219, v211
    v_mul_f32 v205, v218, v205
    v_mul_f32 v210, v219, v210
    v_mul_f32 v208, v218, v208
    v_mul_f32 v212, v219, v212
    v_mul_f32 v209, v218, v209
    v_mul_f32 v214, v219, v214
    v_mul_f32 v207, v218, v207
    v_cvt_pk_bf16_f32 v136, v204, v205
    v_mul_f32 v213, v219, v213
    v_cvt_pk_bf16_f32 v120, v210, v211
    v_mul_f32 v215, v219, v215
    v_mfma_f32_16x16x32_bf16 v[216:219], v[124:127], v[128:131], v[100:103]
    v_cvt_pk_bf16_f32 v137, v206, v207
    ds_read_b128 v[204:207], v105
    v_cvt_pk_bf16_f32 v121, v212, v213
    v_cvt_pk_bf16_f32 v138, v208, v209
    v_cvt_pk_bf16_f32 v122, v214, v215
    v_add_u32 v101, s26, v1
    v_mfma_f32_16x16x32_bf16 v[196:199], v[116:119], v[136:139], v[84:87]
    s_nop 0
    v_exp_f32 v216, v216
    v_mfma_f32_16x16x32_bf16 v[200:203], v[120:123], v[128:131], v[88:91]
    v_cvt_pk_bf16_f32 v162, v216, 0
    v_mfma_f32_16x16x32_bf16 v[192:195], v[112:115], v[136:139], v[72:75]
    s_nop 2
    v_exp_f32 v196, v196
    v_exp_f32 v197, v197
    v_exp_f32 v198, v198
    v_exp_f32 v200, v200
    v_exp_f32 v202, v202
    v_exp_f32 v201, v201
    v_exp_f32 v203, v203
    v_cvt_pk_bf16_f32 v160, v200, v201
    v_cvt_pk_bf16_f32 v161, v202, v203
    v_mfma_f32_16x16x32_bf16 v[200:203], v[120:123], v[136:139], v[96:99]
    v_exp_f32 v194, v194
    s_waitcnt lgkmcnt(0)
    v_mfma_f32_16x16x32_bf16 v[228:231], v[204:207], v[116:119], v[106:109]
    v_exp_f32 v192, v192
    v_mfma_f32_16x16x32_bf16 v[236:239], v[204:207], v[124:127], v[106:109]
    v_exp_f32 v195, v195
    v_mfma_f32_16x16x32_bf16 v[224:227], v[204:207], v[112:115], v[106:109]
    v_exp_f32 v193, v193
    v_mfma_f32_16x16x32_bf16 v[232:235], v[204:207], v[120:123], v[106:109]
    v_exp_f32 v202, v202
    v_mfma_f32_16x16x32_bf16 v[244:247], v[144:147], v[160:163], v[244:247]
    v_exp_f32 v200, v200
    v_mfma_f32_16x16x32_bf16 v[248:251], v[152:155], v[160:163], v[248:251]
    v_exp_f32 v201, v201
    v_exp_f32 v199, v199
    v_bfi_b32 v208, v181, v228, v224
    v_mfma_f32_16x16x32_bf16 v[224:227], v[112:115], v[132:135], v[68:71]
    v_bfi_b32 v209, v181, v236, v232
    v_bfi_b32 v208, v182, v209, v208
    v_mfma_f32_16x16x32_bf16 v[232:235], v[120:123], v[132:135], v[92:95]
    v_exp_f32 v208, v208
    v_mfma_f32_16x16x32_bf16 v[228:231], v[116:119], v[132:135], v[80:83]
    v_cvt_pk_bf16_f32 v240, v208, 0
    ds_write_b16 v185, v240
    ds_read2_b64 v[168:171], v186 offset0:8 offset1:12
    ds_read2_b64 v[164:167], v186 offset0:0 offset1:4
    v_mfma_f32_16x16x32_bf16 v[236:239], v[124:127], v[132:135], v[102:105]
    v_rcp_f32 v220, v250
    v_exp_f32 v225, v225
    v_mul_f32 v247, v220, v247
    v_mul_f32 v244, v220, v244
    v_mul_f32 v245, v220, v245
    v_mul_f32 v246, v220, v246
    v_cvt_pk_bf16_f32 v217, v244, v245
    v_cvt_pk_bf16_f32 v218, v246, v247
    ds_write2_b32 v103, v217, v218 offset0:0 offset1:64
    v_mul_f32 v249, v220, v249
    v_mul_f32 v248, v220, v248
    v_cvt_pk_bf16_f32 v219, v248, v249
    ds_write_b32 v103, v219 offset:512
    v_mfma_f32_16x16x32_bf16 v[216:219], v[124:127], v[136:139], v[104:107]
    v_exp_f32 v224, v224
    v_exp_f32 v226, v226
    v_exp_f32 v227, v227
    v_exp_f32 v232, v232
    v_exp_f32 v231, v231
    v_exp_f32 v230, v230
    v_exp_f32 v228, v228
    s_waitcnt lgkmcnt(2)
    v_mfma_f32_16x16x32_bf16 v[204:207], v[140:143], v[164:167], 0
    v_exp_f32 v229, v229
    v_mfma_f32_16x16x32_bf16 v[208:211], v[148:151], v[164:167], 0
    v_exp_f32 v235, v235
    v_mfma_f32_16x16x32_bf16 v[204:207], v[144:147], v[168:171], v[204:207]
    v_exp_f32 v233, v233
    v_mfma_f32_16x16x32_bf16 v[208:211], v[152:155], v[168:171], v[208:211]
    v_exp_f32 v234, v234
    v_exp_f32 v236, v236
    v_cvt_pk_bf16_f32 v166, v228, v229
    v_cvt_pk_bf16_f32 v167, v230, v231
    v_cvt_pk_bf16_f32 v164, v224, v225
    v_cvt_pk_bf16_f32 v165, v226, v227
    v_cvt_pk_bf16_f32 v169, v234, v235
    v_cvt_pk_bf16_f32 v170, v236, 0
    v_rcp_f32 v252, v210
    v_cvt_pk_bf16_f32 v168, v232, v233
    v_mul_f32 v204, v252, v204
    v_mul_f32 v206, v252, v206
    v_mul_f32 v205, v252, v205
    v_mul_f32 v207, v252, v207
    v_mul_f32 v208, v252, v208
    v_cvt_pk_bf16_f32 v253, v204, v205
    v_mul_f32 v209, v252, v209
    v_cvt_pk_bf16_f32 v254, v206, v207
    v_mfma_f32_16x16x32_bf16 v[204:207], v[140:143], v[164:167], 0
    v_cvt_pk_bf16_f32 v255, v208, v209
    s_mov_b64 exec, s[42:43]
    ds_write2_b32 v103, v253, v254 offset0:48 offset1:112
    ds_write_b32 v103, v255 offset:704
    s_mov_b64 exec, -1
    v_mfma_f32_16x16x32_bf16 v[204:207], v[144:147], v[168:171], v[204:207]
    v_exp_f32 v216, v216
    v_mfma_f32_16x16x32_bf16 v[208:211], v[148:151], v[164:167], 0
    v_cvt_pk_bf16_f32 v157, v194, v195
    v_exp_f32 v203, v203
    v_mfma_f32_16x16x32_bf16 v[208:211], v[152:155], v[168:171], v[208:211]
    v_cvt_pk_bf16_f32 v160, v200, v201
    v_cvt_pk_bf16_f32 v158, v196, v197
    v_cvt_pk_bf16_f32 v156, v192, v193
    ds_read_b128 v[192:195], v101 offset:0
    v_cvt_pk_bf16_f32 v159, v198, v199
    ds_read_b128 v[196:199], v101 offset:1024
    v_cvt_pk_bf16_f32 v161, v202, v203
    v_mfma_f32_16x16x32_bf16 v[248:251], v[148:151], v[156:159], 0
    ds_read_b128 v[200:203], v101 offset:2048
    v_mfma_f32_16x16x32_bf16 v[244:247], v[140:143], v[156:159], 0
    v_rcp_f32 v240, v210
    v_cvt_pk_bf16_f32 v162, v216, 0
    v_mul_f32 v204, v240, v204
    v_mul_f32 v208, v240, v208
    v_mfma_f32_16x16x32_bf16 v[248:251], v[152:155], v[160:163], v[248:251]
    v_mul_f32 v206, v240, v206
    v_mul_f32 v205, v240, v205
    v_mfma_f32_16x16x32_bf16 v[244:247], v[144:147], v[160:163], v[244:247]
    v_mul_f32 v209, v240, v209
    v_mul_f32 v207, v240, v207
    v_cvt_pk_bf16_f32 v238, v206, v207
    v_cvt_pk_bf16_f32 v237, v204, v205
    ds_write2_b32 v103, v237, v238 offset0:16 offset1:80
    v_cvt_pk_bf16_f32 v239, v208, v209
    ds_write_b32 v103, v239 offset:576
    v_rcp_f32 v220, v250
    v_add_u32 v105, 64, v105
    v_mul_f32 v245, v220, v245
    s_waitcnt lgkmcnt(4)
    v_mfma_f32_16x16x32_bf16 v[208:211], v[16:19], v[192:195], 0
    v_mul_f32 v246, v220, v246
    v_mul_f32 v248, v220, v248
    s_waitcnt lgkmcnt(3)
    v_mfma_f32_16x16x32_bf16 v[208:211], v[20:23], v[196:199], v[208:211]
    v_mul_f32 v244, v220, v244
    v_mul_f32 v249, v220, v249
    v_mfma_f32_16x16x32_bf16 v[204:207], v[4:7], v[192:195], 0
    v_mul_f32 v247, v220, v247
    v_cvt_pk_bf16_f32 v218, v246, v247
    v_mfma_f32_16x16x32_bf16 v[204:207], v[8:11], v[196:199], v[204:207]
    v_cvt_pk_bf16_f32 v217, v244, v245
    ds_write2_b32 v103, v217, v218 offset0:32 offset1:96
    v_mfma_f32_16x16x32_bf16 v[212:215], v[28:31], v[192:195], 0
    v_cvt_pk_bf16_f32 v219, v248, v249
    ds_write_b32 v103, v219 offset:640
    v_mfma_f32_16x16x32_bf16 v[212:215], v[32:35], v[196:199], v[212:215]
    v_mov_b32_dpp v127, v127 row_ror:4 row_mask:0xf bank_mask:0xf
    v_add_u32 v103, s78, v103
    s_sub_u32 s78, 0, s78
    s_waitcnt lgkmcnt(4)
    v_mfma_f32_16x16x32_bf16 v[208:211], v[24:27], v[200:203], v[208:211]
    v_mfma_f32_16x16x32_bf16 v[212:215], v[36:39], v[200:203], v[212:215]
    v_mfma_f32_16x16x32_bf16 v[204:207], v[12:15], v[200:203], v[204:207]
    s_waitcnt lgkmcnt(0)
    s_barrier
L_M_BODY3_F:
    v_mfma_f32_16x16x32_bf16 v[244:247], v[192:195], v[40:43], 0
    s_add_u32 s26, s26, 9216
    s_cmp_eq_u32 s26, 73728
    v_mfma_f32_16x16x32_bf16 v[248:251], v[192:195], v[52:55], v[176:179]
    ds_read_b128 v[192:195], v101 offset:3072
    v_mfma_f32_16x16x32_bf16 v[244:247], v[196:199], v[44:47], v[244:247]
    s_cselect_b32 s26, 0, s26
    s_add_u32 s24, s24, 1
    v_mfma_f32_16x16x32_bf16 v[248:251], v[196:199], v[56:59], v[248:251]
    ds_read_b128 v[196:199], v101 offset:4096
    v_mfma_f32_16x16x32_bf16 v[244:247], v[200:203], v[48:51], v[244:247]
    v_fma_f32 v217, v210, v210, s46
    v_fma_f32 v216, v204, v204, s46
    v_mfma_f32_16x16x32_bf16 v[248:251], v[200:203], v[60:63], v[248:251]
    ds_read_b128 v[200:203], v101 offset:5120
    v_fmac_f32 v216, v205, v205
    v_fmac_f32 v216, v206, v206
    v_fmac_f32 v216, v207, v207
    v_fmac_f32 v216, v208, v208
    v_cvt_pk_bf16_f32 v141, v246, v247
    v_cvt_pk_bf16_f32 v140, v244, v245
    v_fmac_f32 v216, v209, v209
    v_cvt_pk_bf16_f32 v149, v250, v251
    v_cvt_pk_bf16_f32 v148, v248, v249
    v_fmac_f32 v217, v211, v211
    v_fmac_f32 v217, v212, v212
    v_fmac_f32 v217, v213, v213
    v_fmac_f32 v217, v214, v214
    v_fmac_f32 v217, v215, v215
    v_cvt_pk_bf16_f32 v188, v216, v217
    v_alignbit_b32 v111, v147, v146, 16
    s_nop 0
    v_mfma_f32_16x16x16_bf16 v[218:221], v[172:173], v[188:189], 0
    s_waitcnt lgkmcnt(2)
    v_mfma_f32_16x16x32_bf16 v[224:227], v[4:7], v[192:195], 0
    v_mfma_f32_16x16x32_bf16 v[228:231], v[16:19], v[192:195], 0
    v_mfma_f32_16x16x32_bf16 v[244:247], v[192:195], v[40:43], 0
    v_mfma_f32_16x16x32_bf16 v[232:235], v[28:31], v[192:195], 0
    v_mfma_f32_16x16x32_bf16 v[248:251], v[192:195], v[52:55], v[176:179]
    ds_read_b128 v[192:195], v101 offset:6144
    s_waitcnt lgkmcnt(2)
    v_mfma_f32_16x16x32_bf16 v[224:227], v[8:11], v[196:199], v[224:227]
    v_rsq_f32 v219, v219
    v_mfma_f32_16x16x32_bf16 v[232:235], v[32:35], v[196:199], v[232:235]
    v_rsq_f32 v218, v218
    v_mfma_f32_16x16x32_bf16 v[228:231], v[20:23], v[196:199], v[228:231]
    v_mul_f32 v218, s40, v218
    v_mul_f32 v204, v218, v204
    s_waitcnt lgkmcnt(1)
    v_mfma_f32_16x16x32_bf16 v[224:227], v[12:15], v[200:203], v[224:227]
    v_mul_f32 v210, v219, v210
    v_mul_f32 v212, v219, v212
    v_mfma_f32_16x16x32_bf16 v[232:235], v[36:39], v[200:203], v[232:235]
    v_mul_f32 v205, v218, v205
    v_mul_f32 v211, v219, v211
    v_mfma_f32_16x16x32_bf16 v[244:247], v[196:199], v[44:47], v[244:247]
    v_mul_f32 v206, v218, v206
    v_mul_f32 v213, v219, v213
    v_mfma_f32_16x16x32_bf16 v[244:247], v[200:203], v[48:51], v[244:247]
    v_mul_f32 v207, v218, v207
    v_mul_f32 v214, v219, v214
    v_mfma_f32_16x16x32_bf16 v[248:251], v[196:199], v[56:59], v[248:251]
    ds_read_b128 v[196:199], v101 offset:7168
    v_mfma_f32_16x16x32_bf16 v[248:251], v[200:203], v[60:63], v[248:251]
    v_mul_f32 v215, v219, v215
    v_cvt_pk_bf16_f32 v129, v206, v207
    v_mfma_f32_16x16x32_bf16 v[228:231], v[24:27], v[200:203], v[228:231]
    ds_read_b128 v[200:203], v101 offset:8192
    v_mul_f32 v208, v218, v208
    v_mul_f32 v209, v218, v209
    v_cvt_pk_bf16_f32 v112, v210, v211
    v_cvt_pk_bf16_f32 v128, v204, v205
    s_waitcnt lgkmcnt(2)
    v_mfma_f32_16x16x32_bf16 v[204:207], v[4:7], v[192:195], 0
    v_cvt_pk_bf16_f32 v114, v214, v215
    v_cvt_pk_bf16_f32 v113, v212, v213
    v_mfma_f32_16x16x32_bf16 v[212:215], v[28:31], v[192:195], 0
    v_cvt_pk_bf16_f32 v130, v208, v209
    v_cvt_pk_bf16_f32 v150, v248, v249
    v_mfma_f32_16x16x32_bf16 v[208:211], v[16:19], v[192:195], 0
    v_cvt_pk_bf16_f32 v143, v246, v247
    v_fma_f32 v237, v230, v230, s46
    v_fma_f32 v236, v224, v224, s46
    v_cvt_pk_bf16_f32 v142, v244, v245
    v_mfma_f32_16x16x32_bf16 v[244:247], v[192:195], v[40:43], 0
    v_fmac_f32 v236, v225, v225
    v_fmac_f32 v237, v231, v231
    v_cvt_pk_bf16_f32 v151, v250, v251
    v_mfma_f32_16x16x32_bf16 v[248:251], v[192:195], v[52:55], v[176:179]
    v_fmac_f32 v237, v232, v232
    v_fmac_f32 v237, v233, v233
    v_mfma_f32_16x16x32_bf16 v[192:195], v[112:115], v[128:131], v[64:67]
    v_fmac_f32 v236, v226, v226
    v_fmac_f32 v236, v227, v227
    s_waitcnt lgkmcnt(1)
    v_mfma_f32_16x16x32_bf16 v[208:211], v[20:23], v[196:199], v[208:211]
    v_fmac_f32 v236, v228, v228
    v_fmac_f32 v236, v229, v229
    v_mfma_f32_16x16x32_bf16 v[204:207], v[8:11], v[196:199], v[204:207]
    v_fmac_f32 v237, v234, v234
    v_fmac_f32 v237, v235, v235
    v_mfma_f32_16x16x32_bf16 v[244:247], v[196:199], v[44:47], v[244:247]
    v_cvt_pk_bf16_f32 v190, v236, v237
    v_exp_f32 v192, v192
    s_waitcnt lgkmcnt(0)
    v_mfma_f32_16x16x32_bf16 v[208:211], v[24:27], v[200:203], v[208:211]
    v_exp_f32 v194, v194
    v_mfma_f32_16x16x16_bf16 v[238:241], v[172:173], v[190:191], 0
    v_exp_f32 v193, v193
    v_mfma_f32_16x16x32_bf16 v[204:207], v[12:15], v[200:203], v[204:207]
    v_exp_f32 v195, v195
    v_mfma_f32_16x16x32_bf16 v[212:215], v[32:35], v[196:199], v[212:215]
    v_cvt_pk_bf16_f32 v157, v194, v195
    v_cvt_pk_bf16_f32 v156, v192, v193
    v_mfma_f32_16x16x32_bf16 v[212:215], v[36:39], v[200:203], v[212:215]
    v_fma_f32 v217, v210, v210, s46
    v_rsq_f32 v238, v238
    v_mfma_f32_16x16x32_bf16 v[248:251], v[196:199], v[56:59], v[248:251]
    v_rsq_f32 v239, v239
    v_mfma_f32_16x16x32_bf16 v[248:251], v[200:203], v[60:63], v[248:251]
    v_mul_f32 v238, s40, v238
    v_mul_f32 v224, v238, v224
    v_mfma_f32_16x16x32_bf16 v[244:247], v[200:203], v[48:51], v[244:247]
    v_mul_f32 v231, v239, v231
    v_mul_f32 v225, v238, v225
    v_mul_f32 v230, v239, v230
    v_mul_f32 v232, v239, v232
    v_mul_f32 v227, v238, v227
    v_mul_f32 v234, v239, v234
    v_mul_f32 v226, v238, v226
    v_mul_f32 v229, v238, v229
    v_mul_f32 v233, v239, v233
    v_cvt_pk_bf16_f32 v132, v224, v225
    v_mul_f32 v228, v238, v228
    v_mul_f32 v235, v239, v235
    v_cvt_pk_bf16_f32 v133, v226, v227
    v_cvt_pk_bf16_f32 v118, v234, v235
    v_cvt_pk_bf16_f32 v116, v230, v231
    v_cvt_pk_bf16_f32 v134, v228, v229
    v_cvt_pk_bf16_f32 v117, v232, v233
    v_cvt_pk_bf16_f32 v144, v244, v245
    v_cvt_pk_bf16_f32 v145, v246, v247
    v_mfma_f32_16x16x32_bf16 v[196:199], v[116:119], v[128:131], v[76:79]
    v_cvt_pk_bf16_f32 v153, v250, v251
    v_fma_f32 v216, v204, v204, s46
    v_cvt_pk_bf16_f32 v152, v248, v249
    v_fmac_f32 v216, v205, v205
    v_fmac_f32 v216, v206, v206
    v_fmac_f32 v217, v211, v211
    v_fmac_f32 v216, v207, v207
    v_fmac_f32 v217, v212, v212
    v_fmac_f32 v217, v213, v213
    v_fmac_f32 v216, v208, v208
    v_fmac_f32 v216, v209, v209
    v_fmac_f32 v217, v214, v214
    v_fmac_f32 v217, v215, v215
    v_cvt_pk_bf16_f32 v188, v216, v217
    v_exp_f32 v196, v196
    v_exp_f32 v197, v197
    v_mfma_f32_16x16x16_bf16 v[218:221], v[172:173], v[188:189], 0
    v_exp_f32 v198, v198
    v_exp_f32 v199, v199
    v_cvt_pk_bf16_f32 v158, v196, v197
    v_cvt_pk_bf16_f32 v159, v198, v199
    s_nop 1
    v_mfma_f32_16x16x32_bf16 v[244:247], v[140:143], v[156:159], 0
    s_nop 0
    v_rsq_f32 v218, v218
    v_mfma_f32_16x16x32_bf16 v[248:251], v[148:151], v[156:159], 0
    v_mul_f32 v218, s40, v218
    v_rsq_f32 v219, v219
    v_mul_f32 v204, v218, v204
    v_mul_f32 v206, v218, v206
    v_mul_f32 v211, v219, v211
    v_mul_f32 v205, v218, v205
    v_mul_f32 v210, v219, v210
    v_mul_f32 v208, v218, v208
    v_mul_f32 v212, v219, v212
    v_mul_f32 v209, v218, v209
    v_mul_f32 v214, v219, v214
    v_mul_f32 v207, v218, v207
    v_cvt_pk_bf16_f32 v136, v204, v205
    v_mul_f32 v213, v219, v213
    v_cvt_pk_bf16_f32 v120, v210, v211
    v_mul_f32 v215, v219, v215
    v_mfma_f32_16x16x32_bf16 v[216:219], v[124:127], v[128:131], v[100:103]
    v_cvt_pk_bf16_f32 v137, v206, v207
    ds_read_b128 v[204:207], v105
    v_cvt_pk_bf16_f32 v121, v212, v213
    v_cvt_pk_bf16_f32 v138, v208, v209
    v_cvt_pk_bf16_f32 v122, v214, v215
    v_add_u32 v101, s26, v1
    v_mfma_f32_16x16x32_bf16 v[196:199], v[116:119], v[136:139], v[84:87]
    s_nop 0
    v_exp_f32 v216, v216
    v_mfma_f32_16x16x32_bf16 v[200:203], v[120:123], v[128:131], v[88:91]
    v_cvt_pk_bf16_f32 v162, v216, 0
    v_mfma_f32_16x16x32_bf16 v[192:195], v[112:115], v[136:139], v[72:75]
    s_nop 2
    v_exp_f32 v196, v196
    v_exp_f32 v197, v197
    v_exp_f32 v198, v198
    v_exp_f32 v200, v200
    v_exp_f32 v202, v202
    v_exp_f32 v201, v201
    v_exp_f32 v203, v203
    v_cvt_pk_bf16_f32 v160, v200, v201
    v_cvt_pk_bf16_f32 v161, v202, v203
    v_mfma_f32_16x16x32_bf16 v[200:203], v[120:123], v[136:139], v[96:99]
    v_exp_f32 v194, v194
    s_waitcnt lgkmcnt(0)
    v_mfma_f32_16x16x32_bf16 v[228:231], v[204:207], v[116:119], v[106:109]
    v_exp_f32 v192, v192
    v_mfma_f32_16x16x32_bf16 v[236:239], v[204:207], v[124:127], v[106:109]
    v_exp_f32 v195, v195
    v_mfma_f32_16x16x32_bf16 v[224:227], v[204:207], v[112:115], v[106:109]
    v_exp_f32 v193, v193
    v_mfma_f32_16x16x32_bf16 v[232:235], v[204:207], v[120:123], v[106:109]
    v_exp_f32 v202, v202
    v_mfma_f32_16x16x32_bf16 v[244:247], v[144:147], v[160:163], v[244:247]
    v_exp_f32 v200, v200
    v_mfma_f32_16x16x32_bf16 v[248:251], v[152:155], v[160:163], v[248:251]
    v_exp_f32 v201, v201
    v_exp_f32 v199, v199
    v_bfi_b32 v208, v181, v228, v224
    v_mfma_f32_16x16x32_bf16 v[224:227], v[112:115], v[132:135], v[68:71]
    v_bfi_b32 v209, v181, v236, v232
    v_bfi_b32 v208, v182, v209, v208
    v_mfma_f32_16x16x32_bf16 v[232:235], v[120:123], v[132:135], v[92:95]
    v_exp_f32 v208, v208
    v_mfma_f32_16x16x32_bf16 v[228:231], v[116:119], v[132:135], v[80:83]
    v_cvt_pk_bf16_f32 v240, v208, 0
    ds_write_b16 v185, v240
    ds_read2_b64 v[168:171], v186 offset0:8 offset1:12
    ds_read2_b64 v[164:167], v186 offset0:0 offset1:4
    v_mfma_f32_16x16x32_bf16 v[236:239], v[124:127], v[132:135], v[102:105]
    v_rcp_f32 v220, v250
    v_exp_f32 v225, v225
    v_mul_f32 v247, v220, v247
    v_mul_f32 v244, v220, v244
    v_mul_f32 v245, v220, v245
    v_mul_f32 v246, v220, v246
    v_cvt_pk_bf16_f32 v217, v244, v245
    v_cvt_pk_bf16_f32 v218, v246, v247
    ds_write2_b32 v103, v217, v218 offset0:0 offset1:64
    v_mul_f32 v249, v220, v249
    v_mul_f32 v248, v220, v248
    v_cvt_pk_bf16_f32 v219, v248, v249
    ds_write_b32 v103, v219 offset:512
    v_mfma_f32_16x16x32_bf16 v[216:219], v[124:127], v[136:139], v[104:107]
    v_exp_f32 v224, v224
    v_exp_f32 v226, v226
    v_exp_f32 v227, v227
    v_exp_f32 v232, v232
    v_exp_f32 v231, v231
    v_exp_f32 v230, v230
    v_exp_f32 v228, v228
    s_waitcnt lgkmcnt(2)
    v_mfma_f32_16x16x32_bf16 v[204:207], v[140:143], v[164:167], 0
    v_exp_f32 v229, v229
    v_mfma_f32_16x16x32_bf16 v[208:211], v[148:151], v[164:167], 0
    v_exp_f32 v235, v235
    v_mfma_f32_16x16x32_bf16 v[204:207], v[144:147], v[168:171], v[204:207]
    v_exp_f32 v233, v233
    v_mfma_f32_16x16x32_bf16 v[208:211], v[152:155], v[168:171], v[208:211]
    v_exp_f32 v234, v234
    v_exp_f32 v236, v236
    v_cvt_pk_bf16_f32 v166, v228, v229
    v_cvt_pk_bf16_f32 v167, v230, v231
    v_cvt_pk_bf16_f32 v164, v224, v225
    v_cvt_pk_bf16_f32 v165, v226, v227
    v_cvt_pk_bf16_f32 v169, v234, v235
    v_cvt_pk_bf16_f32 v170, v236, 0
    v_rcp_f32 v252, v210
    v_cvt_pk_bf16_f32 v168, v232, v233
    v_mul_f32 v204, v252, v204
    v_mul_f32 v206, v252, v206
    v_mul_f32 v205, v252, v205
    v_mul_f32 v207, v252, v207
    v_mul_f32 v208, v252, v208
    v_cvt_pk_bf16_f32 v253, v204, v205
    v_mul_f32 v209, v252, v209
    v_cvt_pk_bf16_f32 v254, v206, v207
    v_mfma_f32_16x16x32_bf16 v[204:207], v[140:143], v[164:167], 0
    v_cvt_pk_bf16_f32 v255, v208, v209
    s_mov_b64 exec, s[42:43]
    ds_write2_b32 v103, v253, v254 offset0:48 offset1:112
    ds_write_b32 v103, v255 offset:704
    s_mov_b64 exec, -1
    v_mfma_f32_16x16x32_bf16 v[204:207], v[144:147], v[168:171], v[204:207]
    v_exp_f32 v216, v216
    v_mfma_f32_16x16x32_bf16 v[208:211], v[148:151], v[164:167], 0
    v_cvt_pk_bf16_f32 v157, v194, v195
    v_exp_f32 v203, v203
    v_mfma_f32_16x16x32_bf16 v[208:211], v[152:155], v[168:171], v[208:211]
    v_cvt_pk_bf16_f32 v160, v200, v201
    v_cvt_pk_bf16_f32 v158, v196, v197
    v_cvt_pk_bf16_f32 v156, v192, v193
    ds_read_b128 v[192:195], v101 offset:0
    v_cvt_pk_bf16_f32 v159, v198, v199
    ds_read_b128 v[196:199], v101 offset:1024
    v_cvt_pk_bf16_f32 v161, v202, v203
    v_mfma_f32_16x16x32_bf16 v[248:251], v[148:151], v[156:159], 0
    ds_read_b128 v[200:203], v101 offset:2048
    v_mfma_f32_16x16x32_bf16 v[244:247], v[140:143], v[156:159], 0
    v_rcp_f32 v240, v210
    v_cvt_pk_bf16_f32 v162, v216, 0
    v_mul_f32 v204, v240, v204
    v_mul_f32 v208, v240, v208
    v_mfma_f32_16x16x32_bf16 v[248:251], v[152:155], v[160:163], v[248:251]
    v_mul_f32 v206, v240, v206
    v_mul_f32 v205, v240, v205
    v_mfma_f32_16x16x32_bf16 v[244:247], v[144:147], v[160:163], v[244:247]
    v_mul_f32 v209, v240, v209
    v_mul_f32 v207, v240, v207
    v_cvt_pk_bf16_f32 v238, v206, v207
    v_cvt_pk_bf16_f32 v237, v204, v205
    ds_write2_b32 v103, v237, v238 offset0:16 offset1:80
    v_cvt_pk_bf16_f32 v239, v208, v209
    ds_write_b32 v103, v239 offset:576
    v_rcp_f32 v220, v250
    v_add_u32 v105, 64, v105
    v_mul_f32 v245, v220, v245
    s_waitcnt lgkmcnt(4)
    v_mfma_f32_16x16x32_bf16 v[208:211], v[16:19], v[192:195], 0
    v_mul_f32 v246, v220, v246
    v_mul_f32 v248, v220, v248
    v_mfma_f32_16x16x32_bf16 v[204:207], v[4:7], v[192:195], 0
    v_mul_f32 v244, v220, v244
    v_mul_f32 v249, v220, v249
    v_mfma_f32_16x16x32_bf16 v[212:215], v[28:31], v[192:195], 0
    v_mul_f32 v247, v220, v247
    v_cvt_pk_bf16_f32 v218, v246, v247
    s_waitcnt lgkmcnt(3)
    v_mfma_f32_16x16x32_bf16 v[208:211], v[20:23], v[196:199], v[208:211]
    v_cvt_pk_bf16_f32 v217, v244, v245
    ds_write2_b32 v103, v217, v218 offset0:32 offset1:96
    v_mfma_f32_16x16x32_bf16 v[204:207], v[8:11], v[196:199], v[204:207]
    v_cvt_pk_bf16_f32 v219, v248, v249
    ds_write_b32 v103, v219 offset:640
    s_waitcnt lgkmcnt(4)
    v_mfma_f32_16x16x32_bf16 v[204:207], v[12:15], v[200:203], v[204:207]
    v_mov_b32_dpp v127, v127 row_ror:4 row_mask:0xf bank_mask:0xf
    v_add_u32 v103, s78, v103
    s_sub_u32 s78, 0, s78
    v_mfma_f32_16x16x32_bf16 v[212:215], v[32:35], v[196:199], v[212:215]
    v_mov_b32_dpp v124, v124 quad_perm:[1,2,3,0] row_mask:0xf bank_mask:0xf
    v_mov_b32_dpp v125, v125 quad_perm:[1,2,3,0] row_mask:0xf bank_mask:0xf
    v_mfma_f32_16x16x32_bf16 v[212:215], v[36:39], v[200:203], v[212:215]
    v_alignbit_b32 v147, v146, v147, 16
    v_mov_b32_dpp v126, v126 quad_perm:[1,2,3,0] row_mask:0xf bank_mask:0xf
    v_mfma_f32_16x16x32_bf16 v[208:211], v[24:27], v[200:203], v[208:211]
    v_mov_b32 v146, v111
    v_alignbit_b32 v111, v155, v154, 16
    v_alignbit_b32 v155, v154, v155, 16
    v_mov_b32 v154, v111
    s_cmp_eq_u32 s24, 16
    s_nop 2
    s_cbranch_scc1 L_M_RELOAD_F
L_M_BACK_F:
    s_cmp_lt_u32 s24, s48
    s_cbranch_scc1 L_M_LOOP_F
L_M_EPI:
    s_waitcnt lgkmcnt(0)
    s_barrier
    s_endpgm
L_M_RELOAD_F:
    s_lshl_b32 s71, s20, 11
    s_add_u32 s71, s71, 136704
    v_add_u32 v252, s71, v1
    v_add_u32 v253, s71, v3
    v_mov_b32 v254, v127
    ds_read_b128 v[124:127], v252
    ds_read_b64 v[146:147], v253 offset:1024
    ds_read_b64 v[154:155], v253 offset:1536
    s_waitcnt lgkmcnt(2)
    v_mov_b32 v127, v254
    s_waitcnt lgkmcnt(0)
    s_nop 0
    s_branch L_M_BACK_F
L_O_PRO:
    s_setprio 2
    v_and_b32 v4, 15, v0
    v_lshlrev_b32 v5, 1, v4
    v_lshrrev_b32 v6, 4, v0
    v_lshlrev_b32 v6, 3, v6
    v_lshl_add_u32 v32, v6, 2, v5
    s_lshl_b32 s70, s20, 6
    v_lshlrev_b32 v33, 2, v4
    v_add_u32 v33, s70, v33
    s_mov_b32 s37, 1344
    s_mov_b32 s38, 294912
    s_cmp_eq_u32 s21, 1
    s_cselect_b32 s38, 576, s38
    s_cmp_eq_u32 s21, 2
    s_cselect_b32 s38, 294336, s38
    s_cselect_b32 s37, 686784, s37
    s_cmp_eq_u32 s21, 3
    s_cselect_b32 s38, 0, s38
    s_waitcnt lgkmcnt(0)
    s_mov_b32 s80, s58
    s_and_b32 s81, s59, 0xffff
    s_mov_b32 s82, 8
    s_mov_b32 s83, 0x20000
    s_mov_b32 s84, s60
    s_and_b32 s85, s61, 0xffff
    s_mov_b32 s86, 64
    s_mov_b32 s87, 0x20000
    s_mov_b32 s88, s62
    s_and_b32 s89, s63, 0xffff
    s_mov_b32 s90, 128
    s_mov_b32 s91, 0x20000
    s_mov_b32 s92, s64
    s_and_b32 s93, s65, 0xffff
    s_mov_b32 s94, 676
    s_mov_b32 s95, 0x20000
    buffer_load_ushort v7, v5, s[80:83], 0 offen
    buffer_load_dwordx2 v[12:13], v6, s[84:87], 0 offen
    buffer_load_dwordx2 v[14:15], v6, s[84:87], 0 offen offset:32
    buffer_load_ushort v8, v32, s[88:91], 0 offen offset:0
    buffer_load_ushort v9, v32, s[88:91], 0 offen offset:8
    buffer_load_ushort v10, v32, s[88:91], 0 offen offset:16
    buffer_load_ushort v11, v32, s[88:91], 0 offen offset:24
    buffer_load_dword v16, v33, s[92:95], 0 offen offset:0
    buffer_load_dword v17, v33, s[92:95], 0 offen offset:256
    buffer_load_dword v18, v33, s[92:95], 0 offen offset:512
    s_lshl_b32 s71, s21, 2
    s_add_u32 s71, s71, s20
    s_lshl_b32 s71, s71, 10
    s_add_u32 s72, s71, 38912
    buffer_load_dwordx4 v[140:143], v1, s[16:19], s72 offen offset:0
    s_add_u32 s71, s71, 22528
    buffer_load_dwordx4 v[136:139], v1, s[16:19], s71 offen offset:0
    s_sub_u32 s12, s16, L_TABLE-standalone__window_attn_swin_v2__vision_kernel
    s_subb_u32 s13, s17, 0
    s_mov_b32 s14, L_USED_END-standalone__window_attn_swin_v2__vision_kernel
    s_mov_b32 s15, 0x20000
    s_lshl_b32 s70, s20, 10
    s_mov_b32 m0, 155136
    s_nop 0
    buffer_load_dwordx4 v1, s[12:15], s70 offen lds
    s_add_u32 s70, s70, 4096
    buffer_load_dwordx4 v1, s[12:15], s70 offen lds
    s_add_u32 s70, s70, 4096
    buffer_load_dwordx4 v1, s[12:15], s70 offen lds
    s_add_u32 s70, s70, 4096
    buffer_load_dwordx4 v1, s[12:15], s70 offen lds
    s_add_u32 s70, s70, 4096
    buffer_load_dwordx4 v1, s[12:15], s70 offen lds
    s_add_u32 s70, s70, 4096
    buffer_load_dwordx4 v1, s[12:15], s70 offen lds
    s_waitcnt vmcnt(16)
    v_lshlrev_b32 v20, 16, v12
    v_and_b32 v21, 0xffff0000, v12
    v_lshlrev_b32 v22, 16, v13
    v_and_b32 v23, 0xffff0000, v13
    s_waitcnt vmcnt(10)
    v_lshlrev_b32 v170, 16, v16
    s_waitcnt vmcnt(9)
    v_lshlrev_b32 v186, 16, v17
    s_waitcnt vmcnt(8)
    v_lshlrev_b32 v202, 16, v18
    v_lshlrev_b32 v24, 16, v14
    v_and_b32 v25, 0xffff0000, v14
    v_lshlrev_b32 v26, 16, v15
    v_and_b32 v27, 0xffff0000, v15
    v_and_b32 v171, 0xffff0000, v16
    v_mul_f32 v172, v170, v20
    v_mul_f32 v173, v170, v21
    v_mul_f32 v174, v170, v22
    v_mul_f32 v175, v170, v23
    v_and_b32 v187, 0xffff0000, v17
    v_mul_f32 v188, v186, v20
    v_mul_f32 v189, v186, v21
    v_mul_f32 v190, v186, v22
    v_mul_f32 v191, v186, v23
    v_and_b32 v203, 0xffff0000, v18
    v_mul_f32 v204, v202, v20
    v_mul_f32 v205, v202, v21
    v_mul_f32 v206, v202, v22
    v_mul_f32 v207, v202, v23
    v_fmac_f32 v172, v171, v24
    v_fmac_f32 v173, v171, v25
    v_fmac_f32 v174, v171, v26
    v_fmac_f32 v175, v171, v27
    v_fmac_f32 v188, v187, v24
    v_fmac_f32 v189, v187, v25
    v_fmac_f32 v190, v187, v26
    v_fmac_f32 v191, v187, v27
    v_fmac_f32 v204, v203, v24
    v_fmac_f32 v205, v203, v25
    v_fmac_f32 v206, v203, v26
    v_fmac_f32 v207, v203, v27
    v_max_f32 v172, 0, v172
    v_max_f32 v173, 0, v173
    v_max_f32 v174, 0, v174
    v_max_f32 v175, 0, v175
    v_max_f32 v188, 0, v188
    v_max_f32 v189, 0, v189
    v_max_f32 v190, 0, v190
    v_max_f32 v191, 0, v191
    v_max_f32 v204, 0, v204
    v_max_f32 v205, 0, v205
    v_max_f32 v206, 0, v206
    v_max_f32 v207, 0, v207
    v_lshl_or_b32 v28, v9, 16, v8
    v_lshl_or_b32 v29, v11, 16, v10
    v_cvt_pk_bf16_f32 v168, v172, v173
    v_cvt_pk_bf16_f32 v169, v174, v175
    v_cvt_pk_bf16_f32 v184, v188, v189
    v_cvt_pk_bf16_f32 v185, v190, v191
    v_cvt_pk_bf16_f32 v200, v204, v205
    v_cvt_pk_bf16_f32 v201, v206, v207
    v_mfma_f32_16x16x16_bf16 v[164:167], v[168:169], v[28:29], 0
    v_lshlrev_b32 v7, 16, v7
    v_lshrrev_b32 v31, 4, v0
    v_mfma_f32_16x16x16_bf16 v[180:183], v[184:185], v[28:29], 0
    v_min_f32 v7, 0x40930000, v7
    v_lshlrev_b32 v31, 4, v31
    v_mfma_f32_16x16x16_bf16 v[196:199], v[200:201], v[28:29], 0
    v_max_f32 v7, 0xc2c80000, v7
    v_lshl_add_u32 v30, v4, 10, v31
    v_cvt_pk_bf16_f32 v176, v164, v165
    v_cvt_pk_bf16_f32 v177, v166, v167
    v_lshlrev_b32 v164, 16, v176
    v_cvt_pk_bf16_f32 v192, v180, v181
    v_cvt_pk_bf16_f32 v193, v182, v183
    v_and_b32 v165, 0xffff0000, v176
    v_cvt_pk_bf16_f32 v208, v196, v197
    v_cvt_pk_bf16_f32 v209, v198, v199
    v_lshlrev_b32 v166, 16, v177
    v_and_b32 v167, 0xffff0000, v177
    v_lshlrev_b32 v180, 16, v192
    v_and_b32 v181, 0xffff0000, v192
    v_lshlrev_b32 v182, 16, v193
    v_and_b32 v183, 0xffff0000, v193
    v_lshlrev_b32 v196, 16, v208
    v_and_b32 v197, 0xffff0000, v208
    v_lshlrev_b32 v198, 16, v209
    v_and_b32 v199, 0xffff0000, v209
    v_mul_f32 v164, 0xbfb8aa3b, v164
    v_mul_f32 v165, 0xbfb8aa3b, v165
    v_mul_f32 v166, 0xbfb8aa3b, v166
    v_mul_f32 v167, 0xbfb8aa3b, v167
    v_mul_f32 v180, 0xbfb8aa3b, v180
    v_mul_f32 v181, 0xbfb8aa3b, v181
    v_mul_f32 v182, 0xbfb8aa3b, v182
    v_mul_f32 v183, 0xbfb8aa3b, v183
    v_mul_f32 v196, 0xbfb8aa3b, v196
    v_mul_f32 v197, 0xbfb8aa3b, v197
    v_mul_f32 v198, 0xbfb8aa3b, v198
    v_mul_f32 v199, 0xbfb8aa3b, v199
    v_mul_f32 v7, 0x3fb8aa3b, v7
    v_exp_f32 v164, v164
    v_exp_f32 v165, v165
    v_exp_f32 v166, v166
    v_exp_f32 v167, v167
    v_exp_f32 v180, v180
    v_exp_f32 v181, v181
    v_exp_f32 v182, v182
    v_exp_f32 v183, v183
    v_exp_f32 v196, v196
    v_exp_f32 v197, v197
    v_exp_f32 v198, v198
    v_exp_f32 v199, v199
    v_exp_f32 v7, v7
    v_add_f32 v164, 1.0, v164
    v_add_f32 v165, 1.0, v165
    v_add_f32 v166, 1.0, v166
    v_add_f32 v167, 1.0, v167
    v_add_f32 v180, 1.0, v180
    v_add_f32 v181, 1.0, v181
    v_add_f32 v182, 1.0, v182
    v_add_f32 v183, 1.0, v183
    v_add_f32 v196, 1.0, v196
    v_add_f32 v197, 1.0, v197
    v_add_f32 v198, 1.0, v198
    v_add_f32 v199, 1.0, v199
    v_cvt_pk_bf16_f32 v7, v7, v7
    v_rcp_f32 v164, v164
    v_rcp_f32 v165, v165
    v_rcp_f32 v166, v166
    v_rcp_f32 v167, v167
    v_rcp_f32 v180, v180
    v_rcp_f32 v181, v181
    v_rcp_f32 v182, v182
    v_rcp_f32 v183, v183
    v_rcp_f32 v196, v196
    v_rcp_f32 v197, v197
    v_rcp_f32 v198, v198
    v_rcp_f32 v199, v199
    v_lshlrev_b32 v7, 16, v7
    v_cvt_pk_bf16_f32 v176, v164, v165
    v_mul_f32 v7, 0x3fb8aa3b, v7
    v_cvt_pk_bf16_f32 v177, v166, v167
    v_cvt_pk_bf16_f32 v192, v180, v181
    v_cvt_pk_bf16_f32 v193, v182, v183
    v_cvt_pk_bf16_f32 v208, v196, v197
    v_cvt_pk_bf16_f32 v209, v198, v199
    v_add_f32 v19, 0xc18755c5, v7
    s_lshl_b32 s73, s20, 6
    v_lshlrev_b32 v164, 16, v176
    v_and_b32 v165, 0xffff0000, v176
    v_lshlrev_b32 v166, 16, v177
    v_and_b32 v167, 0xffff0000, v177
    v_lshlrev_b32 v180, 16, v192
    v_and_b32 v181, 0xffff0000, v192
    v_lshlrev_b32 v182, 16, v193
    v_and_b32 v183, 0xffff0000, v193
    v_lshlrev_b32 v196, 16, v208
    v_and_b32 v197, 0xffff0000, v208
    v_lshlrev_b32 v198, 16, v209
    v_and_b32 v199, 0xffff0000, v209
    s_add_u32 s73, s73, 144896
    s_mov_b32 s74, 0x41b8aa3b
    v_add_u32 v30, s73, v30
    v_fma_f32 v164, v164, s74, -v19
    v_fma_f32 v165, v165, s74, -v19
    v_fma_f32 v166, v166, s74, -v19
    v_fma_f32 v167, v167, s74, -v19
    v_fma_f32 v180, v180, s74, -v19
    v_fma_f32 v181, v181, s74, -v19
    v_fma_f32 v182, v182, s74, -v19
    v_fma_f32 v183, v183, s74, -v19
    v_fma_f32 v196, v196, s74, -v19
    v_fma_f32 v197, v197, s74, -v19
    v_fma_f32 v198, v198, s74, -v19
    v_fma_f32 v199, v199, s74, -v19
    s_mov_b32 s78, 0x000f000f
    s_mov_b32 s79, 0x000f000f
    s_mov_b64 exec, s[78:79]
    ds_write_b128 v30, v[164:167] offset:0
    s_mov_b64 exec, -1
    s_mov_b64 exec, s[78:79]
    ds_write_b128 v30, v[180:183] offset:256
    s_mov_b64 exec, -1
    s_mov_b64 exec, s[78:79]
    ds_write_b128 v30, v[196:199] offset:512
    s_mov_b64 exec, -1
    s_waitcnt vmcnt(7)
    v_mov_b32 v145, v142
    v_mov_b32 v160, 0xbc2bbc2b
    v_mov_b32 v161, 0xbc2bbc2b
    v_mov_b32 v162, 0xbc2bbc2b
    v_mov_b32 v163, 0xbc2bbc2b
    v_mov_b32 v131, 0
    s_waitcnt lgkmcnt(0)
    s_barrier
    s_mov_b32 s77, 18432
    s_mov_b32 s12, s56
    s_and_b32 s13, s57, 0xffff
    s_mov_b32 s14, 18432
    s_mov_b32 s15, 0x20000
    s_mul_i32 s70, s20, 4
    s_min_u32 s71, s20, 2
    s_add_u32 s70, s70, s71
    s_lshl_b32 s70, s70, 10
    s_add_u32 s71, s70, 82944
    s_mov_b32 m0, s71
    s_nop 0
    buffer_load_dwordx4 v1, s[12:15], s70 offen offset:0 lds
    buffer_load_dwordx4 v1, s[12:15], s70 offen offset:1024 lds
    buffer_load_dwordx4 v1, s[12:15], s70 offen offset:2048 lds
    buffer_load_dwordx4 v1, s[12:15], s70 offen offset:3072 lds
    s_add_u32 s70, s70, 4096
    s_add_u32 s71, s71, 4096
    s_cmp_lt_u32 s20, 2
    s_cselect_b32 s71, s71, 155136
    s_cselect_b32 s70, s70, 0x7f000000
    s_mov_b32 m0, s71
    s_nop 0
    buffer_load_dwordx4 v1, s[12:15], s70 offen lds
    buffer_load_dwordx4 v[148:151], v1, s[16:19], s77 offen offset:0
    buffer_load_dwordx4 v[152:155], v1, s[16:19], s77 offen offset:1024
    buffer_load_dwordx4 v[156:159], v1, s[16:19], s77 offen offset:2048
    buffer_load_dwordx4 v[132:135], v1, s[16:19], s77 offen offset:3072
    s_mov_b32 s47, 0x397ba882
    s_mov_b32 s48, 0x411cc471
    s_lshl_b32 s70, s20, 4
    s_mov_b64 s[44:45], 0xffff
    s_lshl_b64 s[44:45], s[44:45], s70
    s_mul_hi_u32 s71, s22, 59652324
    s_mul_i32 s72, s71, 72
    s_sub_u32 s72, s22, s72
    s_sub_u32 s35, 72, s72
    s_mul_i32 s71, s71, 686784
    s_mul_i32 s72, s72, s37
    s_add_u32 s34, s71, s72
    s_add_u32 s34, s34, s38
    s_mov_b32 s39, 590016
    s_mov_b32 s36, 0
    s_mov_b32 s40, s35
    s_mov_b32 s41, s34
    s_cmp_lt_u32 s36, s23
    s_cselect_b32 s75, s34, 0x7f000000
    s_add_u32 s36, s36, 1
    s_add_u32 s34, s34, s37
    s_sub_u32 s35, s35, 1
    s_cmp_eq_u32 s35, 0
    s_cselect_b32 s70, s39, 0
    s_cselect_b32 s35, 72, s35
    s_add_u32 s34, s34, s70
    s_cmp_lt_u32 s36, s23
    s_cselect_b32 s75, s34, 0x7f000000
    s_add_u32 s36, s36, 1
    s_add_u32 s34, s34, s37
    s_sub_u32 s35, s35, 1
    s_cmp_eq_u32 s35, 0
    s_cselect_b32 s70, s39, 0
    s_cselect_b32 s35, 72, s35
    s_add_u32 s34, s34, s70
    s_cmp_lt_u32 s36, s23
    s_cselect_b32 s76, s34, 0x7f000000
    s_add_u32 s36, s36, 1
    s_add_u32 s34, s34, s37
    s_sub_u32 s35, s35, 1
    s_cmp_eq_u32 s35, 0
    s_cselect_b32 s70, s39, 0
    s_cselect_b32 s35, 72, s35
    s_add_u32 s34, s34, s70
    s_mov_b32 s4, s52
    s_and_b32 s5, s53, 0xffff
    s_mov_b32 s6, 50135232
    s_mov_b32 s7, 0x20000
    s_mov_b32 s8, s68
    s_and_b32 s9, s69, 0xffff
    s_mov_b32 s10, 50135232
    s_mov_b32 s11, 0x20000
    s_mov_b32 s26, 18432
    s_lshl_b32 s73, s20, 10
    s_add_u32 s73, s73, s26
    s_mov_b32 m0, s73
    s_waitcnt vmcnt(15)
    buffer_load_dwordx4 v136, s[4:7], s76 offen lds
    s_add_u32 s73, s73, 4096
    s_mov_b32 m0, s73
    s_nop 0
    buffer_load_dwordx4 v137, s[4:7], s76 offen lds
    s_add_u32 s73, s26, 8192
    s_mov_b32 m0, s73
    s_mov_b64 exec, s[44:45]
    buffer_load_dwordx4 v138, s[4:7], s76 offen lds
    s_mov_b64 exec, -1
    s_setprio 0
    s_waitcnt vmcnt(3)
    s_barrier
    s_cmp_lt_u32 s36, s23
    s_cselect_b32 s75, s34, 0x7f000000
    s_add_u32 s36, s36, 1
    s_add_u32 s34, s34, s37
    s_sub_u32 s35, s35, 1
    s_cmp_eq_u32 s35, 0
    s_cselect_b32 s70, s39, 0
    s_cselect_b32 s35, 72, s35
    s_add_u32 s34, s34, s70
    s_mov_b32 s26, 27648
    s_lshl_b32 s73, s20, 10
    s_add_u32 s73, s73, s26
    s_mov_b32 m0, s73
    s_nop 0
    buffer_load_dwordx4 v136, s[4:7], s75 offen lds
    s_add_u32 s73, s73, 4096
    s_mov_b32 m0, s73
    s_nop 0
    buffer_load_dwordx4 v137, s[4:7], s75 offen lds
    s_add_u32 s73, s26, 8192
    s_mov_b32 m0, s73
    s_mov_b64 exec, s[44:45]
    buffer_load_dwordx4 v138, s[4:7], s75 offen lds
    s_mov_b64 exec, -1
    s_cmp_lt_u32 s36, s23
    s_cselect_b32 s75, s34, 0x7f000000
    s_add_u32 s36, s36, 1
    s_add_u32 s34, s34, s37
    s_sub_u32 s35, s35, 1
    s_cmp_eq_u32 s35, 0
    s_cselect_b32 s70, s39, 0
    s_cselect_b32 s35, 72, s35
    s_add_u32 s34, s34, s70
    s_mov_b32 s26, 36864
    s_lshl_b32 s73, s20, 10
    s_add_u32 s73, s73, s26
    s_mov_b32 m0, s73
    s_nop 0
    buffer_load_dwordx4 v136, s[4:7], s75 offen lds
    s_add_u32 s73, s73, 4096
    s_mov_b32 m0, s73
    s_nop 0
    buffer_load_dwordx4 v137, s[4:7], s75 offen lds
    s_add_u32 s73, s26, 8192
    s_mov_b32 m0, s73
    s_mov_b64 exec, s[44:45]
    buffer_load_dwordx4 v138, s[4:7], s75 offen lds
    s_mov_b64 exec, -1
    s_cmp_lt_u32 s36, s23
    s_cselect_b32 s75, s34, 0x7f000000
    s_add_u32 s36, s36, 1
    s_add_u32 s34, s34, s37
    s_sub_u32 s35, s35, 1
    s_cmp_eq_u32 s35, 0
    s_cselect_b32 s70, s39, 0
    s_cselect_b32 s35, 72, s35
    s_add_u32 s34, s34, s70
    s_mov_b32 s26, 46080
    s_lshl_b32 s73, s20, 10
    s_add_u32 s73, s73, s26
    s_mov_b32 m0, s73
    s_nop 0
    buffer_load_dwordx4 v136, s[4:7], s75 offen lds
    s_add_u32 s73, s73, 4096
    s_mov_b32 m0, s73
    s_nop 0
    buffer_load_dwordx4 v137, s[4:7], s75 offen lds
    s_add_u32 s73, s26, 8192
    s_mov_b32 m0, s73
    s_mov_b64 exec, s[44:45]
    buffer_load_dwordx4 v138, s[4:7], s75 offen lds
    s_mov_b64 exec, -1
    s_cmp_lt_u32 s36, s23
    s_cselect_b32 s75, s34, 0x7f000000
    s_add_u32 s36, s36, 1
    s_add_u32 s34, s34, s37
    s_sub_u32 s35, s35, 1
    s_cmp_eq_u32 s35, 0
    s_cselect_b32 s70, s39, 0
    s_cselect_b32 s35, 72, s35
    s_add_u32 s34, s34, s70
    s_mov_b32 s26, 55296
    s_lshl_b32 s73, s20, 10
    s_add_u32 s73, s73, s26
    s_mov_b32 m0, s73
    s_nop 0
    buffer_load_dwordx4 v136, s[4:7], s75 offen lds
    s_add_u32 s73, s73, 4096
    s_mov_b32 m0, s73
    s_nop 0
    buffer_load_dwordx4 v137, s[4:7], s75 offen lds
    s_add_u32 s73, s26, 8192
    s_mov_b32 m0, s73
    s_mov_b64 exec, s[44:45]
    buffer_load_dwordx4 v138, s[4:7], s75 offen lds
    s_mov_b64 exec, -1
    s_cmp_lt_u32 s36, s23
    s_cselect_b32 s75, s34, 0x7f000000
    s_add_u32 s36, s36, 1
    s_add_u32 s34, s34, s37
    s_sub_u32 s35, s35, 1
    s_cmp_eq_u32 s35, 0
    s_cselect_b32 s70, s39, 0
    s_cselect_b32 s35, 72, s35
    s_add_u32 s34, s34, s70
    s_mov_b32 s26, 64512
    s_lshl_b32 s73, s20, 10
    s_add_u32 s73, s73, s26
    s_mov_b32 m0, s73
    s_nop 0
    buffer_load_dwordx4 v136, s[4:7], s75 offen lds
    s_add_u32 s73, s73, 4096
    s_mov_b32 m0, s73
    s_nop 0
    buffer_load_dwordx4 v137, s[4:7], s75 offen lds
    s_add_u32 s73, s26, 8192
    s_mov_b32 m0, s73
    s_mov_b64 exec, s[44:45]
    buffer_load_dwordx4 v138, s[4:7], s75 offen lds
    s_mov_b64 exec, -1
    ds_read_b128 v[100:103], v132 offset:0
    ds_read_b128 v[112:115], v133 offset:0
    ds_read_b128 v[104:107], v132 offset:64
    ds_read_b128 v[116:119], v133 offset:64
    ds_read_b128 v[108:111], v132 offset:128
    ds_read_b128 v[120:123], v133 offset:128
    s_mov_b32 s46, 0
    s_mov_b32 s31, s41
    s_cmp_lt_u32 s46, s23
    s_cselect_b32 s30, s31, 0x7f000000
    s_add_u32 s46, s46, 1
    s_mov_b32 s32, s40
    s_add_u32 s31, s31, s37
    s_sub_u32 s32, s32, 1
    s_cmp_eq_u32 s32, 0
    s_cselect_b32 s71, s39, 0
    s_cselect_b32 s32, 72, s32
    s_mov_b32 s24, 1
    s_mov_b32 s27, 0
    s_mov_b32 s29, 101376
    s_mov_b32 s33, 0x7f000000
    s_add_u32 s31, s31, s71
    s_waitcnt lgkmcnt(5)
    v_mfma_f32_16x16x32_bf16 v[76:79], v[100:103], v[160:163], 0
    s_waitcnt lgkmcnt(4)
    v_mfma_f32_16x16x32_bf16 v[80:83], v[112:115], v[160:163], 0
    s_waitcnt lgkmcnt(3)
    v_mfma_f32_16x16x32_bf16 v[76:79], v[104:107], v[160:163], v[76:79]
    s_waitcnt lgkmcnt(2)
    v_mfma_f32_16x16x32_bf16 v[80:83], v[116:119], v[160:163], v[80:83]
    s_waitcnt lgkmcnt(1)
    v_mfma_f32_16x16x32_bf16 v[76:79], v[108:111], v[160:163], v[76:79]
    s_waitcnt lgkmcnt(0)
    v_mfma_f32_16x16x32_bf16 v[80:83], v[120:123], v[160:163], v[80:83]
    v_mfma_f32_16x16x32_bf16 v[88:91], v[100:103], v[148:151], v[76:79]
    v_mfma_f32_16x16x32_bf16 v[92:95], v[112:115], v[148:151], v[80:83]
    v_mfma_f32_16x16x32_bf16 v[96:99], v[100:103], v[152:155], v[76:79]
    ds_read_b128 v[100:103], v158 offset:0
    v_mfma_f32_16x16x32_bf16 v[84:87], v[112:115], v[152:155], v[80:83]
    ds_read_b128 v[112:115], v159 offset:0
    s_nop 2
    v_cvt_pk_bf16_f32 v52, v88, v89
    v_cvt_pk_bf16_f32 v53, v90, v91
    v_cvt_pk_bf16_f32 v54, v92, v93
    v_cvt_pk_bf16_f32 v55, v94, v95
    v_cvt_pk_bf16_f32 v56, v96, v97
    v_cvt_pk_bf16_f32 v57, v98, v99
    v_cvt_pk_bf16_f32 v58, v84, v85
    v_cvt_pk_bf16_f32 v59, v86, v87
    v_mfma_f32_16x16x32_bf16 v[88:91], v[104:107], v[148:151], v[76:79]
    v_mfma_f32_16x16x32_bf16 v[92:95], v[116:119], v[148:151], v[80:83]
    v_mfma_f32_16x16x32_bf16 v[96:99], v[104:107], v[152:155], v[76:79]
    ds_read_b128 v[104:107], v158 offset:64
    v_mfma_f32_16x16x32_bf16 v[84:87], v[116:119], v[152:155], v[80:83]
    ds_read_b128 v[116:119], v159 offset:64
    s_nop 2
    v_cvt_pk_bf16_f32 v60, v88, v89
    v_cvt_pk_bf16_f32 v61, v90, v91
    v_cvt_pk_bf16_f32 v62, v92, v93
    v_cvt_pk_bf16_f32 v63, v94, v95
    v_cvt_pk_bf16_f32 v64, v96, v97
    v_cvt_pk_bf16_f32 v65, v98, v99
    v_cvt_pk_bf16_f32 v66, v84, v85
    v_cvt_pk_bf16_f32 v67, v86, v87
    v_mfma_f32_16x16x32_bf16 v[88:91], v[108:111], v[148:151], v[76:79]
    v_mfma_f32_16x16x32_bf16 v[92:95], v[120:123], v[148:151], v[80:83]
    v_mfma_f32_16x16x32_bf16 v[96:99], v[108:111], v[152:155], v[76:79]
    ds_read_b128 v[108:111], v158 offset:128
    v_mfma_f32_16x16x32_bf16 v[84:87], v[120:123], v[152:155], v[80:83]
    ds_read_b128 v[120:123], v159 offset:128
    s_waitcnt lgkmcnt(5)
    v_mfma_f32_16x16x32_bf16 v[76:79], v[100:103], v[160:163], 0
    s_waitcnt lgkmcnt(4)
    v_mfma_f32_16x16x32_bf16 v[80:83], v[112:115], v[160:163], 0
    v_cvt_pk_bf16_f32 v68, v88, v89
    s_waitcnt lgkmcnt(3)
    v_mfma_f32_16x16x32_bf16 v[76:79], v[104:107], v[160:163], v[76:79]
    v_cvt_pk_bf16_f32 v69, v90, v91
    v_cvt_pk_bf16_f32 v70, v92, v93
    s_waitcnt lgkmcnt(2)
    v_mfma_f32_16x16x32_bf16 v[80:83], v[116:119], v[160:163], v[80:83]
    v_cvt_pk_bf16_f32 v71, v94, v95
    v_cvt_pk_bf16_f32 v72, v96, v97
    v_cvt_pk_bf16_f32 v73, v98, v99
    v_cvt_pk_bf16_f32 v74, v84, v85
    v_cvt_pk_bf16_f32 v75, v86, v87
    s_waitcnt lgkmcnt(1)
    v_mfma_f32_16x16x32_bf16 v[76:79], v[108:111], v[160:163], v[76:79]
    s_waitcnt lgkmcnt(0)
    v_mfma_f32_16x16x32_bf16 v[80:83], v[120:123], v[160:163], v[80:83]
    v_mfma_f32_16x16x32_bf16 v[88:91], v[100:103], v[148:151], v[76:79]
    v_mfma_f32_16x16x32_bf16 v[92:95], v[112:115], v[148:151], v[80:83]
    v_mfma_f32_16x16x32_bf16 v[96:99], v[100:103], v[152:155], v[76:79]
    ds_read_b128 v[100:103], v156 offset:0
    v_mfma_f32_16x16x32_bf16 v[84:87], v[112:115], v[152:155], v[80:83]
    ds_read_b128 v[112:115], v157 offset:0
    s_nop 2
    v_cvt_pk_bf16_f32 v28, v88, v89
    v_cvt_pk_bf16_f32 v29, v90, v91
    v_cvt_pk_bf16_f32 v30, v92, v93
    v_cvt_pk_bf16_f32 v31, v94, v95
    v_cvt_pk_bf16_f32 v32, v96, v97
    v_cvt_pk_bf16_f32 v33, v98, v99
    v_cvt_pk_bf16_f32 v34, v84, v85
    v_cvt_pk_bf16_f32 v35, v86, v87
    v_mfma_f32_16x16x32_bf16 v[88:91], v[104:107], v[148:151], v[76:79]
    v_mfma_f32_16x16x32_bf16 v[92:95], v[116:119], v[148:151], v[80:83]
    v_mfma_f32_16x16x32_bf16 v[96:99], v[104:107], v[152:155], v[76:79]
    ds_read_b128 v[104:107], v156 offset:64
    v_mfma_f32_16x16x32_bf16 v[84:87], v[116:119], v[152:155], v[80:83]
    ds_read_b128 v[116:119], v157 offset:64
    s_nop 2
    v_cvt_pk_bf16_f32 v36, v88, v89
    v_cvt_pk_bf16_f32 v37, v90, v91
    v_cvt_pk_bf16_f32 v38, v92, v93
    v_cvt_pk_bf16_f32 v39, v94, v95
    v_cvt_pk_bf16_f32 v40, v96, v97
    v_cvt_pk_bf16_f32 v41, v98, v99
    v_cvt_pk_bf16_f32 v42, v84, v85
    v_cvt_pk_bf16_f32 v43, v86, v87
    v_mfma_f32_16x16x32_bf16 v[88:91], v[108:111], v[148:151], v[76:79]
    v_mfma_f32_16x16x32_bf16 v[92:95], v[120:123], v[148:151], v[80:83]
    v_mfma_f32_16x16x32_bf16 v[96:99], v[108:111], v[152:155], v[76:79]
    ds_read_b128 v[108:111], v156 offset:128
    v_mfma_f32_16x16x32_bf16 v[84:87], v[120:123], v[152:155], v[80:83]
    ds_read_b128 v[120:123], v157 offset:128
    s_waitcnt lgkmcnt(5)
    v_mfma_f32_16x16x32_bf16 v[76:79], v[100:103], v[160:163], 0
    s_waitcnt lgkmcnt(4)
    v_mfma_f32_16x16x32_bf16 v[80:83], v[112:115], v[160:163], 0
    v_cvt_pk_bf16_f32 v44, v88, v89
    s_waitcnt lgkmcnt(3)
    v_mfma_f32_16x16x32_bf16 v[76:79], v[104:107], v[160:163], v[76:79]
    v_cvt_pk_bf16_f32 v45, v90, v91
    v_cvt_pk_bf16_f32 v46, v92, v93
    s_waitcnt lgkmcnt(2)
    v_mfma_f32_16x16x32_bf16 v[80:83], v[116:119], v[160:163], v[80:83]
    v_cvt_pk_bf16_f32 v47, v94, v95
    v_cvt_pk_bf16_f32 v48, v96, v97
    v_cvt_pk_bf16_f32 v49, v98, v99
    v_cvt_pk_bf16_f32 v50, v84, v85
    v_cvt_pk_bf16_f32 v51, v86, v87
    s_waitcnt lgkmcnt(1)
    v_mfma_f32_16x16x32_bf16 v[76:79], v[108:111], v[160:163], v[76:79]
    s_waitcnt lgkmcnt(0)
    v_mfma_f32_16x16x32_bf16 v[80:83], v[120:123], v[160:163], v[80:83]
    v_mfma_f32_16x16x32_bf16 v[88:91], v[100:103], v[148:151], v[76:79]
    v_mfma_f32_16x16x32_bf16 v[92:95], v[112:115], v[148:151], v[80:83]
    v_mfma_f32_16x16x32_bf16 v[96:99], v[100:103], v[152:155], v[76:79]
    v_mfma_f32_16x16x32_bf16 v[84:87], v[112:115], v[152:155], v[80:83]
    s_nop 4
    v_cvt_pk_bf16_f32 v4, v88, v89
    v_cvt_pk_bf16_f32 v5, v90, v91
    v_cvt_pk_bf16_f32 v6, v92, v93
    v_cvt_pk_bf16_f32 v7, v94, v95
    v_cvt_pk_bf16_f32 v8, v96, v97
    v_cvt_pk_bf16_f32 v9, v98, v99
    v_cvt_pk_bf16_f32 v10, v84, v85
    v_cvt_pk_bf16_f32 v11, v86, v87
    v_mfma_f32_16x16x32_bf16 v[88:91], v[104:107], v[148:151], v[76:79]
    v_mfma_f32_16x16x32_bf16 v[92:95], v[116:119], v[148:151], v[80:83]
    v_mfma_f32_16x16x32_bf16 v[96:99], v[104:107], v[152:155], v[76:79]
    v_mfma_f32_16x16x32_bf16 v[84:87], v[116:119], v[152:155], v[80:83]
    s_nop 4
    v_cvt_pk_bf16_f32 v12, v88, v89
    v_cvt_pk_bf16_f32 v13, v90, v91
    v_cvt_pk_bf16_f32 v14, v92, v93
    v_cvt_pk_bf16_f32 v15, v94, v95
    v_cvt_pk_bf16_f32 v16, v96, v97
    v_cvt_pk_bf16_f32 v17, v98, v99
    v_cvt_pk_bf16_f32 v18, v84, v85
    v_cvt_pk_bf16_f32 v19, v86, v87
    v_mfma_f32_16x16x32_bf16 v[88:91], v[108:111], v[148:151], v[76:79]
    v_mfma_f32_16x16x32_bf16 v[92:95], v[120:123], v[148:151], v[80:83]
    v_mfma_f32_16x16x32_bf16 v[96:99], v[108:111], v[152:155], v[76:79]
    v_mfma_f32_16x16x32_bf16 v[84:87], v[120:123], v[152:155], v[80:83]
    s_nop 4
    v_cvt_pk_bf16_f32 v20, v88, v89
    v_cvt_pk_bf16_f32 v21, v90, v91
    v_cvt_pk_bf16_f32 v22, v92, v93
    v_cvt_pk_bf16_f32 v23, v94, v95
    v_cvt_pk_bf16_f32 v24, v96, v97
    v_cvt_pk_bf16_f32 v25, v98, v99
    v_cvt_pk_bf16_f32 v26, v84, v85
    v_cvt_pk_bf16_f32 v27, v86, v87
    s_cmp_ge_u32 s24, s23
    s_nop 0
    s_cbranch_scc1 L_O_DONE
L_O_LOOP:
    s_cmp_lt_u32 s24, 6
    s_cbranch_scc1 L_O_EARLY
    s_waitcnt vmcnt(30) lgkmcnt(0)
L_O_GO:
    s_barrier
    s_cmp_lt_u32 s36, s23
    s_cselect_b32 s75, s34, 0x7f000000
    s_add_u32 s36, s36, 1
    s_add_u32 s34, s34, s37
    s_sub_u32 s35, s35, 1
    s_cmp_eq_u32 s35, 0
    s_cselect_b32 s70, s39, 0
    s_cselect_b32 s35, 72, s35
    s_add_u32 s34, s34, s70
    s_lshl_b32 s73, s20, 10
    s_add_u32 s73, s73, s27
    s_mov_b32 m0, s73
    s_add_u32 s73, s73, 4096
    v_add_u32 v144, s29, v145
    v_mul_f32 v125, v101, v101
    ds_read2st64_b32 v[78:79], v144 offset0:2 offset1:13
    ds_read2st64_b32 v[86:87], v144 offset0:40 offset1:41
    ds_read2st64_b32 v[82:83], v144 offset0:26 offset1:27
    ds_read2st64_b32 v[76:77], v144 offset0:0 offset1:1
    ds_read2st64_b32 v[84:85], v144 offset0:28 offset1:39
    ds_read2st64_b32 v[80:81], v144 offset0:14 offset1:15
    v_fmac_f32 v125, v103, v103
    v_fma_f32 v124, v100, v100, s47
    v_fmac_f32 v125, v105, v105
    v_fmac_f32 v124, v102, v102
    v_fmac_f32 v125, v107, v107
    v_fmac_f32 v124, v104, v104
    v_fmac_f32 v125, v109, v109
    v_fmac_f32 v124, v106, v106
    v_fmac_f32 v125, v111, v111
    v_fmac_f32 v124, v108, v108
    v_fmac_f32 v125, v113, v113
    v_fmac_f32 v124, v110, v110
    v_fmac_f32 v125, v115, v115
    v_fmac_f32 v124, v112, v112
    v_fmac_f32 v125, v117, v117
    v_fmac_f32 v124, v114, v114
    v_fmac_f32 v125, v119, v119
    v_fmac_f32 v124, v116, v116
    v_fmac_f32 v125, v121, v121
    v_fmac_f32 v124, v118, v118
    v_fmac_f32 v125, v123, v123
    v_fmac_f32 v124, v120, v120
    v_fmac_f32 v124, v122, v122
    v_add_f32 v124, v124, v125
    v_cvt_pk_bf16_f32 v130, v124, 0
    s_nop 1
    v_mfma_f32_16x16x16_bf16 v[126:129], v[134:135], v[130:131], 0
    s_nop 7
    v_rsq_f32 v126, v126
    s_nop 0
    v_mul_f32 v126, s48, v126
    v_mul_f32 v102, v126, v102
    v_mul_f32 v106, v126, v106
    v_mul_f32 v100, v126, v100
    v_mul_f32 v107, v126, v107
    v_mul_f32 v103, v126, v103
    v_mul_f32 v109, v126, v109
    v_mul_f32 v110, v126, v110
    v_mul_f32 v101, v126, v101
    v_mul_f32 v112, v126, v112
    v_mul_f32 v104, v126, v104
    v_mul_f32 v105, v126, v105
    v_mul_f32 v111, v126, v111
    v_mul_f32 v108, v126, v108
    v_mul_f32 v118, v126, v118
    v_mul_f32 v123, v126, v123
    v_mul_f32 v117, v126, v117
    v_cvt_pk_bf16_f32 v88, v100, v101
    v_cvt_pk_bf16_f32 v89, v102, v103
    s_waitcnt lgkmcnt(2)
    v_mfma_f32_16x16x32_bf16 v[100:103], v[4:7], v[76:79], 0
    v_mul_f32 v116, v126, v116
    v_mul_f32 v119, v126, v119
    v_mul_f32 v120, v126, v120
    s_waitcnt lgkmcnt(0)
    v_mfma_f32_16x16x32_bf16 v[100:103], v[28:31], v[80:83], v[100:103]
    v_mul_f32 v113, v126, v113
    v_mul_f32 v115, v126, v115
    v_cvt_pk_bf16_f32 v94, v112, v113
    v_mfma_f32_16x16x32_bf16 v[100:103], v[52:55], v[84:87], v[100:103]
    v_mul_f32 v114, v126, v114
    v_cvt_pk_bf16_f32 v97, v118, v119
    v_cvt_pk_bf16_f32 v95, v114, v115
    v_mfma_f32_16x16x32_bf16 v[112:115], v[16:19], v[76:79], 0
    v_mul_f32 v121, v126, v121
    v_cvt_pk_bf16_f32 v96, v116, v117
    v_mul_f32 v122, v126, v122
    v_mfma_f32_16x16x32_bf16 v[116:119], v[20:23], v[76:79], 0
    v_cvt_pk_bf16_f32 v92, v108, v109
    v_cvt_pk_bf16_f32 v91, v106, v107
    v_cvt_pk_bf16_f32 v90, v104, v105
    v_mfma_f32_16x16x32_bf16 v[104:107], v[8:11], v[76:79], 0
    buffer_store_dwordx4 v[88:91], v139, s[8:11], s33 offen offset:0 sc1
    v_cvt_pk_bf16_f32 v99, v122, v123
    v_cvt_pk_bf16_f32 v93, v110, v111
    v_mfma_f32_16x16x32_bf16 v[104:107], v[32:35], v[80:83], v[104:107]
    buffer_store_dwordx4 v[92:95], v139, s[8:11], s33 offen offset:64 sc1
    v_cvt_pk_bf16_f32 v98, v120, v121
    buffer_store_dwordx4 v[96:99], v139, s[8:11], s33 offen offset:128 sc1
    buffer_load_dwordx4 v136, s[4:7], s75 offen lds
    s_mov_b32 m0, s73
    s_add_u32 s73, s27, 8192
    buffer_load_dwordx4 v137, s[4:7], s75 offen lds
    s_mov_b32 m0, s73
    v_mfma_f32_16x16x32_bf16 v[108:111], v[12:15], v[76:79], 0
    s_mov_b32 s33, s30
    s_cmp_lt_u32 s46, s23
    s_cselect_b32 s30, s31, 0x7f000000
    v_mfma_f32_16x16x32_bf16 v[108:111], v[36:39], v[80:83], v[108:111]
    s_add_u32 s46, s46, 1
    s_add_u32 s31, s31, s37
    s_sub_u32 s32, s32, 1
    v_mfma_f32_16x16x32_bf16 v[108:111], v[60:63], v[84:87], v[108:111]
    s_cmp_eq_u32 s32, 0
    s_cselect_b32 s71, s39, 0
    s_cselect_b32 s32, 72, s32
    v_mfma_f32_16x16x32_bf16 v[120:123], v[24:27], v[76:79], 0
    s_add_u32 s31, s31, s71
    s_add_u32 s27, s27, 9216
    s_cmp_eq_u32 s27, 73728
    v_mfma_f32_16x16x32_bf16 v[120:123], v[48:51], v[80:83], v[120:123]
    s_cselect_b32 s27, 0, s27
    s_xor_b32 s29, s29, 19456
    s_add_u32 s24, s24, 1
    v_mfma_f32_16x16x32_bf16 v[104:107], v[56:59], v[84:87], v[104:107]
    s_mov_b64 exec, s[44:45]
    buffer_load_dwordx4 v138, s[4:7], s75 offen lds
    s_mov_b64 exec, -1
    v_mfma_f32_16x16x32_bf16 v[120:123], v[72:75], v[84:87], v[120:123]
    v_mfma_f32_16x16x32_bf16 v[112:115], v[40:43], v[80:83], v[112:115]
    v_mfma_f32_16x16x32_bf16 v[112:115], v[64:67], v[84:87], v[112:115]
    v_mfma_f32_16x16x32_bf16 v[116:119], v[44:47], v[80:83], v[116:119]
    v_mfma_f32_16x16x32_bf16 v[116:119], v[68:71], v[84:87], v[116:119]
    s_cmp_lt_u32 s24, s23
    s_nop 6
    s_cbranch_scc1 L_O_LOOP
L_O_DONE:
    v_fma_f32 v124, v100, v100, s47
    v_mul_f32 v125, v101, v101
    v_fmac_f32 v124, v102, v102
    v_fmac_f32 v125, v103, v103
    v_fmac_f32 v124, v104, v104
    v_fmac_f32 v125, v105, v105
    v_fmac_f32 v124, v106, v106
    v_fmac_f32 v125, v107, v107
    v_fmac_f32 v124, v108, v108
    v_fmac_f32 v125, v109, v109
    v_fmac_f32 v124, v110, v110
    v_fmac_f32 v125, v111, v111
    v_fmac_f32 v124, v112, v112
    v_fmac_f32 v125, v113, v113
    v_fmac_f32 v124, v114, v114
    v_fmac_f32 v125, v115, v115
    v_fmac_f32 v124, v116, v116
    v_fmac_f32 v125, v117, v117
    v_fmac_f32 v124, v118, v118
    v_fmac_f32 v125, v119, v119
    v_fmac_f32 v124, v120, v120
    v_fmac_f32 v125, v121, v121
    v_fmac_f32 v124, v122, v122
    v_fmac_f32 v125, v123, v123
    v_add_f32 v124, v124, v125
    v_cvt_pk_bf16_f32 v130, v124, 0
    s_nop 1
    v_mfma_f32_16x16x16_bf16 v[126:129], v[134:135], v[130:131], 0
    s_nop 7
    v_rsq_f32 v126, v126
    s_nop 0
    v_mul_f32 v126, s48, v126
    v_mul_f32 v100, v126, v100
    v_mul_f32 v101, v126, v101
    v_mul_f32 v102, v126, v102
    v_mul_f32 v103, v126, v103
    v_mul_f32 v104, v126, v104
    v_mul_f32 v105, v126, v105
    v_mul_f32 v106, v126, v106
    v_mul_f32 v107, v126, v107
    v_mul_f32 v108, v126, v108
    v_mul_f32 v109, v126, v109
    v_mul_f32 v110, v126, v110
    v_mul_f32 v111, v126, v111
    v_mul_f32 v112, v126, v112
    v_mul_f32 v113, v126, v113
    v_mul_f32 v114, v126, v114
    v_mul_f32 v115, v126, v115
    v_mul_f32 v116, v126, v116
    v_mul_f32 v117, v126, v117
    v_mul_f32 v118, v126, v118
    v_mul_f32 v119, v126, v119
    v_mul_f32 v120, v126, v120
    v_mul_f32 v121, v126, v121
    v_mul_f32 v122, v126, v122
    v_mul_f32 v123, v126, v123
    v_cvt_pk_bf16_f32 v88, v100, v101
    v_cvt_pk_bf16_f32 v89, v102, v103
    v_cvt_pk_bf16_f32 v90, v104, v105
    v_cvt_pk_bf16_f32 v91, v106, v107
    v_cvt_pk_bf16_f32 v92, v108, v109
    v_cvt_pk_bf16_f32 v93, v110, v111
    v_cvt_pk_bf16_f32 v94, v112, v113
    v_cvt_pk_bf16_f32 v95, v114, v115
    buffer_store_dwordx4 v[88:91], v139, s[8:11], s33 offen offset:0 sc1
    v_cvt_pk_bf16_f32 v96, v116, v117
    v_cvt_pk_bf16_f32 v97, v118, v119
    v_cvt_pk_bf16_f32 v98, v120, v121
    v_cvt_pk_bf16_f32 v99, v122, v123
    buffer_store_dwordx4 v[92:95], v139, s[8:11], s33 offen offset:64 sc1
    buffer_store_dwordx4 v[96:99], v139, s[8:11], s33 offen offset:128 sc1
    s_waitcnt lgkmcnt(0)
    s_barrier
    v_add_u32 v144, s29, v145
    ds_read2st64_b32 v[76:77], v144 offset0:0 offset1:1
    ds_read2st64_b32 v[78:79], v144 offset0:2 offset1:13
    ds_read2st64_b32 v[80:81], v144 offset0:14 offset1:15
    ds_read2st64_b32 v[82:83], v144 offset0:26 offset1:27
    ds_read2st64_b32 v[84:85], v144 offset0:28 offset1:39
    ds_read2st64_b32 v[86:87], v144 offset0:40 offset1:41
    s_waitcnt lgkmcnt(4)
    v_mfma_f32_16x16x32_bf16 v[100:103], v[4:7], v[76:79], 0
    v_mfma_f32_16x16x32_bf16 v[104:107], v[8:11], v[76:79], 0
    s_waitcnt lgkmcnt(2)
    v_mfma_f32_16x16x32_bf16 v[100:103], v[28:31], v[80:83], v[100:103]
    v_mfma_f32_16x16x32_bf16 v[108:111], v[12:15], v[76:79], 0
    v_mfma_f32_16x16x32_bf16 v[104:107], v[32:35], v[80:83], v[104:107]
    s_waitcnt lgkmcnt(0)
    v_mfma_f32_16x16x32_bf16 v[100:103], v[52:55], v[84:87], v[100:103]
    v_mfma_f32_16x16x32_bf16 v[112:115], v[16:19], v[76:79], 0
    v_mfma_f32_16x16x32_bf16 v[108:111], v[36:39], v[80:83], v[108:111]
    v_mfma_f32_16x16x32_bf16 v[104:107], v[56:59], v[84:87], v[104:107]
    v_mfma_f32_16x16x32_bf16 v[116:119], v[20:23], v[76:79], 0
    v_mfma_f32_16x16x32_bf16 v[112:115], v[40:43], v[80:83], v[112:115]
    v_mfma_f32_16x16x32_bf16 v[108:111], v[60:63], v[84:87], v[108:111]
    s_nop 1
    v_fma_f32 v124, v100, v100, s47
    v_mul_f32 v125, v101, v101
    v_mfma_f32_16x16x32_bf16 v[120:123], v[24:27], v[76:79], 0
    v_fmac_f32 v124, v102, v102
    v_fmac_f32 v125, v103, v103
    v_mfma_f32_16x16x32_bf16 v[116:119], v[44:47], v[80:83], v[116:119]
    v_fmac_f32 v124, v104, v104
    v_fmac_f32 v125, v105, v105
    v_mfma_f32_16x16x32_bf16 v[112:115], v[64:67], v[84:87], v[112:115]
    v_fmac_f32 v124, v106, v106
    v_fmac_f32 v125, v107, v107
    v_mfma_f32_16x16x32_bf16 v[120:123], v[48:51], v[80:83], v[120:123]
    v_fmac_f32 v124, v108, v108
    v_fmac_f32 v125, v109, v109
    v_mfma_f32_16x16x32_bf16 v[116:119], v[68:71], v[84:87], v[116:119]
    v_fmac_f32 v124, v110, v110
    v_fmac_f32 v125, v111, v111
    v_mfma_f32_16x16x32_bf16 v[120:123], v[72:75], v[84:87], v[120:123]
    v_fmac_f32 v124, v112, v112
    v_fmac_f32 v125, v113, v113
    v_fmac_f32 v124, v114, v114
    v_fmac_f32 v125, v115, v115
    s_nop 0
    v_fmac_f32 v124, v116, v116
    v_fmac_f32 v125, v117, v117
    v_fmac_f32 v124, v118, v118
    v_fmac_f32 v125, v119, v119
    v_fmac_f32 v124, v120, v120
    v_fmac_f32 v125, v121, v121
    v_fmac_f32 v124, v122, v122
    v_fmac_f32 v125, v123, v123
    v_add_f32 v124, v124, v125
    v_cvt_pk_bf16_f32 v130, v124, 0
    s_nop 1
    v_mfma_f32_16x16x16_bf16 v[126:129], v[134:135], v[130:131], 0
    s_nop 7
    v_rsq_f32 v126, v126
    s_nop 0
    v_mul_f32 v126, s48, v126
    v_mul_f32 v100, v126, v100
    v_mul_f32 v101, v126, v101
    v_mul_f32 v102, v126, v102
    v_mul_f32 v103, v126, v103
    v_mul_f32 v104, v126, v104
    v_mul_f32 v105, v126, v105
    v_mul_f32 v106, v126, v106
    v_mul_f32 v107, v126, v107
    v_mul_f32 v108, v126, v108
    v_mul_f32 v109, v126, v109
    v_mul_f32 v110, v126, v110
    v_mul_f32 v111, v126, v111
    v_mul_f32 v112, v126, v112
    v_mul_f32 v113, v126, v113
    v_mul_f32 v114, v126, v114
    v_mul_f32 v115, v126, v115
    v_mul_f32 v116, v126, v116
    v_mul_f32 v117, v126, v117
    v_mul_f32 v118, v126, v118
    v_mul_f32 v119, v126, v119
    v_mul_f32 v120, v126, v120
    v_mul_f32 v121, v126, v121
    v_mul_f32 v122, v126, v122
    v_mul_f32 v123, v126, v123
    v_cvt_pk_bf16_f32 v88, v100, v101
    v_cvt_pk_bf16_f32 v89, v102, v103
    v_cvt_pk_bf16_f32 v90, v104, v105
    v_cvt_pk_bf16_f32 v91, v106, v107
    v_cvt_pk_bf16_f32 v92, v108, v109
    v_cvt_pk_bf16_f32 v93, v110, v111
    v_cvt_pk_bf16_f32 v94, v112, v113
    v_cvt_pk_bf16_f32 v95, v114, v115
    buffer_store_dwordx4 v[88:91], v139, s[8:11], s30 offen offset:0 sc1
    v_cvt_pk_bf16_f32 v96, v116, v117
    v_cvt_pk_bf16_f32 v97, v118, v119
    v_cvt_pk_bf16_f32 v98, v120, v121
    v_cvt_pk_bf16_f32 v99, v122, v123
    buffer_store_dwordx4 v[92:95], v139, s[8:11], s30 offen offset:64 sc1
    buffer_store_dwordx4 v[96:99], v139, s[8:11], s30 offen offset:128 sc1
    s_nop 1
    s_endpgm
L_O_EARLY:
    s_waitcnt vmcnt(15) lgkmcnt(0)
    s_branch L_O_GO
L_USED_END:
L_M_LOOP_S:
    s_waitcnt lgkmcnt(0)
    s_barrier
L_M_BODY0_S:
    v_mfma_f32_16x16x32_bf16 v[244:247], v[192:195], v[40:43], 0
    s_add_u32 s26, s26, 9216
    s_cmp_eq_u32 s26, 73728
    v_mfma_f32_16x16x32_bf16 v[248:251], v[192:195], v[52:55], v[176:179]
    ds_read_b128 v[192:195], v101 offset:3072
    v_mfma_f32_16x16x32_bf16 v[244:247], v[196:199], v[44:47], v[244:247]
    s_cselect_b32 s26, 0, s26
    s_add_u32 s24, s24, 1
    v_mfma_f32_16x16x32_bf16 v[248:251], v[196:199], v[56:59], v[248:251]
    ds_read_b128 v[196:199], v101 offset:4096
    v_mfma_f32_16x16x32_bf16 v[244:247], v[200:203], v[48:51], v[244:247]
    v_fma_f32 v217, v210, v210, s46
    v_fma_f32 v216, v204, v204, s46
    v_mfma_f32_16x16x32_bf16 v[248:251], v[200:203], v[60:63], v[248:251]
    ds_read_b128 v[200:203], v101 offset:5120
    v_fmac_f32 v216, v205, v205
    v_fmac_f32 v216, v206, v206
    v_fmac_f32 v216, v207, v207
    v_fmac_f32 v216, v208, v208
    v_cvt_pk_bf16_f32 v141, v246, v247
    v_cvt_pk_bf16_f32 v140, v244, v245
    v_fmac_f32 v216, v209, v209
    v_cvt_pk_bf16_f32 v149, v250, v251
    v_cvt_pk_bf16_f32 v148, v248, v249
    v_fmac_f32 v217, v211, v211
    v_fmac_f32 v217, v212, v212
    v_fmac_f32 v217, v213, v213
    v_fmac_f32 v217, v214, v214
    v_fmac_f32 v217, v215, v215
    v_cvt_pk_bf16_f32 v188, v216, v217
    s_nop 1
    v_mfma_f32_16x16x16_bf16 v[218:221], v[172:173], v[188:189], 0
    s_waitcnt lgkmcnt(2)
    v_mfma_f32_16x16x32_bf16 v[224:227], v[4:7], v[192:195], 0
    v_mfma_f32_16x16x32_bf16 v[228:231], v[16:19], v[192:195], 0
    v_mfma_f32_16x16x32_bf16 v[244:247], v[192:195], v[40:43], 0
    v_mfma_f32_16x16x32_bf16 v[232:235], v[28:31], v[192:195], 0
    v_mfma_f32_16x16x32_bf16 v[248:251], v[192:195], v[52:55], v[176:179]
    ds_read_b128 v[192:195], v101 offset:6144
    s_waitcnt lgkmcnt(2)
    v_mfma_f32_16x16x32_bf16 v[224:227], v[8:11], v[196:199], v[224:227]
    v_rsq_f32 v219, v219
    v_mfma_f32_16x16x32_bf16 v[232:235], v[32:35], v[196:199], v[232:235]
    v_rsq_f32 v218, v218
    v_mfma_f32_16x16x32_bf16 v[228:231], v[20:23], v[196:199], v[228:231]
    v_mul_f32 v218, s40, v218
    v_mul_f32 v204, v218, v204
    s_waitcnt lgkmcnt(1)
    v_mfma_f32_16x16x32_bf16 v[224:227], v[12:15], v[200:203], v[224:227]
    v_mul_f32 v210, v219, v210
    v_mul_f32 v212, v219, v212
    v_mfma_f32_16x16x32_bf16 v[232:235], v[36:39], v[200:203], v[232:235]
    v_mul_f32 v205, v218, v205
    v_mul_f32 v211, v219, v211
    v_mfma_f32_16x16x32_bf16 v[244:247], v[196:199], v[44:47], v[244:247]
    v_mul_f32 v206, v218, v206
    v_mul_f32 v213, v219, v213
    v_mfma_f32_16x16x32_bf16 v[244:247], v[200:203], v[48:51], v[244:247]
    v_mul_f32 v207, v218, v207
    v_mul_f32 v214, v219, v214
    v_mfma_f32_16x16x32_bf16 v[248:251], v[196:199], v[56:59], v[248:251]
    ds_read_b128 v[196:199], v101 offset:7168
    v_mfma_f32_16x16x32_bf16 v[248:251], v[200:203], v[60:63], v[248:251]
    v_mul_f32 v215, v219, v215
    v_cvt_pk_bf16_f32 v129, v206, v207
    v_mfma_f32_16x16x32_bf16 v[228:231], v[24:27], v[200:203], v[228:231]
    ds_read_b128 v[200:203], v101 offset:8192
    v_mul_f32 v208, v218, v208
    v_mul_f32 v209, v218, v209
    v_cvt_pk_bf16_f32 v112, v210, v211
    v_cvt_pk_bf16_f32 v128, v204, v205
    s_waitcnt lgkmcnt(2)
    v_mfma_f32_16x16x32_bf16 v[204:207], v[4:7], v[192:195], 0
    v_cvt_pk_bf16_f32 v114, v214, v215
    v_cvt_pk_bf16_f32 v113, v212, v213
    v_mfma_f32_16x16x32_bf16 v[212:215], v[28:31], v[192:195], 0
    v_cvt_pk_bf16_f32 v130, v208, v209
    v_cvt_pk_bf16_f32 v150, v248, v249
    v_mfma_f32_16x16x32_bf16 v[208:211], v[16:19], v[192:195], 0
    v_cvt_pk_bf16_f32 v143, v246, v247
    v_fma_f32 v237, v230, v230, s46
    v_fma_f32 v236, v224, v224, s46
    v_cvt_pk_bf16_f32 v142, v244, v245
    v_mfma_f32_16x16x32_bf16 v[244:247], v[192:195], v[40:43], 0
    v_fmac_f32 v236, v225, v225
    v_fmac_f32 v237, v231, v231
    v_cvt_pk_bf16_f32 v151, v250, v251
    v_mfma_f32_16x16x32_bf16 v[248:251], v[192:195], v[52:55], v[176:179]
    v_fmac_f32 v237, v232, v232
    v_fmac_f32 v237, v233, v233
    v_mfma_f32_16x16x32_bf16 v[192:195], v[112:115], v[128:131], v[64:67]
    v_fmac_f32 v236, v226, v226
    v_fmac_f32 v236, v227, v227
    s_waitcnt lgkmcnt(1)
    v_mfma_f32_16x16x32_bf16 v[208:211], v[20:23], v[196:199], v[208:211]
    v_fmac_f32 v236, v228, v228
    v_fmac_f32 v236, v229, v229
    v_mfma_f32_16x16x32_bf16 v[204:207], v[8:11], v[196:199], v[204:207]
    v_fmac_f32 v237, v234, v234
    v_fmac_f32 v237, v235, v235
    v_mfma_f32_16x16x32_bf16 v[244:247], v[196:199], v[44:47], v[244:247]
    v_cvt_pk_bf16_f32 v190, v236, v237
    s_waitcnt lgkmcnt(0)
    v_mfma_f32_16x16x32_bf16 v[208:211], v[24:27], v[200:203], v[208:211]
    v_mfma_f32_16x16x16_bf16 v[238:241], v[172:173], v[190:191], 0
    v_mfma_f32_16x16x32_bf16 v[204:207], v[12:15], v[200:203], v[204:207]
    v_mfma_f32_16x16x32_bf16 v[212:215], v[32:35], v[196:199], v[212:215]
    v_mfma_f32_16x16x32_bf16 v[212:215], v[36:39], v[200:203], v[212:215]
    v_mfma_f32_16x16x32_bf16 v[248:251], v[196:199], v[56:59], v[248:251]
    v_mfma_f32_16x16x32_bf16 v[248:251], v[200:203], v[60:63], v[248:251]
    s_nop 1
    v_fma_f32 v217, v210, v210, s46
    v_mfma_f32_16x16x32_bf16 v[244:247], v[200:203], v[48:51], v[244:247]
    v_rsq_f32 v238, v238
    v_rsq_f32 v239, v239
    v_mul_f32 v238, s40, v238
    v_mul_f32 v224, v238, v224
    v_mul_f32 v231, v239, v231
    v_mul_f32 v225, v238, v225
    v_mul_f32 v230, v239, v230
    v_mul_f32 v232, v239, v232
    v_mul_f32 v227, v238, v227
    v_mul_f32 v234, v239, v234
    v_mul_f32 v226, v238, v226
    v_mul_f32 v229, v238, v229
    v_mul_f32 v233, v239, v233
    v_cvt_pk_bf16_f32 v132, v224, v225
    v_mul_f32 v228, v238, v228
    v_mul_f32 v235, v239, v235
    v_cvt_pk_bf16_f32 v133, v226, v227
    v_cvt_pk_bf16_f32 v118, v234, v235
    v_cvt_pk_bf16_f32 v116, v230, v231
    v_cvt_pk_bf16_f32 v134, v228, v229
    v_cvt_pk_bf16_f32 v117, v232, v233
    v_cvt_pk_bf16_f32 v144, v244, v245
    v_cvt_pk_bf16_f32 v145, v246, v247
    v_mfma_f32_16x16x32_bf16 v[196:199], v[116:119], v[128:131], v[76:79]
    v_cvt_pk_bf16_f32 v153, v250, v251
    v_fma_f32 v216, v204, v204, s46
    v_cvt_pk_bf16_f32 v152, v248, v249
    v_fmac_f32 v216, v205, v205
    v_fmac_f32 v216, v206, v206
    v_fmac_f32 v217, v211, v211
    v_fmac_f32 v216, v207, v207
    v_fmac_f32 v217, v212, v212
    v_fmac_f32 v217, v213, v213
    v_fmac_f32 v216, v208, v208
    v_fmac_f32 v216, v209, v209
    v_fmac_f32 v217, v214, v214
    v_fmac_f32 v217, v215, v215
    v_cvt_pk_bf16_f32 v188, v216, v217
    s_nop 1
    v_mfma_f32_16x16x16_bf16 v[218:221], v[172:173], v[188:189], 0
    s_nop 7
    v_rsq_f32 v218, v218
    v_rsq_f32 v219, v219
    v_mul_f32 v218, s40, v218
    v_mul_f32 v204, v218, v204
    v_mul_f32 v206, v218, v206
    v_mul_f32 v211, v219, v211
    v_mul_f32 v205, v218, v205
    v_mul_f32 v210, v219, v210
    v_mul_f32 v208, v218, v208
    v_mul_f32 v212, v219, v212
    v_mul_f32 v209, v218, v209
    v_mul_f32 v214, v219, v214
    v_mul_f32 v207, v218, v207
    v_cvt_pk_bf16_f32 v136, v204, v205
    v_mul_f32 v213, v219, v213
    v_cvt_pk_bf16_f32 v120, v210, v211
    v_mul_f32 v215, v219, v215
    v_mfma_f32_16x16x32_bf16 v[216:219], v[124:127], v[128:131], v[100:103]
    v_cvt_pk_bf16_f32 v137, v206, v207
    ds_read_b128 v[204:207], v105
    v_cvt_pk_bf16_f32 v121, v212, v213
    v_cvt_pk_bf16_f32 v138, v208, v209
    v_cvt_pk_bf16_f32 v122, v214, v215
    v_max3_f32 v220, v192, v193, v194
    v_max3_f32 v220, v220, v195, v196
    v_mfma_f32_16x16x32_bf16 v[200:203], v[120:123], v[128:131], v[88:91]
    v_max3_f32 v220, v220, v197, v198
    v_add_u32 v101, s26, v1
    s_nop 5
    v_max3_f32 v220, v220, v199, v200
    v_max3_f32 v220, v220, v201, v202
    v_max3_f32 v220, v220, v203, v216
    v_mov_b32 v217, v220
    s_nop 1
    v_permlane32_swap_b32 v220, v217
    v_max_f32 v220, v220, v217
    v_mov_b32 v217, v220
    s_nop 1
    v_permlane16_swap_b32 v220, v217
    v_max_f32 v220, v220, v217
    v_sub_f32 v196, v196, v220
    v_sub_f32 v193, v193, v220
    v_sub_f32 v192, v192, v220
    v_sub_f32 v194, v194, v220
    v_sub_f32 v195, v195, v220
    v_sub_f32 v199, v199, v220
    v_sub_f32 v200, v200, v220
    v_sub_f32 v198, v198, v220
    s_waitcnt lgkmcnt(0)
    v_mfma_f32_16x16x32_bf16 v[228:231], v[204:207], v[116:119], v[106:109]
    v_sub_f32 v197, v197, v220
    v_sub_f32 v203, v203, v220
    v_mfma_f32_16x16x32_bf16 v[236:239], v[204:207], v[124:127], v[106:109]
    v_sub_f32 v201, v201, v220
    v_sub_f32 v216, v216, v220
    v_mfma_f32_16x16x32_bf16 v[224:227], v[204:207], v[112:115], v[106:109]
    v_sub_f32 v202, v202, v220
    v_exp_f32 v193, v193
    v_mfma_f32_16x16x32_bf16 v[232:235], v[204:207], v[120:123], v[106:109]
    v_exp_f32 v192, v192
    v_exp_f32 v194, v194
    v_exp_f32 v196, v196
    v_exp_f32 v195, v195
    v_exp_f32 v197, v197
    v_bfi_b32 v208, v181, v228, v224
    v_mfma_f32_16x16x32_bf16 v[228:231], v[116:119], v[132:135], v[80:83]
    v_exp_f32 v198, v198
    v_mfma_f32_16x16x32_bf16 v[224:227], v[112:115], v[132:135], v[68:71]
    v_bfi_b32 v209, v181, v236, v232
    v_bfi_b32 v208, v182, v209, v208
    v_mfma_f32_16x16x32_bf16 v[232:235], v[120:123], v[132:135], v[92:95]
    v_mov_b32 v209, v208
    v_exp_f32 v203, v203
    v_mfma_f32_16x16x32_bf16 v[236:239], v[124:127], v[132:135], v[102:105]
    v_max_f32_dpp v209, v209, v209 row_ror:8 row_mask:0xf bank_mask:0xf
    v_exp_f32 v202, v202
    v_exp_f32 v201, v201
    v_max_f32_dpp v209, v209, v209 row_ror:4 row_mask:0xf bank_mask:0xf
    v_exp_f32 v199, v199
    v_exp_f32 v200, v200
    v_max_f32_dpp v209, v209, v209 row_ror:2 row_mask:0xf bank_mask:0xf
    v_cvt_pk_bf16_f32 v157, v194, v195
    v_exp_f32 v216, v216
    v_max_f32_dpp v209, v209, v209 row_ror:1 row_mask:0xf bank_mask:0xf
    v_mov_b32 v210, v209
    v_cvt_pk_bf16_f32 v156, v192, v193
    v_mfma_f32_16x16x32_bf16 v[192:195], v[112:115], v[136:139], v[72:75]
    v_permlane32_swap_b32 v209, v210
    v_max_f32 v209, v209, v210
    v_mov_b32 v210, v209
    v_cvt_pk_bf16_f32 v158, v196, v197
    v_cvt_pk_bf16_f32 v161, v202, v203
    v_permlane16_swap_b32 v209, v210
    v_max_f32 v209, v209, v210
    v_sub_f32 v208, v208, v209
    v_exp_f32 v208, v208
    v_cvt_pk_bf16_f32 v162, v216, 0
    v_cvt_pk_bf16_f32 v240, v208, 0
    ds_write_b16 v185, v240
    ds_read2_b64 v[168:171], v186 offset0:8 offset1:12
    ds_read2_b64 v[164:167], v186 offset0:0 offset1:4
    v_cvt_pk_bf16_f32 v159, v198, v199
    v_mfma_f32_16x16x32_bf16 v[196:199], v[116:119], v[136:139], v[84:87]
    v_cvt_pk_bf16_f32 v160, v200, v201
    v_max3_f32 v240, v224, v225, v226
    v_mfma_f32_16x16x32_bf16 v[248:251], v[148:151], v[156:159], 0
    v_max3_f32 v240, v240, v227, v228
    v_max3_f32 v240, v240, v229, v230
    v_mfma_f32_16x16x32_bf16 v[244:247], v[140:143], v[156:159], 0
    v_max3_f32 v240, v240, v231, v232
    v_max3_f32 v240, v240, v233, v234
    v_mfma_f32_16x16x32_bf16 v[244:247], v[144:147], v[160:163], v[244:247]
    v_max3_f32 v240, v240, v235, v236
    v_mov_b32 v237, v240
    v_mfma_f32_16x16x32_bf16 v[248:251], v[152:155], v[160:163], v[248:251]
    s_nop 0
    v_permlane32_swap_b32 v240, v237
    v_mfma_f32_16x16x32_bf16 v[200:203], v[120:123], v[136:139], v[96:99]
    v_max_f32 v240, v240, v237
    v_mov_b32 v237, v240
    s_nop 1
    v_permlane16_swap_b32 v240, v237
    v_rcp_f32 v220, v250
    v_max_f32 v240, v240, v237
    v_mul_f32 v245, v220, v245
    v_mul_f32 v247, v220, v247
    v_mul_f32 v244, v220, v244
    v_mul_f32 v246, v220, v246
    v_cvt_pk_bf16_f32 v218, v246, v247
    s_waitcnt lgkmcnt(0)
    v_mfma_f32_16x16x32_bf16 v[204:207], v[140:143], v[164:167], 0
    v_mul_f32 v249, v220, v249
    v_mul_f32 v248, v220, v248
    v_mfma_f32_16x16x32_bf16 v[204:207], v[144:147], v[168:171], v[204:207]
    v_cvt_pk_bf16_f32 v219, v248, v249
    ds_write_b32 v103, v219 offset:512
    v_mfma_f32_16x16x32_bf16 v[208:211], v[148:151], v[164:167], 0
    v_cvt_pk_bf16_f32 v217, v244, v245
    ds_write2_b32 v103, v217, v218 offset0:0 offset1:64
    v_mfma_f32_16x16x32_bf16 v[208:211], v[152:155], v[168:171], v[208:211]
    v_sub_f32 v225, v225, v240
    v_sub_f32 v224, v224, v240
    v_mfma_f32_16x16x32_bf16 v[216:219], v[124:127], v[136:139], v[104:107]
    v_sub_f32 v227, v227, v240
    v_sub_f32 v229, v229, v240
    v_sub_f32 v226, v226, v240
    v_sub_f32 v232, v232, v240
    v_sub_f32 v230, v230, v240
    v_rcp_f32 v252, v210
    v_sub_f32 v228, v228, v240
    v_mul_f32 v204, v252, v204
    v_mul_f32 v206, v252, v206
    v_mul_f32 v208, v252, v208
    v_mul_f32 v205, v252, v205
    v_cvt_pk_bf16_f32 v253, v204, v205
    v_mul_f32 v207, v252, v207
    v_cvt_pk_bf16_f32 v254, v206, v207
    v_mul_f32 v209, v252, v209
    v_cvt_pk_bf16_f32 v255, v208, v209
    s_mov_b64 exec, s[42:43]
    ds_write2_b32 v103, v253, v254 offset0:48 offset1:112
    ds_write_b32 v103, v255 offset:704
    s_mov_b64 exec, -1
    v_sub_f32 v231, v231, v240
    v_sub_f32 v233, v233, v240
    v_exp_f32 v225, v225
    v_sub_f32 v236, v236, v240
    v_sub_f32 v234, v234, v240
    v_exp_f32 v224, v224
    v_sub_f32 v235, v235, v240
    v_exp_f32 v228, v228
    v_exp_f32 v226, v226
    v_exp_f32 v229, v229
    v_exp_f32 v231, v231
    v_exp_f32 v227, v227
    v_exp_f32 v232, v232
    v_exp_f32 v234, v234
    v_exp_f32 v230, v230
    v_exp_f32 v233, v233
    v_exp_f32 v236, v236
    v_exp_f32 v235, v235
    v_cvt_pk_bf16_f32 v164, v224, v225
    v_cvt_pk_bf16_f32 v165, v226, v227
    v_cvt_pk_bf16_f32 v167, v230, v231
    v_cvt_pk_bf16_f32 v166, v228, v229
    v_cvt_pk_bf16_f32 v168, v232, v233
    v_cvt_pk_bf16_f32 v169, v234, v235
    v_mfma_f32_16x16x32_bf16 v[208:211], v[148:151], v[164:167], 0
    v_cvt_pk_bf16_f32 v170, v236, 0
    v_max3_f32 v220, v192, v193, v194
    v_mfma_f32_16x16x32_bf16 v[204:207], v[140:143], v[164:167], 0
    v_max3_f32 v220, v220, v195, v196
    v_max3_f32 v220, v220, v197, v198
    v_mfma_f32_16x16x32_bf16 v[204:207], v[144:147], v[168:171], v[204:207]
    v_max3_f32 v220, v220, v199, v200
    v_max3_f32 v220, v220, v201, v202
    v_mfma_f32_16x16x32_bf16 v[208:211], v[152:155], v[168:171], v[208:211]
    v_max3_f32 v220, v220, v203, v216
    v_mov_b32 v217, v220
    v_mov_b32_dpp v127, v127 row_ror:4 row_mask:0xf bank_mask:0xf
    v_add_u32 v105, 64, v105
    v_permlane32_swap_b32 v220, v217
    v_max_f32 v220, v220, v217
    v_mov_b32 v217, v220
    s_nop 0
    v_rcp_f32 v240, v210
    v_permlane16_swap_b32 v220, v217
    v_mul_f32 v209, v240, v209
    v_mul_f32 v206, v240, v206
    v_mul_f32 v204, v240, v204
    v_mul_f32 v208, v240, v208
    v_mul_f32 v205, v240, v205
    v_cvt_pk_bf16_f32 v237, v204, v205
    v_mul_f32 v207, v240, v207
    v_cvt_pk_bf16_f32 v239, v208, v209
    ds_write_b32 v103, v239 offset:576
    v_cvt_pk_bf16_f32 v238, v206, v207
    ds_write2_b32 v103, v237, v238 offset0:16 offset1:80
    v_max_f32 v220, v220, v217
    v_sub_f32 v192, v192, v220
    v_sub_f32 v193, v193, v220
    v_sub_f32 v195, v195, v220
    v_sub_f32 v194, v194, v220
    v_sub_f32 v196, v196, v220
    v_sub_f32 v200, v200, v220
    v_sub_f32 v197, v197, v220
    v_sub_f32 v198, v198, v220
    v_sub_f32 v199, v199, v220
    v_exp_f32 v193, v193
    v_sub_f32 v203, v203, v220
    v_sub_f32 v201, v201, v220
    v_sub_f32 v202, v202, v220
    v_sub_f32 v216, v216, v220
    v_exp_f32 v192, v192
    v_exp_f32 v195, v195
    v_exp_f32 v194, v194
    v_exp_f32 v197, v197
    v_exp_f32 v196, v196
    v_exp_f32 v199, v199
    v_exp_f32 v200, v200
    v_exp_f32 v198, v198
    v_exp_f32 v216, v216
    v_cvt_pk_bf16_f32 v156, v192, v193
    v_cvt_pk_bf16_f32 v157, v194, v195
    ds_read_b128 v[192:195], v101 offset:0
    v_exp_f32 v201, v201
    v_exp_f32 v203, v203
    v_exp_f32 v202, v202
    v_cvt_pk_bf16_f32 v160, v200, v201
    v_cvt_pk_bf16_f32 v158, v196, v197
    v_cvt_pk_bf16_f32 v159, v198, v199
    ds_read_b128 v[196:199], v101 offset:1024
    v_cvt_pk_bf16_f32 v162, v216, 0
    v_mfma_f32_16x16x32_bf16 v[244:247], v[140:143], v[156:159], 0
    v_cvt_pk_bf16_f32 v161, v202, v203
    ds_read_b128 v[200:203], v101 offset:2048
    v_mfma_f32_16x16x32_bf16 v[248:251], v[148:151], v[156:159], 0
    v_mfma_f32_16x16x32_bf16 v[244:247], v[144:147], v[160:163], v[244:247]
    v_mfma_f32_16x16x32_bf16 v[248:251], v[152:155], v[160:163], v[248:251]
    s_nop 7
    v_rcp_f32 v220, v250
    s_nop 0
    v_mul_f32 v246, v220, v246
    s_waitcnt lgkmcnt(2)
    v_mfma_f32_16x16x32_bf16 v[208:211], v[16:19], v[192:195], 0
    v_mul_f32 v247, v220, v247
    v_mul_f32 v245, v220, v245
    v_mfma_f32_16x16x32_bf16 v[204:207], v[4:7], v[192:195], 0
    v_mul_f32 v244, v220, v244
    v_mul_f32 v249, v220, v249
    v_mfma_f32_16x16x32_bf16 v[212:215], v[28:31], v[192:195], 0
    v_mul_f32 v248, v220, v248
    v_cvt_pk_bf16_f32 v219, v248, v249
    ds_write_b32 v103, v219 offset:640
    s_waitcnt lgkmcnt(2)
    v_mfma_f32_16x16x32_bf16 v[208:211], v[20:23], v[196:199], v[208:211]
    v_cvt_pk_bf16_f32 v218, v246, v247
    v_cvt_pk_bf16_f32 v217, v244, v245
    ds_write2_b32 v103, v217, v218 offset0:32 offset1:96
    s_waitcnt lgkmcnt(2)
    v_mfma_f32_16x16x32_bf16 v[208:211], v[24:27], v[200:203], v[208:211]
    v_add_u32 v103, s78, v103
    s_sub_u32 s78, 0, s78
    v_mfma_f32_16x16x32_bf16 v[204:207], v[8:11], v[196:199], v[204:207]
    v_mfma_f32_16x16x32_bf16 v[204:207], v[12:15], v[200:203], v[204:207]
    v_mfma_f32_16x16x32_bf16 v[212:215], v[32:35], v[196:199], v[212:215]
    v_mfma_f32_16x16x32_bf16 v[212:215], v[36:39], v[200:203], v[212:215]
    s_waitcnt lgkmcnt(0)
    s_barrier
L_M_BODY1_S:
    v_mfma_f32_16x16x32_bf16 v[244:247], v[192:195], v[40:43], 0
    s_add_u32 s26, s26, 9216
    s_cmp_eq_u32 s26, 73728
    v_mfma_f32_16x16x32_bf16 v[248:251], v[192:195], v[52:55], v[176:179]
    ds_read_b128 v[192:195], v101 offset:3072
    v_mfma_f32_16x16x32_bf16 v[244:247], v[196:199], v[44:47], v[244:247]
    s_cselect_b32 s26, 0, s26
    s_add_u32 s24, s24, 1
    v_mfma_f32_16x16x32_bf16 v[248:251], v[196:199], v[56:59], v[248:251]
    ds_read_b128 v[196:199], v101 offset:4096
    v_mfma_f32_16x16x32_bf16 v[244:247], v[200:203], v[48:51], v[244:247]
    v_fma_f32 v217, v210, v210, s46
    v_fma_f32 v216, v204, v204, s46
    v_mfma_f32_16x16x32_bf16 v[248:251], v[200:203], v[60:63], v[248:251]
    ds_read_b128 v[200:203], v101 offset:5120
    v_fmac_f32 v216, v205, v205
    v_fmac_f32 v216, v206, v206
    v_fmac_f32 v216, v207, v207
    v_fmac_f32 v216, v208, v208
    v_cvt_pk_bf16_f32 v141, v246, v247
    v_cvt_pk_bf16_f32 v140, v244, v245
    v_fmac_f32 v216, v209, v209
    v_cvt_pk_bf16_f32 v149, v250, v251
    v_cvt_pk_bf16_f32 v148, v248, v249
    v_fmac_f32 v217, v211, v211
    v_fmac_f32 v217, v212, v212
    v_fmac_f32 v217, v213, v213
    v_fmac_f32 v217, v214, v214
    v_fmac_f32 v217, v215, v215
    v_cvt_pk_bf16_f32 v188, v216, v217
    s_nop 1
    v_mfma_f32_16x16x16_bf16 v[218:221], v[172:173], v[188:189], 0
    s_waitcnt lgkmcnt(2)
    v_mfma_f32_16x16x32_bf16 v[224:227], v[4:7], v[192:195], 0
    v_mfma_f32_16x16x32_bf16 v[228:231], v[16:19], v[192:195], 0
    v_mfma_f32_16x16x32_bf16 v[244:247], v[192:195], v[40:43], 0
    v_mfma_f32_16x16x32_bf16 v[232:235], v[28:31], v[192:195], 0
    v_mfma_f32_16x16x32_bf16 v[248:251], v[192:195], v[52:55], v[176:179]
    ds_read_b128 v[192:195], v101 offset:6144
    s_waitcnt lgkmcnt(2)
    v_mfma_f32_16x16x32_bf16 v[224:227], v[8:11], v[196:199], v[224:227]
    v_rsq_f32 v219, v219
    v_mfma_f32_16x16x32_bf16 v[232:235], v[32:35], v[196:199], v[232:235]
    v_rsq_f32 v218, v218
    v_mfma_f32_16x16x32_bf16 v[228:231], v[20:23], v[196:199], v[228:231]
    v_mul_f32 v218, s40, v218
    v_mul_f32 v204, v218, v204
    s_waitcnt lgkmcnt(1)
    v_mfma_f32_16x16x32_bf16 v[224:227], v[12:15], v[200:203], v[224:227]
    v_mul_f32 v210, v219, v210
    v_mul_f32 v212, v219, v212
    v_mfma_f32_16x16x32_bf16 v[232:235], v[36:39], v[200:203], v[232:235]
    v_mul_f32 v205, v218, v205
    v_mul_f32 v211, v219, v211
    v_mfma_f32_16x16x32_bf16 v[244:247], v[196:199], v[44:47], v[244:247]
    v_mul_f32 v206, v218, v206
    v_mul_f32 v213, v219, v213
    v_mfma_f32_16x16x32_bf16 v[244:247], v[200:203], v[48:51], v[244:247]
    v_mul_f32 v207, v218, v207
    v_mul_f32 v214, v219, v214
    v_mfma_f32_16x16x32_bf16 v[248:251], v[196:199], v[56:59], v[248:251]
    ds_read_b128 v[196:199], v101 offset:7168
    v_mfma_f32_16x16x32_bf16 v[248:251], v[200:203], v[60:63], v[248:251]
    v_mul_f32 v215, v219, v215
    v_cvt_pk_bf16_f32 v129, v206, v207
    v_mfma_f32_16x16x32_bf16 v[228:231], v[24:27], v[200:203], v[228:231]
    ds_read_b128 v[200:203], v101 offset:8192
    v_mul_f32 v208, v218, v208
    v_mul_f32 v209, v218, v209
    v_cvt_pk_bf16_f32 v112, v210, v211
    v_cvt_pk_bf16_f32 v128, v204, v205
    s_waitcnt lgkmcnt(2)
    v_mfma_f32_16x16x32_bf16 v[204:207], v[4:7], v[192:195], 0
    v_cvt_pk_bf16_f32 v114, v214, v215
    v_cvt_pk_bf16_f32 v113, v212, v213
    v_mfma_f32_16x16x32_bf16 v[212:215], v[28:31], v[192:195], 0
    v_cvt_pk_bf16_f32 v130, v208, v209
    v_cvt_pk_bf16_f32 v150, v248, v249
    v_mfma_f32_16x16x32_bf16 v[208:211], v[16:19], v[192:195], 0
    v_cvt_pk_bf16_f32 v143, v246, v247
    v_fma_f32 v237, v230, v230, s46
    v_fma_f32 v236, v224, v224, s46
    v_cvt_pk_bf16_f32 v142, v244, v245
    v_mfma_f32_16x16x32_bf16 v[244:247], v[192:195], v[40:43], 0
    v_fmac_f32 v236, v225, v225
    v_fmac_f32 v237, v231, v231
    v_cvt_pk_bf16_f32 v151, v250, v251
    v_mfma_f32_16x16x32_bf16 v[248:251], v[192:195], v[52:55], v[176:179]
    v_fmac_f32 v237, v232, v232
    v_fmac_f32 v237, v233, v233
    v_mfma_f32_16x16x32_bf16 v[192:195], v[112:115], v[128:131], v[64:67]
    v_fmac_f32 v236, v226, v226
    v_fmac_f32 v236, v227, v227
    s_waitcnt lgkmcnt(1)
    v_mfma_f32_16x16x32_bf16 v[208:211], v[20:23], v[196:199], v[208:211]
    v_fmac_f32 v236, v228, v228
    v_fmac_f32 v236, v229, v229
    v_mfma_f32_16x16x32_bf16 v[204:207], v[8:11], v[196:199], v[204:207]
    v_fmac_f32 v237, v234, v234
    v_fmac_f32 v237, v235, v235
    v_mfma_f32_16x16x32_bf16 v[244:247], v[196:199], v[44:47], v[244:247]
    v_cvt_pk_bf16_f32 v190, v236, v237
    s_waitcnt lgkmcnt(0)
    v_mfma_f32_16x16x32_bf16 v[208:211], v[24:27], v[200:203], v[208:211]
    v_mfma_f32_16x16x16_bf16 v[238:241], v[172:173], v[190:191], 0
    v_mfma_f32_16x16x32_bf16 v[204:207], v[12:15], v[200:203], v[204:207]
    v_mfma_f32_16x16x32_bf16 v[212:215], v[32:35], v[196:199], v[212:215]
    v_mfma_f32_16x16x32_bf16 v[212:215], v[36:39], v[200:203], v[212:215]
    v_mfma_f32_16x16x32_bf16 v[248:251], v[196:199], v[56:59], v[248:251]
    v_mfma_f32_16x16x32_bf16 v[248:251], v[200:203], v[60:63], v[248:251]
    s_nop 1
    v_fma_f32 v217, v210, v210, s46
    v_mfma_f32_16x16x32_bf16 v[244:247], v[200:203], v[48:51], v[244:247]
    v_rsq_f32 v238, v238
    v_rsq_f32 v239, v239
    v_mul_f32 v238, s40, v238
    v_mul_f32 v224, v238, v224
    v_mul_f32 v231, v239, v231
    v_mul_f32 v225, v238, v225
    v_mul_f32 v230, v239, v230
    v_mul_f32 v232, v239, v232
    v_mul_f32 v227, v238, v227
    v_mul_f32 v234, v239, v234
    v_mul_f32 v226, v238, v226
    v_mul_f32 v229, v238, v229
    v_mul_f32 v233, v239, v233
    v_cvt_pk_bf16_f32 v132, v224, v225
    v_mul_f32 v228, v238, v228
    v_mul_f32 v235, v239, v235
    v_cvt_pk_bf16_f32 v133, v226, v227
    v_cvt_pk_bf16_f32 v118, v234, v235
    v_cvt_pk_bf16_f32 v116, v230, v231
    v_cvt_pk_bf16_f32 v134, v228, v229
    v_cvt_pk_bf16_f32 v117, v232, v233
    v_cvt_pk_bf16_f32 v144, v244, v245
    v_cvt_pk_bf16_f32 v145, v246, v247
    v_mfma_f32_16x16x32_bf16 v[196:199], v[116:119], v[128:131], v[76:79]
    v_cvt_pk_bf16_f32 v153, v250, v251
    v_fma_f32 v216, v204, v204, s46
    v_cvt_pk_bf16_f32 v152, v248, v249
    v_fmac_f32 v216, v205, v205
    v_fmac_f32 v216, v206, v206
    v_fmac_f32 v217, v211, v211
    v_fmac_f32 v216, v207, v207
    v_fmac_f32 v217, v212, v212
    v_fmac_f32 v217, v213, v213
    v_fmac_f32 v216, v208, v208
    v_fmac_f32 v216, v209, v209
    v_fmac_f32 v217, v214, v214
    v_fmac_f32 v217, v215, v215
    v_cvt_pk_bf16_f32 v188, v216, v217
    s_nop 1
    v_mfma_f32_16x16x16_bf16 v[218:221], v[172:173], v[188:189], 0
    s_nop 7
    v_rsq_f32 v218, v218
    v_rsq_f32 v219, v219
    v_mul_f32 v218, s40, v218
    v_mul_f32 v204, v218, v204
    v_mul_f32 v206, v218, v206
    v_mul_f32 v211, v219, v211
    v_mul_f32 v205, v218, v205
    v_mul_f32 v210, v219, v210
    v_mul_f32 v208, v218, v208
    v_mul_f32 v212, v219, v212
    v_mul_f32 v209, v218, v209
    v_mul_f32 v214, v219, v214
    v_mul_f32 v207, v218, v207
    v_cvt_pk_bf16_f32 v136, v204, v205
    v_mul_f32 v213, v219, v213
    v_cvt_pk_bf16_f32 v120, v210, v211
    v_mul_f32 v215, v219, v215
    v_mfma_f32_16x16x32_bf16 v[216:219], v[124:127], v[128:131], v[100:103]
    v_cvt_pk_bf16_f32 v137, v206, v207
    ds_read_b128 v[204:207], v105
    v_cvt_pk_bf16_f32 v121, v212, v213
    v_cvt_pk_bf16_f32 v138, v208, v209
    v_cvt_pk_bf16_f32 v122, v214, v215
    v_max3_f32 v220, v192, v193, v194
    v_max3_f32 v220, v220, v195, v196
    v_mfma_f32_16x16x32_bf16 v[200:203], v[120:123], v[128:131], v[88:91]
    v_max3_f32 v220, v220, v197, v198
    v_add_u32 v101, s26, v1
    s_nop 5
    v_max3_f32 v220, v220, v199, v200
    v_max3_f32 v220, v220, v201, v202
    v_max3_f32 v220, v220, v203, v216
    v_mov_b32 v217, v220
    s_nop 1
    v_permlane32_swap_b32 v220, v217
    v_max_f32 v220, v220, v217
    v_mov_b32 v217, v220
    s_nop 1
    v_permlane16_swap_b32 v220, v217
    v_max_f32 v220, v220, v217
    v_sub_f32 v196, v196, v220
    v_sub_f32 v193, v193, v220
    v_sub_f32 v192, v192, v220
    v_sub_f32 v194, v194, v220
    v_sub_f32 v195, v195, v220
    v_sub_f32 v199, v199, v220
    v_sub_f32 v200, v200, v220
    v_sub_f32 v198, v198, v220
    s_waitcnt lgkmcnt(0)
    v_mfma_f32_16x16x32_bf16 v[228:231], v[204:207], v[116:119], v[106:109]
    v_sub_f32 v197, v197, v220
    v_sub_f32 v203, v203, v220
    v_mfma_f32_16x16x32_bf16 v[236:239], v[204:207], v[124:127], v[106:109]
    v_sub_f32 v201, v201, v220
    v_sub_f32 v216, v216, v220
    v_mfma_f32_16x16x32_bf16 v[224:227], v[204:207], v[112:115], v[106:109]
    v_sub_f32 v202, v202, v220
    v_exp_f32 v193, v193
    v_mfma_f32_16x16x32_bf16 v[232:235], v[204:207], v[120:123], v[106:109]
    v_exp_f32 v192, v192
    v_exp_f32 v194, v194
    v_exp_f32 v196, v196
    v_exp_f32 v195, v195
    v_exp_f32 v197, v197
    v_bfi_b32 v208, v181, v228, v224
    v_mfma_f32_16x16x32_bf16 v[228:231], v[116:119], v[132:135], v[80:83]
    v_exp_f32 v198, v198
    v_mfma_f32_16x16x32_bf16 v[224:227], v[112:115], v[132:135], v[68:71]
    v_bfi_b32 v209, v181, v236, v232
    v_bfi_b32 v208, v182, v209, v208
    v_mfma_f32_16x16x32_bf16 v[232:235], v[120:123], v[132:135], v[92:95]
    v_mov_b32 v209, v208
    v_exp_f32 v203, v203
    v_mfma_f32_16x16x32_bf16 v[236:239], v[124:127], v[132:135], v[102:105]
    v_max_f32_dpp v209, v209, v209 row_ror:8 row_mask:0xf bank_mask:0xf
    v_exp_f32 v202, v202
    v_exp_f32 v201, v201
    v_max_f32_dpp v209, v209, v209 row_ror:4 row_mask:0xf bank_mask:0xf
    v_exp_f32 v199, v199
    v_exp_f32 v200, v200
    v_max_f32_dpp v209, v209, v209 row_ror:2 row_mask:0xf bank_mask:0xf
    v_cvt_pk_bf16_f32 v157, v194, v195
    v_exp_f32 v216, v216
    v_max_f32_dpp v209, v209, v209 row_ror:1 row_mask:0xf bank_mask:0xf
    v_mov_b32 v210, v209
    v_cvt_pk_bf16_f32 v156, v192, v193
    v_mfma_f32_16x16x32_bf16 v[192:195], v[112:115], v[136:139], v[72:75]
    v_permlane32_swap_b32 v209, v210
    v_max_f32 v209, v209, v210
    v_mov_b32 v210, v209
    v_cvt_pk_bf16_f32 v158, v196, v197
    v_cvt_pk_bf16_f32 v161, v202, v203
    v_permlane16_swap_b32 v209, v210
    v_max_f32 v209, v209, v210
    v_sub_f32 v208, v208, v209
    v_exp_f32 v208, v208
    v_cvt_pk_bf16_f32 v162, v216, 0
    v_cvt_pk_bf16_f32 v240, v208, 0
    ds_write_b16 v185, v240
    ds_read2_b64 v[168:171], v186 offset0:8 offset1:12
    ds_read2_b64 v[164:167], v186 offset0:0 offset1:4
    v_cvt_pk_bf16_f32 v159, v198, v199
    v_mfma_f32_16x16x32_bf16 v[196:199], v[116:119], v[136:139], v[84:87]
    v_cvt_pk_bf16_f32 v160, v200, v201
    v_max3_f32 v240, v224, v225, v226
    v_mfma_f32_16x16x32_bf16 v[248:251], v[148:151], v[156:159], 0
    v_max3_f32 v240, v240, v227, v228
    v_max3_f32 v240, v240, v229, v230
    v_mfma_f32_16x16x32_bf16 v[244:247], v[140:143], v[156:159], 0
    v_max3_f32 v240, v240, v231, v232
    v_max3_f32 v240, v240, v233, v234
    v_mfma_f32_16x16x32_bf16 v[244:247], v[144:147], v[160:163], v[244:247]
    v_max3_f32 v240, v240, v235, v236
    v_mov_b32 v237, v240
    v_mfma_f32_16x16x32_bf16 v[248:251], v[152:155], v[160:163], v[248:251]
    s_nop 0
    v_permlane32_swap_b32 v240, v237
    v_mfma_f32_16x16x32_bf16 v[200:203], v[120:123], v[136:139], v[96:99]
    v_max_f32 v240, v240, v237
    v_mov_b32 v237, v240
    s_nop 1
    v_permlane16_swap_b32 v240, v237
    v_rcp_f32 v220, v250
    v_max_f32 v240, v240, v237
    v_mul_f32 v245, v220, v245
    v_mul_f32 v247, v220, v247
    v_mul_f32 v244, v220, v244
    v_mul_f32 v246, v220, v246
    v_cvt_pk_bf16_f32 v218, v246, v247
    s_waitcnt lgkmcnt(0)
    v_mfma_f32_16x16x32_bf16 v[204:207], v[140:143], v[164:167], 0
    v_mul_f32 v249, v220, v249
    v_mul_f32 v248, v220, v248
    v_mfma_f32_16x16x32_bf16 v[204:207], v[144:147], v[168:171], v[204:207]
    v_cvt_pk_bf16_f32 v219, v248, v249
    ds_write_b32 v103, v219 offset:512
    v_mfma_f32_16x16x32_bf16 v[208:211], v[148:151], v[164:167], 0
    v_cvt_pk_bf16_f32 v217, v244, v245
    ds_write2_b32 v103, v217, v218 offset0:0 offset1:64
    v_mfma_f32_16x16x32_bf16 v[208:211], v[152:155], v[168:171], v[208:211]
    v_sub_f32 v225, v225, v240
    v_sub_f32 v224, v224, v240
    v_mfma_f32_16x16x32_bf16 v[216:219], v[124:127], v[136:139], v[104:107]
    v_sub_f32 v227, v227, v240
    v_sub_f32 v229, v229, v240
    v_sub_f32 v226, v226, v240
    v_sub_f32 v232, v232, v240
    v_sub_f32 v230, v230, v240
    v_rcp_f32 v252, v210
    v_sub_f32 v228, v228, v240
    v_mul_f32 v204, v252, v204
    v_mul_f32 v206, v252, v206
    v_mul_f32 v208, v252, v208
    v_mul_f32 v205, v252, v205
    v_cvt_pk_bf16_f32 v253, v204, v205
    v_mul_f32 v207, v252, v207
    v_cvt_pk_bf16_f32 v254, v206, v207
    v_mul_f32 v209, v252, v209
    v_cvt_pk_bf16_f32 v255, v208, v209
    s_mov_b64 exec, s[42:43]
    ds_write2_b32 v103, v253, v254 offset0:48 offset1:112
    ds_write_b32 v103, v255 offset:704
    s_mov_b64 exec, -1
    v_sub_f32 v231, v231, v240
    v_sub_f32 v233, v233, v240
    v_exp_f32 v225, v225
    v_sub_f32 v236, v236, v240
    v_sub_f32 v234, v234, v240
    v_exp_f32 v224, v224
    v_sub_f32 v235, v235, v240
    v_exp_f32 v228, v228
    v_exp_f32 v226, v226
    v_exp_f32 v229, v229
    v_exp_f32 v231, v231
    v_exp_f32 v227, v227
    v_exp_f32 v232, v232
    v_exp_f32 v234, v234
    v_exp_f32 v230, v230
    v_exp_f32 v233, v233
    v_exp_f32 v236, v236
    v_exp_f32 v235, v235
    v_cvt_pk_bf16_f32 v164, v224, v225
    v_cvt_pk_bf16_f32 v165, v226, v227
    v_cvt_pk_bf16_f32 v167, v230, v231
    v_cvt_pk_bf16_f32 v166, v228, v229
    v_cvt_pk_bf16_f32 v168, v232, v233
    v_cvt_pk_bf16_f32 v169, v234, v235
    v_mfma_f32_16x16x32_bf16 v[208:211], v[148:151], v[164:167], 0
    v_cvt_pk_bf16_f32 v170, v236, 0
    v_max3_f32 v220, v192, v193, v194
    v_mfma_f32_16x16x32_bf16 v[204:207], v[140:143], v[164:167], 0
    v_max3_f32 v220, v220, v195, v196
    v_max3_f32 v220, v220, v197, v198
    v_mfma_f32_16x16x32_bf16 v[204:207], v[144:147], v[168:171], v[204:207]
    v_max3_f32 v220, v220, v199, v200
    v_max3_f32 v220, v220, v201, v202
    v_mfma_f32_16x16x32_bf16 v[208:211], v[152:155], v[168:171], v[208:211]
    v_max3_f32 v220, v220, v203, v216
    v_mov_b32 v217, v220
    v_mov_b32_dpp v127, v127 row_ror:4 row_mask:0xf bank_mask:0xf
    v_add_u32 v105, 64, v105
    v_permlane32_swap_b32 v220, v217
    v_max_f32 v220, v220, v217
    v_mov_b32 v217, v220
    s_nop 0
    v_rcp_f32 v240, v210
    v_permlane16_swap_b32 v220, v217
    v_mul_f32 v209, v240, v209
    v_mul_f32 v206, v240, v206
    v_mul_f32 v204, v240, v204
    v_mul_f32 v208, v240, v208
    v_mul_f32 v205, v240, v205
    v_cvt_pk_bf16_f32 v237, v204, v205
    v_mul_f32 v207, v240, v207
    v_cvt_pk_bf16_f32 v239, v208, v209
    ds_write_b32 v103, v239 offset:576
    v_cvt_pk_bf16_f32 v238, v206, v207
    ds_write2_b32 v103, v237, v238 offset0:16 offset1:80
    v_max_f32 v220, v220, v217
    v_sub_f32 v192, v192, v220
    v_sub_f32 v193, v193, v220
    v_sub_f32 v195, v195, v220
    v_sub_f32 v194, v194, v220
    v_sub_f32 v196, v196, v220
    v_sub_f32 v200, v200, v220
    v_sub_f32 v197, v197, v220
    v_sub_f32 v198, v198, v220
    v_sub_f32 v199, v199, v220
    v_exp_f32 v193, v193
    v_sub_f32 v203, v203, v220
    v_sub_f32 v201, v201, v220
    v_sub_f32 v202, v202, v220
    v_sub_f32 v216, v216, v220
    v_exp_f32 v192, v192
    v_exp_f32 v195, v195
    v_exp_f32 v194, v194
    v_exp_f32 v197, v197
    v_exp_f32 v196, v196
    v_exp_f32 v199, v199
    v_exp_f32 v200, v200
    v_exp_f32 v198, v198
    v_exp_f32 v216, v216
    v_cvt_pk_bf16_f32 v156, v192, v193
    v_cvt_pk_bf16_f32 v157, v194, v195
    ds_read_b128 v[192:195], v101 offset:0
    v_exp_f32 v201, v201
    v_exp_f32 v203, v203
    v_exp_f32 v202, v202
    v_cvt_pk_bf16_f32 v160, v200, v201
    v_cvt_pk_bf16_f32 v158, v196, v197
    v_cvt_pk_bf16_f32 v159, v198, v199
    ds_read_b128 v[196:199], v101 offset:1024
    v_cvt_pk_bf16_f32 v162, v216, 0
    v_mfma_f32_16x16x32_bf16 v[244:247], v[140:143], v[156:159], 0
    v_cvt_pk_bf16_f32 v161, v202, v203
    ds_read_b128 v[200:203], v101 offset:2048
    v_mfma_f32_16x16x32_bf16 v[248:251], v[148:151], v[156:159], 0
    v_mfma_f32_16x16x32_bf16 v[244:247], v[144:147], v[160:163], v[244:247]
    v_mfma_f32_16x16x32_bf16 v[248:251], v[152:155], v[160:163], v[248:251]
    s_nop 7
    v_rcp_f32 v220, v250
    s_nop 0
    v_mul_f32 v246, v220, v246
    s_waitcnt lgkmcnt(2)
    v_mfma_f32_16x16x32_bf16 v[208:211], v[16:19], v[192:195], 0
    v_mul_f32 v247, v220, v247
    v_mul_f32 v245, v220, v245
    v_mfma_f32_16x16x32_bf16 v[204:207], v[4:7], v[192:195], 0
    v_mul_f32 v244, v220, v244
    v_mul_f32 v249, v220, v249
    v_mfma_f32_16x16x32_bf16 v[212:215], v[28:31], v[192:195], 0
    v_mul_f32 v248, v220, v248
    v_cvt_pk_bf16_f32 v219, v248, v249
    ds_write_b32 v103, v219 offset:640
    s_waitcnt lgkmcnt(2)
    v_mfma_f32_16x16x32_bf16 v[208:211], v[20:23], v[196:199], v[208:211]
    v_cvt_pk_bf16_f32 v218, v246, v247
    v_cvt_pk_bf16_f32 v217, v244, v245
    ds_write2_b32 v103, v217, v218 offset0:32 offset1:96
    s_waitcnt lgkmcnt(2)
    v_mfma_f32_16x16x32_bf16 v[208:211], v[24:27], v[200:203], v[208:211]
    v_add_u32 v103, s78, v103
    s_sub_u32 s78, 0, s78
    v_mfma_f32_16x16x32_bf16 v[204:207], v[8:11], v[196:199], v[204:207]
    v_mfma_f32_16x16x32_bf16 v[204:207], v[12:15], v[200:203], v[204:207]
    v_mfma_f32_16x16x32_bf16 v[212:215], v[32:35], v[196:199], v[212:215]
    v_mfma_f32_16x16x32_bf16 v[212:215], v[36:39], v[200:203], v[212:215]
    s_waitcnt lgkmcnt(0)
    s_barrier
L_M_BODY2_S:
    v_mfma_f32_16x16x32_bf16 v[244:247], v[192:195], v[40:43], 0
    s_add_u32 s26, s26, 9216
    s_cmp_eq_u32 s26, 73728
    v_mfma_f32_16x16x32_bf16 v[248:251], v[192:195], v[52:55], v[176:179]
    ds_read_b128 v[192:195], v101 offset:3072
    v_mfma_f32_16x16x32_bf16 v[244:247], v[196:199], v[44:47], v[244:247]
    s_cselect_b32 s26, 0, s26
    s_add_u32 s24, s24, 1
    v_mfma_f32_16x16x32_bf16 v[248:251], v[196:199], v[56:59], v[248:251]
    ds_read_b128 v[196:199], v101 offset:4096
    v_mfma_f32_16x16x32_bf16 v[244:247], v[200:203], v[48:51], v[244:247]
    v_fma_f32 v217, v210, v210, s46
    v_fma_f32 v216, v204, v204, s46
    v_mfma_f32_16x16x32_bf16 v[248:251], v[200:203], v[60:63], v[248:251]
    ds_read_b128 v[200:203], v101 offset:5120
    v_fmac_f32 v216, v205, v205
    v_fmac_f32 v216, v206, v206
    v_fmac_f32 v216, v207, v207
    v_fmac_f32 v216, v208, v208
    v_cvt_pk_bf16_f32 v141, v246, v247
    v_cvt_pk_bf16_f32 v140, v244, v245
    v_fmac_f32 v216, v209, v209
    v_cvt_pk_bf16_f32 v149, v250, v251
    v_cvt_pk_bf16_f32 v148, v248, v249
    v_fmac_f32 v217, v211, v211
    v_fmac_f32 v217, v212, v212
    v_fmac_f32 v217, v213, v213
    v_fmac_f32 v217, v214, v214
    v_fmac_f32 v217, v215, v215
    v_cvt_pk_bf16_f32 v188, v216, v217
    s_nop 1
    v_mfma_f32_16x16x16_bf16 v[218:221], v[172:173], v[188:189], 0
    s_waitcnt lgkmcnt(2)
    v_mfma_f32_16x16x32_bf16 v[224:227], v[4:7], v[192:195], 0
    v_mfma_f32_16x16x32_bf16 v[228:231], v[16:19], v[192:195], 0
    v_mfma_f32_16x16x32_bf16 v[244:247], v[192:195], v[40:43], 0
    v_mfma_f32_16x16x32_bf16 v[232:235], v[28:31], v[192:195], 0
    v_mfma_f32_16x16x32_bf16 v[248:251], v[192:195], v[52:55], v[176:179]
    ds_read_b128 v[192:195], v101 offset:6144
    s_waitcnt lgkmcnt(2)
    v_mfma_f32_16x16x32_bf16 v[224:227], v[8:11], v[196:199], v[224:227]
    v_rsq_f32 v219, v219
    v_mfma_f32_16x16x32_bf16 v[232:235], v[32:35], v[196:199], v[232:235]
    v_rsq_f32 v218, v218
    v_mfma_f32_16x16x32_bf16 v[228:231], v[20:23], v[196:199], v[228:231]
    v_mul_f32 v218, s40, v218
    v_mul_f32 v204, v218, v204
    s_waitcnt lgkmcnt(1)
    v_mfma_f32_16x16x32_bf16 v[224:227], v[12:15], v[200:203], v[224:227]
    v_mul_f32 v210, v219, v210
    v_mul_f32 v212, v219, v212
    v_mfma_f32_16x16x32_bf16 v[232:235], v[36:39], v[200:203], v[232:235]
    v_mul_f32 v205, v218, v205
    v_mul_f32 v211, v219, v211
    v_mfma_f32_16x16x32_bf16 v[244:247], v[196:199], v[44:47], v[244:247]
    v_mul_f32 v206, v218, v206
    v_mul_f32 v213, v219, v213
    v_mfma_f32_16x16x32_bf16 v[244:247], v[200:203], v[48:51], v[244:247]
    v_mul_f32 v207, v218, v207
    v_mul_f32 v214, v219, v214
    v_mfma_f32_16x16x32_bf16 v[248:251], v[196:199], v[56:59], v[248:251]
    ds_read_b128 v[196:199], v101 offset:7168
    v_mfma_f32_16x16x32_bf16 v[248:251], v[200:203], v[60:63], v[248:251]
    v_mul_f32 v215, v219, v215
    v_cvt_pk_bf16_f32 v129, v206, v207
    v_mfma_f32_16x16x32_bf16 v[228:231], v[24:27], v[200:203], v[228:231]
    ds_read_b128 v[200:203], v101 offset:8192
    v_mul_f32 v208, v218, v208
    v_mul_f32 v209, v218, v209
    v_cvt_pk_bf16_f32 v112, v210, v211
    v_cvt_pk_bf16_f32 v128, v204, v205
    s_waitcnt lgkmcnt(2)
    v_mfma_f32_16x16x32_bf16 v[204:207], v[4:7], v[192:195], 0
    v_cvt_pk_bf16_f32 v114, v214, v215
    v_cvt_pk_bf16_f32 v113, v212, v213
    v_mfma_f32_16x16x32_bf16 v[212:215], v[28:31], v[192:195], 0
    v_cvt_pk_bf16_f32 v130, v208, v209
    v_cvt_pk_bf16_f32 v150, v248, v249
    v_mfma_f32_16x16x32_bf16 v[208:211], v[16:19], v[192:195], 0
    v_cvt_pk_bf16_f32 v143, v246, v247
    v_fma_f32 v237, v230, v230, s46
    v_fma_f32 v236, v224, v224, s46
    v_cvt_pk_bf16_f32 v142, v244, v245
    v_mfma_f32_16x16x32_bf16 v[244:247], v[192:195], v[40:43], 0
    v_fmac_f32 v236, v225, v225
    v_fmac_f32 v237, v231, v231
    v_cvt_pk_bf16_f32 v151, v250, v251
    v_mfma_f32_16x16x32_bf16 v[248:251], v[192:195], v[52:55], v[176:179]
    v_fmac_f32 v237, v232, v232
    v_fmac_f32 v237, v233, v233
    v_mfma_f32_16x16x32_bf16 v[192:195], v[112:115], v[128:131], v[64:67]
    v_fmac_f32 v236, v226, v226
    v_fmac_f32 v236, v227, v227
    s_waitcnt lgkmcnt(1)
    v_mfma_f32_16x16x32_bf16 v[208:211], v[20:23], v[196:199], v[208:211]
    v_fmac_f32 v236, v228, v228
    v_fmac_f32 v236, v229, v229
    v_mfma_f32_16x16x32_bf16 v[204:207], v[8:11], v[196:199], v[204:207]
    v_fmac_f32 v237, v234, v234
    v_fmac_f32 v237, v235, v235
    v_mfma_f32_16x16x32_bf16 v[244:247], v[196:199], v[44:47], v[244:247]
    v_cvt_pk_bf16_f32 v190, v236, v237
    s_waitcnt lgkmcnt(0)
    v_mfma_f32_16x16x32_bf16 v[208:211], v[24:27], v[200:203], v[208:211]
    v_mfma_f32_16x16x16_bf16 v[238:241], v[172:173], v[190:191], 0
    v_mfma_f32_16x16x32_bf16 v[204:207], v[12:15], v[200:203], v[204:207]
    v_mfma_f32_16x16x32_bf16 v[212:215], v[32:35], v[196:199], v[212:215]
    v_mfma_f32_16x16x32_bf16 v[212:215], v[36:39], v[200:203], v[212:215]
    v_mfma_f32_16x16x32_bf16 v[248:251], v[196:199], v[56:59], v[248:251]
    v_mfma_f32_16x16x32_bf16 v[248:251], v[200:203], v[60:63], v[248:251]
    s_nop 1
    v_fma_f32 v217, v210, v210, s46
    v_mfma_f32_16x16x32_bf16 v[244:247], v[200:203], v[48:51], v[244:247]
    v_rsq_f32 v238, v238
    v_rsq_f32 v239, v239
    v_mul_f32 v238, s40, v238
    v_mul_f32 v224, v238, v224
    v_mul_f32 v231, v239, v231
    v_mul_f32 v225, v238, v225
    v_mul_f32 v230, v239, v230
    v_mul_f32 v232, v239, v232
    v_mul_f32 v227, v238, v227
    v_mul_f32 v234, v239, v234
    v_mul_f32 v226, v238, v226
    v_mul_f32 v229, v238, v229
    v_mul_f32 v233, v239, v233
    v_cvt_pk_bf16_f32 v132, v224, v225
    v_mul_f32 v228, v238, v228
    v_mul_f32 v235, v239, v235
    v_cvt_pk_bf16_f32 v133, v226, v227
    v_cvt_pk_bf16_f32 v118, v234, v235
    v_cvt_pk_bf16_f32 v116, v230, v231
    v_cvt_pk_bf16_f32 v134, v228, v229
    v_cvt_pk_bf16_f32 v117, v232, v233
    v_cvt_pk_bf16_f32 v144, v244, v245
    v_cvt_pk_bf16_f32 v145, v246, v247
    v_mfma_f32_16x16x32_bf16 v[196:199], v[116:119], v[128:131], v[76:79]
    v_cvt_pk_bf16_f32 v153, v250, v251
    v_fma_f32 v216, v204, v204, s46
    v_cvt_pk_bf16_f32 v152, v248, v249
    v_fmac_f32 v216, v205, v205
    v_fmac_f32 v216, v206, v206
    v_fmac_f32 v217, v211, v211
    v_fmac_f32 v216, v207, v207
    v_fmac_f32 v217, v212, v212
    v_fmac_f32 v217, v213, v213
    v_fmac_f32 v216, v208, v208
    v_fmac_f32 v216, v209, v209
    v_fmac_f32 v217, v214, v214
    v_fmac_f32 v217, v215, v215
    v_cvt_pk_bf16_f32 v188, v216, v217
    s_nop 1
    v_mfma_f32_16x16x16_bf16 v[218:221], v[172:173], v[188:189], 0
    s_nop 7
    v_rsq_f32 v218, v218
    v_rsq_f32 v219, v219
    v_mul_f32 v218, s40, v218
    v_mul_f32 v204, v218, v204
    v_mul_f32 v206, v218, v206
    v_mul_f32 v211, v219, v211
    v_mul_f32 v205, v218, v205
    v_mul_f32 v210, v219, v210
    v_mul_f32 v208, v218, v208
    v_mul_f32 v212, v219, v212
    v_mul_f32 v209, v218, v209
    v_mul_f32 v214, v219, v214
    v_mul_f32 v207, v218, v207
    v_cvt_pk_bf16_f32 v136, v204, v205
    v_mul_f32 v213, v219, v213
    v_cvt_pk_bf16_f32 v120, v210, v211
    v_mul_f32 v215, v219, v215
    v_mfma_f32_16x16x32_bf16 v[216:219], v[124:127], v[128:131], v[100:103]
    v_cvt_pk_bf16_f32 v137, v206, v207
    ds_read_b128 v[204:207], v105
    v_cvt_pk_bf16_f32 v121, v212, v213
    v_cvt_pk_bf16_f32 v138, v208, v209
    v_cvt_pk_bf16_f32 v122, v214, v215
    v_max3_f32 v220, v192, v193, v194
    v_max3_f32 v220, v220, v195, v196
    v_mfma_f32_16x16x32_bf16 v[200:203], v[120:123], v[128:131], v[88:91]
    v_max3_f32 v220, v220, v197, v198
    v_add_u32 v101, s26, v1
    s_nop 5
    v_max3_f32 v220, v220, v199, v200
    v_max3_f32 v220, v220, v201, v202
    v_max3_f32 v220, v220, v203, v216
    v_mov_b32 v217, v220
    s_nop 1
    v_permlane32_swap_b32 v220, v217
    v_max_f32 v220, v220, v217
    v_mov_b32 v217, v220
    s_nop 1
    v_permlane16_swap_b32 v220, v217
    v_max_f32 v220, v220, v217
    v_sub_f32 v196, v196, v220
    v_sub_f32 v193, v193, v220
    v_sub_f32 v192, v192, v220
    v_sub_f32 v194, v194, v220
    v_sub_f32 v195, v195, v220
    v_sub_f32 v199, v199, v220
    v_sub_f32 v200, v200, v220
    v_sub_f32 v198, v198, v220
    s_waitcnt lgkmcnt(0)
    v_mfma_f32_16x16x32_bf16 v[228:231], v[204:207], v[116:119], v[106:109]
    v_sub_f32 v197, v197, v220
    v_sub_f32 v203, v203, v220
    v_mfma_f32_16x16x32_bf16 v[236:239], v[204:207], v[124:127], v[106:109]
    v_sub_f32 v201, v201, v220
    v_sub_f32 v216, v216, v220
    v_mfma_f32_16x16x32_bf16 v[224:227], v[204:207], v[112:115], v[106:109]
    v_sub_f32 v202, v202, v220
    v_exp_f32 v193, v193
    v_mfma_f32_16x16x32_bf16 v[232:235], v[204:207], v[120:123], v[106:109]
    v_exp_f32 v192, v192
    v_exp_f32 v194, v194
    v_exp_f32 v196, v196
    v_exp_f32 v195, v195
    v_exp_f32 v197, v197
    v_bfi_b32 v208, v181, v228, v224
    v_mfma_f32_16x16x32_bf16 v[228:231], v[116:119], v[132:135], v[80:83]
    v_exp_f32 v198, v198
    v_mfma_f32_16x16x32_bf16 v[224:227], v[112:115], v[132:135], v[68:71]
    v_bfi_b32 v209, v181, v236, v232
    v_bfi_b32 v208, v182, v209, v208
    v_mfma_f32_16x16x32_bf16 v[232:235], v[120:123], v[132:135], v[92:95]
    v_mov_b32 v209, v208
    v_exp_f32 v203, v203
    v_mfma_f32_16x16x32_bf16 v[236:239], v[124:127], v[132:135], v[102:105]
    v_max_f32_dpp v209, v209, v209 row_ror:8 row_mask:0xf bank_mask:0xf
    v_exp_f32 v202, v202
    v_exp_f32 v201, v201
    v_max_f32_dpp v209, v209, v209 row_ror:4 row_mask:0xf bank_mask:0xf
    v_exp_f32 v199, v199
    v_exp_f32 v200, v200
    v_max_f32_dpp v209, v209, v209 row_ror:2 row_mask:0xf bank_mask:0xf
    v_cvt_pk_bf16_f32 v157, v194, v195
    v_exp_f32 v216, v216
    v_max_f32_dpp v209, v209, v209 row_ror:1 row_mask:0xf bank_mask:0xf
    v_mov_b32 v210, v209
    v_cvt_pk_bf16_f32 v156, v192, v193
    v_mfma_f32_16x16x32_bf16 v[192:195], v[112:115], v[136:139], v[72:75]
    v_permlane32_swap_b32 v209, v210
    v_max_f32 v209, v209, v210
    v_mov_b32 v210, v209
    v_cvt_pk_bf16_f32 v158, v196, v197
    v_cvt_pk_bf16_f32 v161, v202, v203
    v_permlane16_swap_b32 v209, v210
    v_max_f32 v209, v209, v210
    v_sub_f32 v208, v208, v209
    v_exp_f32 v208, v208
    v_cvt_pk_bf16_f32 v162, v216, 0
    v_cvt_pk_bf16_f32 v240, v208, 0
    ds_write_b16 v185, v240
    ds_read2_b64 v[168:171], v186 offset0:8 offset1:12
    ds_read2_b64 v[164:167], v186 offset0:0 offset1:4
    v_cvt_pk_bf16_f32 v159, v198, v199
    v_mfma_f32_16x16x32_bf16 v[196:199], v[116:119], v[136:139], v[84:87]
    v_cvt_pk_bf16_f32 v160, v200, v201
    v_max3_f32 v240, v224, v225, v226
    v_mfma_f32_16x16x32_bf16 v[248:251], v[148:151], v[156:159], 0
    v_max3_f32 v240, v240, v227, v228
    v_max3_f32 v240, v240, v229, v230
    v_mfma_f32_16x16x32_bf16 v[244:247], v[140:143], v[156:159], 0
    v_max3_f32 v240, v240, v231, v232
    v_max3_f32 v240, v240, v233, v234
    v_mfma_f32_16x16x32_bf16 v[244:247], v[144:147], v[160:163], v[244:247]
    v_max3_f32 v240, v240, v235, v236
    v_mov_b32 v237, v240
    v_mfma_f32_16x16x32_bf16 v[248:251], v[152:155], v[160:163], v[248:251]
    s_nop 0
    v_permlane32_swap_b32 v240, v237
    v_mfma_f32_16x16x32_bf16 v[200:203], v[120:123], v[136:139], v[96:99]
    v_max_f32 v240, v240, v237
    v_mov_b32 v237, v240
    s_nop 1
    v_permlane16_swap_b32 v240, v237
    v_rcp_f32 v220, v250
    v_max_f32 v240, v240, v237
    v_mul_f32 v245, v220, v245
    v_mul_f32 v247, v220, v247
    v_mul_f32 v244, v220, v244
    v_mul_f32 v246, v220, v246
    v_cvt_pk_bf16_f32 v218, v246, v247
    s_waitcnt lgkmcnt(0)
    v_mfma_f32_16x16x32_bf16 v[204:207], v[140:143], v[164:167], 0
    v_mul_f32 v249, v220, v249
    v_mul_f32 v248, v220, v248
    v_mfma_f32_16x16x32_bf16 v[204:207], v[144:147], v[168:171], v[204:207]
    v_cvt_pk_bf16_f32 v219, v248, v249
    ds_write_b32 v103, v219 offset:512
    v_mfma_f32_16x16x32_bf16 v[208:211], v[148:151], v[164:167], 0
    v_cvt_pk_bf16_f32 v217, v244, v245
    ds_write2_b32 v103, v217, v218 offset0:0 offset1:64
    v_mfma_f32_16x16x32_bf16 v[208:211], v[152:155], v[168:171], v[208:211]
    v_sub_f32 v225, v225, v240
    v_sub_f32 v224, v224, v240
    v_mfma_f32_16x16x32_bf16 v[216:219], v[124:127], v[136:139], v[104:107]
    v_sub_f32 v227, v227, v240
    v_sub_f32 v229, v229, v240
    v_sub_f32 v226, v226, v240
    v_sub_f32 v232, v232, v240
    v_sub_f32 v230, v230, v240
    v_rcp_f32 v252, v210
    v_sub_f32 v228, v228, v240
    v_mul_f32 v204, v252, v204
    v_mul_f32 v206, v252, v206
    v_mul_f32 v208, v252, v208
    v_mul_f32 v205, v252, v205
    v_cvt_pk_bf16_f32 v253, v204, v205
    v_mul_f32 v207, v252, v207
    v_cvt_pk_bf16_f32 v254, v206, v207
    v_mul_f32 v209, v252, v209
    v_cvt_pk_bf16_f32 v255, v208, v209
    s_mov_b64 exec, s[42:43]
    ds_write2_b32 v103, v253, v254 offset0:48 offset1:112
    ds_write_b32 v103, v255 offset:704
    s_mov_b64 exec, -1
    v_sub_f32 v231, v231, v240
    v_sub_f32 v233, v233, v240
    v_exp_f32 v225, v225
    v_sub_f32 v236, v236, v240
    v_sub_f32 v234, v234, v240
    v_exp_f32 v224, v224
    v_sub_f32 v235, v235, v240
    v_exp_f32 v228, v228
    v_exp_f32 v226, v226
    v_exp_f32 v229, v229
    v_exp_f32 v231, v231
    v_exp_f32 v227, v227
    v_exp_f32 v232, v232
    v_exp_f32 v234, v234
    v_exp_f32 v230, v230
    v_exp_f32 v233, v233
    v_exp_f32 v236, v236
    v_exp_f32 v235, v235
    v_cvt_pk_bf16_f32 v164, v224, v225
    v_cvt_pk_bf16_f32 v165, v226, v227
    v_cvt_pk_bf16_f32 v167, v230, v231
    v_cvt_pk_bf16_f32 v166, v228, v229
    v_cvt_pk_bf16_f32 v168, v232, v233
    v_cvt_pk_bf16_f32 v169, v234, v235
    v_mfma_f32_16x16x32_bf16 v[208:211], v[148:151], v[164:167], 0
    v_cvt_pk_bf16_f32 v170, v236, 0
    v_max3_f32 v220, v192, v193, v194
    v_mfma_f32_16x16x32_bf16 v[204:207], v[140:143], v[164:167], 0
    v_max3_f32 v220, v220, v195, v196
    v_max3_f32 v220, v220, v197, v198
    v_mfma_f32_16x16x32_bf16 v[204:207], v[144:147], v[168:171], v[204:207]
    v_max3_f32 v220, v220, v199, v200
    v_max3_f32 v220, v220, v201, v202
    v_mfma_f32_16x16x32_bf16 v[208:211], v[152:155], v[168:171], v[208:211]
    v_max3_f32 v220, v220, v203, v216
    v_mov_b32 v217, v220
    v_mov_b32_dpp v127, v127 row_ror:4 row_mask:0xf bank_mask:0xf
    v_add_u32 v105, 64, v105
    v_permlane32_swap_b32 v220, v217
    v_max_f32 v220, v220, v217
    v_mov_b32 v217, v220
    s_nop 0
    v_rcp_f32 v240, v210
    v_permlane16_swap_b32 v220, v217
    v_mul_f32 v209, v240, v209
    v_mul_f32 v206, v240, v206
    v_mul_f32 v204, v240, v204
    v_mul_f32 v208, v240, v208
    v_mul_f32 v205, v240, v205
    v_cvt_pk_bf16_f32 v237, v204, v205
    v_mul_f32 v207, v240, v207
    v_cvt_pk_bf16_f32 v239, v208, v209
    ds_write_b32 v103, v239 offset:576
    v_cvt_pk_bf16_f32 v238, v206, v207
    ds_write2_b32 v103, v237, v238 offset0:16 offset1:80
    v_max_f32 v220, v220, v217
    v_sub_f32 v192, v192, v220
    v_sub_f32 v193, v193, v220
    v_sub_f32 v195, v195, v220
    v_sub_f32 v194, v194, v220
    v_sub_f32 v196, v196, v220
    v_sub_f32 v200, v200, v220
    v_sub_f32 v197, v197, v220
    v_sub_f32 v198, v198, v220
    v_sub_f32 v199, v199, v220
    v_exp_f32 v193, v193
    v_sub_f32 v203, v203, v220
    v_sub_f32 v201, v201, v220
    v_sub_f32 v202, v202, v220
    v_sub_f32 v216, v216, v220
    v_exp_f32 v192, v192
    v_exp_f32 v195, v195
    v_exp_f32 v194, v194
    v_exp_f32 v197, v197
    v_exp_f32 v196, v196
    v_exp_f32 v199, v199
    v_exp_f32 v200, v200
    v_exp_f32 v198, v198
    v_exp_f32 v216, v216
    v_cvt_pk_bf16_f32 v156, v192, v193
    v_cvt_pk_bf16_f32 v157, v194, v195
    ds_read_b128 v[192:195], v101 offset:0
    v_exp_f32 v201, v201
    v_exp_f32 v203, v203
    v_exp_f32 v202, v202
    v_cvt_pk_bf16_f32 v160, v200, v201
    v_cvt_pk_bf16_f32 v158, v196, v197
    v_cvt_pk_bf16_f32 v159, v198, v199
    ds_read_b128 v[196:199], v101 offset:1024
    v_cvt_pk_bf16_f32 v162, v216, 0
    v_mfma_f32_16x16x32_bf16 v[244:247], v[140:143], v[156:159], 0
    v_cvt_pk_bf16_f32 v161, v202, v203
    ds_read_b128 v[200:203], v101 offset:2048
    v_mfma_f32_16x16x32_bf16 v[248:251], v[148:151], v[156:159], 0
    v_mfma_f32_16x16x32_bf16 v[244:247], v[144:147], v[160:163], v[244:247]
    v_mfma_f32_16x16x32_bf16 v[248:251], v[152:155], v[160:163], v[248:251]
    s_nop 7
    v_rcp_f32 v220, v250
    s_nop 0
    v_mul_f32 v246, v220, v246
    s_waitcnt lgkmcnt(2)
    v_mfma_f32_16x16x32_bf16 v[208:211], v[16:19], v[192:195], 0
    v_mul_f32 v247, v220, v247
    v_mul_f32 v245, v220, v245
    v_mfma_f32_16x16x32_bf16 v[204:207], v[4:7], v[192:195], 0
    v_mul_f32 v244, v220, v244
    v_mul_f32 v249, v220, v249
    v_mfma_f32_16x16x32_bf16 v[212:215], v[28:31], v[192:195], 0
    v_mul_f32 v248, v220, v248
    v_cvt_pk_bf16_f32 v219, v248, v249
    ds_write_b32 v103, v219 offset:640
    s_waitcnt lgkmcnt(2)
    v_mfma_f32_16x16x32_bf16 v[208:211], v[20:23], v[196:199], v[208:211]
    v_cvt_pk_bf16_f32 v218, v246, v247
    v_cvt_pk_bf16_f32 v217, v244, v245
    ds_write2_b32 v103, v217, v218 offset0:32 offset1:96
    s_waitcnt lgkmcnt(2)
    v_mfma_f32_16x16x32_bf16 v[208:211], v[24:27], v[200:203], v[208:211]
    v_add_u32 v103, s78, v103
    s_sub_u32 s78, 0, s78
    v_mfma_f32_16x16x32_bf16 v[204:207], v[8:11], v[196:199], v[204:207]
    v_mfma_f32_16x16x32_bf16 v[204:207], v[12:15], v[200:203], v[204:207]
    v_mfma_f32_16x16x32_bf16 v[212:215], v[32:35], v[196:199], v[212:215]
    v_mfma_f32_16x16x32_bf16 v[212:215], v[36:39], v[200:203], v[212:215]
    s_waitcnt lgkmcnt(0)
    s_barrier
L_M_BODY3_S:
    v_mfma_f32_16x16x32_bf16 v[244:247], v[192:195], v[40:43], 0
    s_add_u32 s26, s26, 9216
    s_cmp_eq_u32 s26, 73728
    v_mfma_f32_16x16x32_bf16 v[248:251], v[192:195], v[52:55], v[176:179]
    ds_read_b128 v[192:195], v101 offset:3072
    v_mfma_f32_16x16x32_bf16 v[244:247], v[196:199], v[44:47], v[244:247]
    s_cselect_b32 s26, 0, s26
    s_add_u32 s24, s24, 1
    v_mfma_f32_16x16x32_bf16 v[248:251], v[196:199], v[56:59], v[248:251]
    ds_read_b128 v[196:199], v101 offset:4096
    v_mfma_f32_16x16x32_bf16 v[244:247], v[200:203], v[48:51], v[244:247]
    v_fma_f32 v217, v210, v210, s46
    v_fma_f32 v216, v204, v204, s46
    v_mfma_f32_16x16x32_bf16 v[248:251], v[200:203], v[60:63], v[248:251]
    ds_read_b128 v[200:203], v101 offset:5120
    v_fmac_f32 v216, v205, v205
    v_fmac_f32 v216, v206, v206
    v_fmac_f32 v216, v207, v207
    v_fmac_f32 v216, v208, v208
    v_cvt_pk_bf16_f32 v141, v246, v247
    v_cvt_pk_bf16_f32 v140, v244, v245
    v_fmac_f32 v216, v209, v209
    v_cvt_pk_bf16_f32 v149, v250, v251
    v_cvt_pk_bf16_f32 v148, v248, v249
    v_fmac_f32 v217, v211, v211
    v_fmac_f32 v217, v212, v212
    v_fmac_f32 v217, v213, v213
    v_fmac_f32 v217, v214, v214
    v_fmac_f32 v217, v215, v215
    v_cvt_pk_bf16_f32 v188, v216, v217
    v_alignbit_b32 v111, v147, v146, 16
    s_nop 0
    v_mfma_f32_16x16x16_bf16 v[218:221], v[172:173], v[188:189], 0
    s_waitcnt lgkmcnt(2)
    v_mfma_f32_16x16x32_bf16 v[224:227], v[4:7], v[192:195], 0
    v_mfma_f32_16x16x32_bf16 v[228:231], v[16:19], v[192:195], 0
    v_mfma_f32_16x16x32_bf16 v[244:247], v[192:195], v[40:43], 0
    v_mfma_f32_16x16x32_bf16 v[232:235], v[28:31], v[192:195], 0
    v_mfma_f32_16x16x32_bf16 v[248:251], v[192:195], v[52:55], v[176:179]
    ds_read_b128 v[192:195], v101 offset:6144
    s_waitcnt lgkmcnt(2)
    v_mfma_f32_16x16x32_bf16 v[224:227], v[8:11], v[196:199], v[224:227]
    v_rsq_f32 v219, v219
    v_mfma_f32_16x16x32_bf16 v[232:235], v[32:35], v[196:199], v[232:235]
    v_rsq_f32 v218, v218
    v_mfma_f32_16x16x32_bf16 v[228:231], v[20:23], v[196:199], v[228:231]
    v_mul_f32 v218, s40, v218
    v_mul_f32 v204, v218, v204
    s_waitcnt lgkmcnt(1)
    v_mfma_f32_16x16x32_bf16 v[224:227], v[12:15], v[200:203], v[224:227]
    v_mul_f32 v210, v219, v210
    v_mul_f32 v212, v219, v212
    v_mfma_f32_16x16x32_bf16 v[232:235], v[36:39], v[200:203], v[232:235]
    v_mul_f32 v205, v218, v205
    v_mul_f32 v211, v219, v211
    v_mfma_f32_16x16x32_bf16 v[244:247], v[196:199], v[44:47], v[244:247]
    v_mul_f32 v206, v218, v206
    v_mul_f32 v213, v219, v213
    v_mfma_f32_16x16x32_bf16 v[244:247], v[200:203], v[48:51], v[244:247]
    v_mul_f32 v207, v218, v207
    v_mul_f32 v214, v219, v214
    v_mfma_f32_16x16x32_bf16 v[248:251], v[196:199], v[56:59], v[248:251]
    ds_read_b128 v[196:199], v101 offset:7168
    v_mfma_f32_16x16x32_bf16 v[248:251], v[200:203], v[60:63], v[248:251]
    v_mul_f32 v215, v219, v215
    v_cvt_pk_bf16_f32 v129, v206, v207
    v_mfma_f32_16x16x32_bf16 v[228:231], v[24:27], v[200:203], v[228:231]
    ds_read_b128 v[200:203], v101 offset:8192
    v_mul_f32 v208, v218, v208
    v_mul_f32 v209, v218, v209
    v_cvt_pk_bf16_f32 v112, v210, v211
    v_cvt_pk_bf16_f32 v128, v204, v205
    s_waitcnt lgkmcnt(2)
    v_mfma_f32_16x16x32_bf16 v[204:207], v[4:7], v[192:195], 0
    v_cvt_pk_bf16_f32 v114, v214, v215
    v_cvt_pk_bf16_f32 v113, v212, v213
    v_mfma_f32_16x16x32_bf16 v[212:215], v[28:31], v[192:195], 0
    v_cvt_pk_bf16_f32 v130, v208, v209
    v_cvt_pk_bf16_f32 v150, v248, v249
    v_mfma_f32_16x16x32_bf16 v[208:211], v[16:19], v[192:195], 0
    v_cvt_pk_bf16_f32 v143, v246, v247
    v_fma_f32 v237, v230, v230, s46
    v_fma_f32 v236, v224, v224, s46
    v_cvt_pk_bf16_f32 v142, v244, v245
    v_mfma_f32_16x16x32_bf16 v[244:247], v[192:195], v[40:43], 0
    v_fmac_f32 v236, v225, v225
    v_fmac_f32 v237, v231, v231
    v_cvt_pk_bf16_f32 v151, v250, v251
    v_mfma_f32_16x16x32_bf16 v[248:251], v[192:195], v[52:55], v[176:179]
    v_fmac_f32 v237, v232, v232
    v_fmac_f32 v237, v233, v233
    v_mfma_f32_16x16x32_bf16 v[192:195], v[112:115], v[128:131], v[64:67]
    v_fmac_f32 v236, v226, v226
    v_fmac_f32 v236, v227, v227
    s_waitcnt lgkmcnt(1)
    v_mfma_f32_16x16x32_bf16 v[208:211], v[20:23], v[196:199], v[208:211]
    v_fmac_f32 v236, v228, v228
    v_fmac_f32 v236, v229, v229
    v_mfma_f32_16x16x32_bf16 v[204:207], v[8:11], v[196:199], v[204:207]
    v_fmac_f32 v237, v234, v234
    v_fmac_f32 v237, v235, v235
    v_mfma_f32_16x16x32_bf16 v[244:247], v[196:199], v[44:47], v[244:247]
    v_cvt_pk_bf16_f32 v190, v236, v237
    s_waitcnt lgkmcnt(0)
    v_mfma_f32_16x16x32_bf16 v[208:211], v[24:27], v[200:203], v[208:211]
    v_mfma_f32_16x16x16_bf16 v[238:241], v[172:173], v[190:191], 0
    v_mfma_f32_16x16x32_bf16 v[204:207], v[12:15], v[200:203], v[204:207]
    v_mfma_f32_16x16x32_bf16 v[212:215], v[32:35], v[196:199], v[212:215]
    v_mfma_f32_16x16x32_bf16 v[212:215], v[36:39], v[200:203], v[212:215]
    v_mfma_f32_16x16x32_bf16 v[248:251], v[196:199], v[56:59], v[248:251]
    v_mfma_f32_16x16x32_bf16 v[248:251], v[200:203], v[60:63], v[248:251]
    s_nop 1
    v_fma_f32 v217, v210, v210, s46
    v_mfma_f32_16x16x32_bf16 v[244:247], v[200:203], v[48:51], v[244:247]
    v_rsq_f32 v238, v238
    v_rsq_f32 v239, v239
    v_mul_f32 v238, s40, v238
    v_mul_f32 v224, v238, v224
    v_mul_f32 v231, v239, v231
    v_mul_f32 v225, v238, v225
    v_mul_f32 v230, v239, v230
    v_mul_f32 v232, v239, v232
    v_mul_f32 v227, v238, v227
    v_mul_f32 v234, v239, v234
    v_mul_f32 v226, v238, v226
    v_mul_f32 v229, v238, v229
    v_mul_f32 v233, v239, v233
    v_cvt_pk_bf16_f32 v132, v224, v225
    v_mul_f32 v228, v238, v228
    v_mul_f32 v235, v239, v235
    v_cvt_pk_bf16_f32 v133, v226, v227
    v_cvt_pk_bf16_f32 v118, v234, v235
    v_cvt_pk_bf16_f32 v116, v230, v231
    v_cvt_pk_bf16_f32 v134, v228, v229
    v_cvt_pk_bf16_f32 v117, v232, v233
    v_cvt_pk_bf16_f32 v144, v244, v245
    v_cvt_pk_bf16_f32 v145, v246, v247
    v_mfma_f32_16x16x32_bf16 v[196:199], v[116:119], v[128:131], v[76:79]
    v_cvt_pk_bf16_f32 v153, v250, v251
    v_fma_f32 v216, v204, v204, s46
    v_cvt_pk_bf16_f32 v152, v248, v249
    v_fmac_f32 v216, v205, v205
    v_fmac_f32 v216, v206, v206
    v_fmac_f32 v217, v211, v211
    v_fmac_f32 v216, v207, v207
    v_fmac_f32 v217, v212, v212
    v_fmac_f32 v217, v213, v213
    v_fmac_f32 v216, v208, v208
    v_fmac_f32 v216, v209, v209
    v_fmac_f32 v217, v214, v214
    v_fmac_f32 v217, v215, v215
    v_cvt_pk_bf16_f32 v188, v216, v217
    s_nop 1
    v_mfma_f32_16x16x16_bf16 v[218:221], v[172:173], v[188:189], 0
    s_nop 7
    v_rsq_f32 v218, v218
    v_rsq_f32 v219, v219
    v_mul_f32 v218, s40, v218
    v_mul_f32 v204, v218, v204
    v_mul_f32 v206, v218, v206
    v_mul_f32 v211, v219, v211
    v_mul_f32 v205, v218, v205
    v_mul_f32 v210, v219, v210
    v_mul_f32 v208, v218, v208
    v_mul_f32 v212, v219, v212
    v_mul_f32 v209, v218, v209
    v_mul_f32 v214, v219, v214
    v_mul_f32 v207, v218, v207
    v_cvt_pk_bf16_f32 v136, v204, v205
    v_mul_f32 v213, v219, v213
    v_cvt_pk_bf16_f32 v120, v210, v211
    v_mul_f32 v215, v219, v215
    v_mfma_f32_16x16x32_bf16 v[216:219], v[124:127], v[128:131], v[100:103]
    v_cvt_pk_bf16_f32 v137, v206, v207
    ds_read_b128 v[204:207], v105
    v_cvt_pk_bf16_f32 v121, v212, v213
    v_cvt_pk_bf16_f32 v138, v208, v209
    v_cvt_pk_bf16_f32 v122, v214, v215
    v_max3_f32 v220, v192, v193, v194
    v_max3_f32 v220, v220, v195, v196
    v_mfma_f32_16x16x32_bf16 v[200:203], v[120:123], v[128:131], v[88:91]
    v_max3_f32 v220, v220, v197, v198
    v_add_u32 v101, s26, v1
    s_nop 5
    v_max3_f32 v220, v220, v199, v200
    v_max3_f32 v220, v220, v201, v202
    v_max3_f32 v220, v220, v203, v216
    v_mov_b32 v217, v220
    s_nop 1
    v_permlane32_swap_b32 v220, v217
    v_max_f32 v220, v220, v217
    v_mov_b32 v217, v220
    s_nop 1
    v_permlane16_swap_b32 v220, v217
    v_max_f32 v220, v220, v217
    v_sub_f32 v196, v196, v220
    v_sub_f32 v193, v193, v220
    v_sub_f32 v192, v192, v220
    v_sub_f32 v194, v194, v220
    v_sub_f32 v195, v195, v220
    v_sub_f32 v199, v199, v220
    v_sub_f32 v200, v200, v220
    v_sub_f32 v198, v198, v220
    s_waitcnt lgkmcnt(0)
    v_mfma_f32_16x16x32_bf16 v[228:231], v[204:207], v[116:119], v[106:109]
    v_sub_f32 v197, v197, v220
    v_sub_f32 v203, v203, v220
    v_mfma_f32_16x16x32_bf16 v[236:239], v[204:207], v[124:127], v[106:109]
    v_sub_f32 v201, v201, v220
    v_sub_f32 v216, v216, v220
    v_mfma_f32_16x16x32_bf16 v[224:227], v[204:207], v[112:115], v[106:109]
    v_sub_f32 v202, v202, v220
    v_exp_f32 v193, v193
    v_mfma_f32_16x16x32_bf16 v[232:235], v[204:207], v[120:123], v[106:109]
    v_exp_f32 v192, v192
    v_exp_f32 v194, v194
    v_exp_f32 v196, v196
    v_exp_f32 v195, v195
    v_exp_f32 v197, v197
    v_bfi_b32 v208, v181, v228, v224
    v_mfma_f32_16x16x32_bf16 v[228:231], v[116:119], v[132:135], v[80:83]
    v_exp_f32 v198, v198
    v_mfma_f32_16x16x32_bf16 v[224:227], v[112:115], v[132:135], v[68:71]
    v_bfi_b32 v209, v181, v236, v232
    v_bfi_b32 v208, v182, v209, v208
    v_mfma_f32_16x16x32_bf16 v[232:235], v[120:123], v[132:135], v[92:95]
    v_mov_b32 v209, v208
    v_exp_f32 v203, v203
    v_mfma_f32_16x16x32_bf16 v[236:239], v[124:127], v[132:135], v[102:105]
    v_max_f32_dpp v209, v209, v209 row_ror:8 row_mask:0xf bank_mask:0xf
    v_exp_f32 v202, v202
    v_exp_f32 v201, v201
    v_max_f32_dpp v209, v209, v209 row_ror:4 row_mask:0xf bank_mask:0xf
    v_exp_f32 v199, v199
    v_exp_f32 v200, v200
    v_max_f32_dpp v209, v209, v209 row_ror:2 row_mask:0xf bank_mask:0xf
    v_cvt_pk_bf16_f32 v157, v194, v195
    v_exp_f32 v216, v216
    v_max_f32_dpp v209, v209, v209 row_ror:1 row_mask:0xf bank_mask:0xf
    v_mov_b32 v210, v209
    v_cvt_pk_bf16_f32 v156, v192, v193
    v_mfma_f32_16x16x32_bf16 v[192:195], v[112:115], v[136:139], v[72:75]
    v_permlane32_swap_b32 v209, v210
    v_max_f32 v209, v209, v210
    v_mov_b32 v210, v209
    v_cvt_pk_bf16_f32 v158, v196, v197
    v_cvt_pk_bf16_f32 v161, v202, v203
    v_permlane16_swap_b32 v209, v210
    v_max_f32 v209, v209, v210
    v_sub_f32 v208, v208, v209
    v_exp_f32 v208, v208
    v_cvt_pk_bf16_f32 v162, v216, 0
    v_cvt_pk_bf16_f32 v240, v208, 0
    ds_write_b16 v185, v240
    ds_read2_b64 v[168:171], v186 offset0:8 offset1:12
    ds_read2_b64 v[164:167], v186 offset0:0 offset1:4
    v_cvt_pk_bf16_f32 v159, v198, v199
    v_mfma_f32_16x16x32_bf16 v[196:199], v[116:119], v[136:139], v[84:87]
    v_cvt_pk_bf16_f32 v160, v200, v201
    v_max3_f32 v240, v224, v225, v226
    v_mfma_f32_16x16x32_bf16 v[248:251], v[148:151], v[156:159], 0
    v_max3_f32 v240, v240, v227, v228
    v_max3_f32 v240, v240, v229, v230
    v_mfma_f32_16x16x32_bf16 v[244:247], v[140:143], v[156:159], 0
    v_max3_f32 v240, v240, v231, v232
    v_max3_f32 v240, v240, v233, v234
    v_mfma_f32_16x16x32_bf16 v[244:247], v[144:147], v[160:163], v[244:247]
    v_max3_f32 v240, v240, v235, v236
    v_mov_b32 v237, v240
    v_mfma_f32_16x16x32_bf16 v[248:251], v[152:155], v[160:163], v[248:251]
    s_nop 0
    v_permlane32_swap_b32 v240, v237
    v_mfma_f32_16x16x32_bf16 v[200:203], v[120:123], v[136:139], v[96:99]
    v_max_f32 v240, v240, v237
    v_mov_b32 v237, v240
    s_nop 1
    v_permlane16_swap_b32 v240, v237
    v_rcp_f32 v220, v250
    v_max_f32 v240, v240, v237
    v_mul_f32 v245, v220, v245
    v_mul_f32 v247, v220, v247
    v_mul_f32 v244, v220, v244
    v_mul_f32 v246, v220, v246
    v_cvt_pk_bf16_f32 v218, v246, v247
    s_waitcnt lgkmcnt(0)
    v_mfma_f32_16x16x32_bf16 v[204:207], v[140:143], v[164:167], 0
    v_mul_f32 v249, v220, v249
    v_mul_f32 v248, v220, v248
    v_mfma_f32_16x16x32_bf16 v[204:207], v[144:147], v[168:171], v[204:207]
    v_cvt_pk_bf16_f32 v219, v248, v249
    ds_write_b32 v103, v219 offset:512
    v_mfma_f32_16x16x32_bf16 v[208:211], v[148:151], v[164:167], 0
    v_cvt_pk_bf16_f32 v217, v244, v245
    ds_write2_b32 v103, v217, v218 offset0:0 offset1:64
    v_mfma_f32_16x16x32_bf16 v[208:211], v[152:155], v[168:171], v[208:211]
    v_sub_f32 v225, v225, v240
    v_sub_f32 v224, v224, v240
    v_mfma_f32_16x16x32_bf16 v[216:219], v[124:127], v[136:139], v[104:107]
    v_sub_f32 v227, v227, v240
    v_sub_f32 v229, v229, v240
    v_sub_f32 v226, v226, v240
    v_sub_f32 v232, v232, v240
    v_sub_f32 v230, v230, v240
    v_rcp_f32 v252, v210
    v_sub_f32 v228, v228, v240
    v_mul_f32 v204, v252, v204
    v_mul_f32 v206, v252, v206
    v_mul_f32 v208, v252, v208
    v_mul_f32 v205, v252, v205
    v_cvt_pk_bf16_f32 v253, v204, v205
    v_mul_f32 v207, v252, v207
    v_cvt_pk_bf16_f32 v254, v206, v207
    v_mul_f32 v209, v252, v209
    v_cvt_pk_bf16_f32 v255, v208, v209
    s_mov_b64 exec, s[42:43]
    ds_write2_b32 v103, v253, v254 offset0:48 offset1:112
    ds_write_b32 v103, v255 offset:704
    s_mov_b64 exec, -1
    v_sub_f32 v231, v231, v240
    v_sub_f32 v233, v233, v240
    v_exp_f32 v225, v225
    v_sub_f32 v236, v236, v240
    v_sub_f32 v234, v234, v240
    v_exp_f32 v224, v224
    v_sub_f32 v235, v235, v240
    v_exp_f32 v228, v228
    v_exp_f32 v226, v226
    v_exp_f32 v229, v229
    v_exp_f32 v231, v231
    v_exp_f32 v227, v227
    v_exp_f32 v232, v232
    v_exp_f32 v234, v234
    v_exp_f32 v230, v230
    v_exp_f32 v233, v233
    v_exp_f32 v236, v236
    v_exp_f32 v235, v235
    v_cvt_pk_bf16_f32 v164, v224, v225
    v_cvt_pk_bf16_f32 v165, v226, v227
    v_cvt_pk_bf16_f32 v167, v230, v231
    v_cvt_pk_bf16_f32 v166, v228, v229
    v_cvt_pk_bf16_f32 v168, v232, v233
    v_cvt_pk_bf16_f32 v169, v234, v235
    v_mfma_f32_16x16x32_bf16 v[208:211], v[148:151], v[164:167], 0
    v_cvt_pk_bf16_f32 v170, v236, 0
    v_max3_f32 v220, v192, v193, v194
    v_mfma_f32_16x16x32_bf16 v[204:207], v[140:143], v[164:167], 0
    v_max3_f32 v220, v220, v195, v196
    v_max3_f32 v220, v220, v197, v198
    v_mfma_f32_16x16x32_bf16 v[204:207], v[144:147], v[168:171], v[204:207]
    v_max3_f32 v220, v220, v199, v200
    v_max3_f32 v220, v220, v201, v202
    v_mfma_f32_16x16x32_bf16 v[208:211], v[152:155], v[168:171], v[208:211]
    v_max3_f32 v220, v220, v203, v216
    v_mov_b32 v217, v220
    v_mov_b32_dpp v127, v127 row_ror:4 row_mask:0xf bank_mask:0xf
    v_add_u32 v105, 64, v105
    v_permlane32_swap_b32 v220, v217
    v_max_f32 v220, v220, v217
    v_mov_b32 v217, v220
    v_mov_b32_dpp v124, v124 quad_perm:[1,2,3,0] row_mask:0xf bank_mask:0xf
    v_rcp_f32 v240, v210
    v_permlane16_swap_b32 v220, v217
    v_mul_f32 v209, v240, v209
    v_mul_f32 v206, v240, v206
    v_mul_f32 v204, v240, v204
    v_mul_f32 v208, v240, v208
    v_mul_f32 v205, v240, v205
    v_cvt_pk_bf16_f32 v237, v204, v205
    v_mul_f32 v207, v240, v207
    v_cvt_pk_bf16_f32 v239, v208, v209
    ds_write_b32 v103, v239 offset:576
    v_cvt_pk_bf16_f32 v238, v206, v207
    ds_write2_b32 v103, v237, v238 offset0:16 offset1:80
    v_max_f32 v220, v220, v217
    v_sub_f32 v192, v192, v220
    v_sub_f32 v193, v193, v220
    v_sub_f32 v195, v195, v220
    v_sub_f32 v194, v194, v220
    v_sub_f32 v196, v196, v220
    v_sub_f32 v200, v200, v220
    v_sub_f32 v197, v197, v220
    v_sub_f32 v198, v198, v220
    v_sub_f32 v199, v199, v220
    v_exp_f32 v193, v193
    v_sub_f32 v203, v203, v220
    v_sub_f32 v201, v201, v220
    v_sub_f32 v202, v202, v220
    v_sub_f32 v216, v216, v220
    v_exp_f32 v192, v192
    v_exp_f32 v195, v195
    v_exp_f32 v194, v194
    v_exp_f32 v197, v197
    v_exp_f32 v196, v196
    v_exp_f32 v199, v199
    v_exp_f32 v200, v200
    v_exp_f32 v198, v198
    v_exp_f32 v216, v216
    v_cvt_pk_bf16_f32 v156, v192, v193
    v_cvt_pk_bf16_f32 v157, v194, v195
    ds_read_b128 v[192:195], v101 offset:0
    v_exp_f32 v201, v201
    v_exp_f32 v203, v203
    v_exp_f32 v202, v202
    v_cvt_pk_bf16_f32 v160, v200, v201
    v_cvt_pk_bf16_f32 v158, v196, v197
    v_cvt_pk_bf16_f32 v159, v198, v199
    ds_read_b128 v[196:199], v101 offset:1024
    v_cvt_pk_bf16_f32 v162, v216, 0
    v_mfma_f32_16x16x32_bf16 v[244:247], v[140:143], v[156:159], 0
    v_cvt_pk_bf16_f32 v161, v202, v203
    ds_read_b128 v[200:203], v101 offset:2048
    v_mfma_f32_16x16x32_bf16 v[248:251], v[148:151], v[156:159], 0
    v_mov_b32_dpp v126, v126 quad_perm:[1,2,3,0] row_mask:0xf bank_mask:0xf
    v_mov_b32_dpp v125, v125 quad_perm:[1,2,3,0] row_mask:0xf bank_mask:0xf
    v_mfma_f32_16x16x32_bf16 v[244:247], v[144:147], v[160:163], v[244:247]
    v_alignbit_b32 v147, v146, v147, 16
    v_mov_b32 v146, v111
    v_mfma_f32_16x16x32_bf16 v[248:251], v[152:155], v[160:163], v[248:251]
    v_alignbit_b32 v111, v155, v154, 16
    v_alignbit_b32 v155, v154, v155, 16
    v_mov_b32 v154, v111
    s_nop 4
    v_rcp_f32 v220, v250
    s_nop 0
    v_mul_f32 v246, v220, v246
    s_waitcnt lgkmcnt(2)
    v_mfma_f32_16x16x32_bf16 v[204:207], v[4:7], v[192:195], 0
    v_mul_f32 v247, v220, v247
    v_mul_f32 v245, v220, v245
    v_mfma_f32_16x16x32_bf16 v[208:211], v[16:19], v[192:195], 0
    v_mul_f32 v244, v220, v244
    v_mul_f32 v249, v220, v249
    v_mfma_f32_16x16x32_bf16 v[212:215], v[28:31], v[192:195], 0
    v_mul_f32 v248, v220, v248
    v_cvt_pk_bf16_f32 v219, v248, v249
    ds_write_b32 v103, v219 offset:640
    s_waitcnt lgkmcnt(2)
    v_mfma_f32_16x16x32_bf16 v[208:211], v[20:23], v[196:199], v[208:211]
    v_cvt_pk_bf16_f32 v218, v246, v247
    v_cvt_pk_bf16_f32 v217, v244, v245
    ds_write2_b32 v103, v217, v218 offset0:32 offset1:96
    v_mfma_f32_16x16x32_bf16 v[204:207], v[8:11], v[196:199], v[204:207]
    v_add_u32 v103, s78, v103
    s_sub_u32 s78, 0, s78
    s_waitcnt lgkmcnt(2)
    v_mfma_f32_16x16x32_bf16 v[204:207], v[12:15], v[200:203], v[204:207]
    v_mfma_f32_16x16x32_bf16 v[212:215], v[32:35], v[196:199], v[212:215]
    v_mfma_f32_16x16x32_bf16 v[212:215], v[36:39], v[200:203], v[212:215]
    v_mfma_f32_16x16x32_bf16 v[208:211], v[24:27], v[200:203], v[208:211]
    s_cmp_eq_u32 s24, 16
    s_nop 6
    s_cbranch_scc1 L_M_RELOAD_S
L_M_BACK_S:
    s_cmp_lt_u32 s24, s48
    s_cbranch_scc1 L_M_LOOP_S
    s_branch L_M_EPI
L_M_RELOAD_S:
    s_lshl_b32 s71, s20, 11
    s_add_u32 s71, s71, 136704
    v_add_u32 v252, s71, v1
    v_add_u32 v253, s71, v3
    v_mov_b32 v254, v127
    ds_read_b128 v[124:127], v252
    ds_read_b64 v[146:147], v253 offset:1024
    ds_read_b64 v[154:155], v253 offset:1536
    s_waitcnt lgkmcnt(2)
    v_mov_b32 v127, v254
    s_waitcnt lgkmcnt(0)
    s_nop 0
    s_branch L_M_BACK_S
L_END:
    s_endpgm
.p2align 8
.type L_TABLE,@object
L_TABLE:
.long 0x3f80,0x0,0x0,0x0,0x3f800000,0x0,0x0,0x0
.long 0x0,0x3f80,0x0,0x0,0x0,0x3f800000,0x0,0x0
.long 0x0,0x0,0x0,0x3f80,0x0,0x0,0x0,0x3f800000
.long 0x0,0x0,0x0,0x0,0x0,0x0,0x0,0x0
.long 0x0,0x0,0x0,0x0,0x0,0x0,0x0,0x0
.long 0x0,0x0,0x0,0x0,0x0,0x0,0x0,0x0
.long 0x0,0x0,0x0,0x0,0x0,0x0,0x0,0x0
.long 0x0,0x0,0x0,0x0,0x0,0x0,0x0,0x0
.long 0x0,0x0,0x0,0x0,0x0,0x0,0x0,0x0
.long 0x0,0x0,0x0,0x0,0x0,0x0,0x0,0x0
.long 0x0,0x0,0x0,0x0,0x0,0x0,0x0,0x0
.long 0x3f80,0x0,0x0,0x0,0x3f800000,0x0,0x0,0x0
.long 0x0,0x0,0x3f80,0x0,0x0,0x0,0x3f800000,0x0
.long 0x0,0x0,0x0,0x3f80,0x0,0x0,0x0,0x3f800000
.long 0x0,0x0,0x0,0x0,0x0,0x0,0x0,0x0
.long 0x0,0x0,0x0,0x0,0x0,0x0,0x0,0x0
.long 0x0,0x0,0x0,0x0,0x0,0x0,0x0,0x0
.long 0x0,0x0,0x0,0x0,0x0,0x0,0x0,0x0
.long 0x0,0x0,0x0,0x0,0x0,0x0,0x0,0x0
.long 0x0,0x0,0x0,0x0,0x0,0x0,0x0,0x0
.long 0x0,0x0,0x0,0x0,0x0,0x0,0x0,0x0
.long 0x0,0x0,0x0,0x0,0x0,0x0,0x0,0x0
.long 0x0,0x3f80,0x0,0x0,0x0,0x3f800000,0x0,0x0
.long 0x0,0x0,0x3f80,0x0,0x0,0x0,0x3f800000,0x0
.long 0x0,0x0,0x0,0x0,0x0,0x0,0x0,0x0
.long 0x0,0x0,0x0,0x0,0x0,0x0,0x0,0x0
.long 0x0,0x0,0x0,0x0,0x0,0x0,0x0,0x0
.long 0x0,0x0,0x0,0x0,0x0,0x0,0x0,0x0
.long 0x0,0x0,0x0,0x0,0x0,0x0,0x0,0x0
.long 0x0,0x0,0x0,0x0,0x0,0x0,0x0,0x0
.long 0x0,0x0,0x0,0x0,0x0,0x0,0x0,0x0
.long 0x0,0x0,0x0,0x0,0x0,0x0,0x0,0x0
.long 0x0,0x0,0x3f80,0x0,0x0,0x0,0x3f800000,0x0
.long 0x0,0x0,0x0,0x0,0x0,0x0,0x0,0x0
.long 0x0,0x0,0x0,0x0,0x0,0x0,0x0,0x0
.long 0x0,0x0,0x0,0x0,0x0,0x0,0x0,0x0
.long 0x0,0x0,0x0,0x0,0x0,0x0,0x0,0x0
.long 0x0,0x0,0x0,0x0,0x0,0x0,0x0,0x0
.long 0x0,0x0,0x0,0x0,0x0,0x0,0x0,0x0
.long 0x0,0x0,0x0,0x0,0x0,0x0,0x0,0x0
.long 0x0,0x0,0x0,0x0,0x0,0x0,0x0,0x0
.long 0x0,0x0,0x0,0x0,0x0,0x0,0x0,0x0
.long 0x0,0x3f80,0x0,0x0,0x0,0x3f800000,0x0,0x0
.long 0x0,0x0,0x0,0x0,0x0,0x0,0x0,0x0
.long 0x0,0x0,0x0,0x0,0x0,0x0,0x0,0x0
.long 0x0,0x0,0x0,0x0,0x0,0x0,0x0,0x0
.long 0x0,0x0,0x0,0x0,0x0,0x0,0x0,0x0
.long 0x0,0x0,0x0,0x0,0x0,0x0,0x0,0x0
.long 0x0,0x0,0x0,0x0,0x0,0x0,0x0,0x0
.long 0x0,0x0,0x0,0x0,0x0,0x0,0x0,0x0
.long 0x0,0x0,0x0,0x0,0x0,0x0,0x0,0x0
.long 0x0,0x0,0x0,0x0,0x0,0x0,0x0,0x0
.long 0x3f80,0x0,0x0,0x0,0x3f800000,0x0,0x0,0x0
.long 0x0,0x0,0x0,0x0,0x0,0x0,0x0,0x0
.long 0x0,0x0,0x0,0x3f80,0x0,0x0,0x0,0x3f800000
.long 0x0,0x0,0x0,0x0,0x0,0x0,0x0,0x0
.long 0x0,0x0,0x0,0x0,0x0,0x0,0x0,0x0
.long 0x0,0x0,0x0,0x0,0x0,0x0,0x0,0x0
.long 0x0,0x0,0x0,0x0,0x0,0x0,0x0,0x0
.long 0x0,0x0,0x0,0x0,0x0,0x0,0x0,0x0
.long 0x0,0x0,0x0,0x0,0x0,0x0,0x0,0x0
.long 0x0,0x0,0x0,0x0,0x0,0x0,0x0,0x0
.long 0x0,0x0,0x0,0x0,0x0,0x0,0x0,0x0
.long 0x0,0x0,0x0,0x0,0x0,0x0,0x0,0x0
.long 0x0,0x0,0x0,0x0,0x0,0x0,0x0,0x0
.long 0x3f80,0x0,0x0,0x0,0x3f800000,0x0,0x0,0x0
.long 0x0,0x0,0x0,0x0,0x0,0x0,0x0,0x0
.long 0x0,0x0,0x0,0x3f80,0x0,0x0,0x0,0x3f800000
.long 0x0,0x0,0x0,0x0,0x0,0x0,0x0,0x0
.long 0x0,0x0,0x0,0x0,0x0,0x0,0x0,0x0
.long 0x0,0x0,0x0,0x0,0x0,0x0,0x0,0x0
.long 0x0,0x0,0x0,0x0,0x0,0x0,0x0,0x0
.long 0x0,0x0,0x0,0x0,0x0,0x0,0x0,0x0
.long 0x0,0x0,0x0,0x0,0x0,0x0,0x0,0x0
.long 0x0,0x0,0x0,0x0,0x0,0x0,0x0,0x0
.long 0x0,0x0,0x0,0x0,0x0,0x0,0x0,0x0
.long 0x0,0x0,0x0,0x0,0x0,0x0,0x0,0x0
.long 0x0,0x0,0x3f80,0x0,0x0,0x0,0x3f800000,0x0
.long 0x0,0x0,0x0,0x0,0x0,0x0,0x0,0x0
.long 0x0,0x0,0x0,0x0,0x0,0x0,0x0,0x0
.long 0x0,0x0,0x0,0x0,0x0,0x0,0x0,0x0
.long 0x0,0x0,0x0,0x0,0x0,0x0,0x0,0x0
.long 0x0,0x0,0x0,0x0,0x0,0x0,0x0,0x0
.long 0x0,0x0,0x0,0x0,0x0,0x0,0x0,0x0
.long 0x0,0x0,0x0,0x0,0x0,0x0,0x0,0x0
.long 0x0,0x0,0x0,0x0,0x0,0x0,0x0,0x0
.long 0x0,0x0,0x0,0x0,0x0,0x0,0x0,0x0
.long 0x0,0x3f80,0x0,0x0,0x0,0x3f800000,0x0,0x0
.long 0x0,0x0,0x0,0x0,0x0,0x0,0x0,0x0
.long 0x0,0x0,0x0,0x0,0x0,0x0,0x0,0x0
.long 0x0,0x0,0x0,0x0,0x0,0x0,0x0,0x0
.long 0x0,0x0,0x0,0x0,0x0,0x0,0x0,0x0
.long 0x0,0x0,0x0,0x0,0x0,0x0,0x0,0x0
.long 0x0,0x0,0x0,0x0,0x0,0x0,0x0,0x0
.long 0x0,0x0,0x0,0x0,0x0,0x0,0x0,0x0
.long 0x0,0x0,0x0,0x0,0x0,0x0,0x0,0x0
.long 0x0,0x3f80,0x0,0x0,0x0,0x3f800000,0x0,0x0
.long 0x0,0x0,0x3f80,0x0,0x0,0x0,0x3f800000,0x0
.long 0x0,0x0,0x0,0x0,0x0,0x0,0x0,0x0
.long 0x0,0x0,0x0,0x0,0x0,0x0,0x0,0x0
.long 0x0,0x0,0x0,0x0,0x0,0x0,0x0,0x0
.long 0x0,0x0,0x0,0x0,0x0,0x0,0x0,0x0
.long 0x0,0x0,0x0,0x0,0x0,0x0,0x0,0x0
.long 0x0,0x0,0x0,0x0,0x0,0x0,0x0,0x0
.long 0x0,0x0,0x0,0x0,0x0,0x0,0x0,0x0
.long 0x0,0x0,0x0,0x0,0x0,0x0,0x0,0x0
.long 0x3f80,0x0,0x0,0x0,0x3f800000,0x0,0x0,0x0
.long 0x0,0x3f80,0x0,0x0,0x0,0x3f800000,0x0,0x0
.long 0x0,0x0,0x0,0x3f80,0x0,0x0,0x0,0x3f800000
.long 0x0,0x0,0x0,0x0,0x0,0x0,0x0,0x0
.long 0x0,0x0,0x0,0x0,0x0,0x0,0x0,0x0
.long 0x0,0x0,0x0,0x0,0x0,0x0,0x0,0x0
.long 0x0,0x0,0x0,0x0,0x0,0x0,0x0,0x0
.long 0x0,0x0,0x0,0x0,0x0,0x0,0x0,0x0
.long 0x0,0x0,0x0,0x0,0x0,0x0,0x0,0x0
.long 0x0,0x0,0x0,0x0,0x0,0x0,0x0,0x0
.long 0x0,0x0,0x0,0x0,0x0,0x0,0x0,0x0
.long 0x3f80,0x0,0x0,0x0,0x3f800000,0x0,0x0,0x0
.long 0x0,0x0,0x3f80,0x0,0x0,0x0,0x3f800000,0x0
.long 0x0,0x0,0x0,0x3f80,0x0,0x0,0x0,0x3f800000
.long 0x0,0x0,0x0,0x0,0x0,0x0,0x0,0x0
.long 0x0,0x0,0x0,0x0,0x0,0x0,0x0,0x0
.long 0x0,0x0,0x0,0x0,0x0,0x0,0x0,0x0
.long 0x0,0x0,0x0,0x0,0x0,0x0,0x0,0x0
.long 0x0,0x0,0x0,0x0,0x0,0x0,0x0,0x0
.long 0x0,0x0,0x0,0x0,0x0,0x0,0x0,0x0
.long 0x0,0x0,0x0,0x0,0x0,0x0,0x0,0x0
.long 0x0,0x0,0x0,0x0,0x0,0x0,0x0,0x0
.long 0x3f80,0x0,0x3f800000,0x0,0x3f800000,0x0,0x3f800000,0x100
.long 0x0,0x3f80,0x3f800000,0x200,0x0,0x3f800000,0x3f800000,0x300
.long 0x3f80,0x0,0x3f800000,0x40,0x3f800000,0x0,0x3f800000,0x140
.long 0x0,0x3f80,0x3f800000,0x240,0x0,0x3f800000,0x3f800000,0x340
.long 0x3f80,0x0,0x3f800000,0x80,0x3f800000,0x0,0x3f800000,0x180
.long 0x0,0x3f80,0x3f800000,0x280,0x0,0x3f800000,0x3f800000,0x380
.long 0x3f80,0x0,0x3f800000,0xc0,0x3f800000,0x0,0x3f800000,0x1c0
.long 0x0,0x3f80,0x3f800000,0x2c0,0x0,0x3f800000,0x3f800000,0x3c0
.long 0x3f80,0x0,0x0,0x10,0x3f800000,0x0,0x0,0x110
.long 0x0,0x3f80,0x0,0x210,0x0,0x3f800000,0x0,0x310
.long 0x3f80,0x0,0x0,0x50,0x3f800000,0x0,0x0,0x150
.long 0x0,0x3f80,0x0,0x250,0x0,0x3f800000,0x0,0x350
.long 0x3f80,0x0,0x0,0x90,0x3f800000,0x0,0x0,0x190
.long 0x0,0x3f80,0x0,0x290,0x0,0x3f800000,0x0,0x390
.long 0x3f80,0x0,0x0,0xd0,0x3f800000,0x0,0x0,0x1d0
.long 0x0,0x3f80,0x0,0x2d0,0x0,0x3f800000,0x0,0x3d0
.long 0x3f80,0x0,0x0,0x20,0x3f800000,0x0,0x0,0x120
.long 0x0,0x3f80,0x0,0x220,0x0,0x3f800000,0x0,0x320
.long 0x3f80,0x0,0x0,0x60,0x3f800000,0x0,0x0,0x160
.long 0x0,0x3f80,0x0,0x260,0x0,0x3f800000,0x0,0x360
.long 0x3f80,0x0,0x0,0xa0,0x3f800000,0x0,0x0,0x1a0
.long 0x0,0x3f80,0x0,0x2a0,0x0,0x3f800000,0x0,0x3a0
.long 0x3f80,0x0,0x0,0xe0,0x3f800000,0x0,0x0,0x1e0
.long 0x0,0x3f80,0x0,0x2e0,0x0,0x3f800000,0x0,0x3e0
.long 0x3f80,0x0,0x0,0x30,0x3f800000,0x0,0x0,0x130
.long 0x0,0x3f80,0x0,0x230,0x0,0x3f800000,0x0,0x330
.long 0x3f80,0x0,0x0,0x70,0x3f800000,0x0,0x0,0x170
.long 0x0,0x3f80,0x0,0x270,0x0,0x3f800000,0x0,0x370
.long 0x3f80,0x0,0x0,0xb0,0x3f800000,0x0,0x0,0x1b0
.long 0x0,0x3f80,0x0,0x2b0,0x0,0x3f800000,0x0,0x3b0
.long 0x3f80,0x0,0x0,0xf0,0x3f800000,0x0,0x0,0x1f0
.long 0x0,0x3f80,0x0,0x2f0,0x0,0x3f800000,0x0,0x3f0
.long 0x0,0x0,0x0,0x0,0x0,0x0,0x0,0x0
.long 0x3f800000,0x3f800000,0x3f800000,0x3f800000,0x0,0x0,0x0,0x0
.long 0x0,0x0,0x0,0x0,0x0,0x0,0x0,0x0
.long 0x3f800000,0x3f800000,0x3f800000,0x3f800000,0x0,0x0,0x0,0x0
.long 0x0,0x0,0x0,0x0,0x0,0x0,0x0,0x0
.long 0x3f800000,0x3f800000,0x3f800000,0x3f800000,0x0,0x0,0x0,0x0
.long 0x0,0x0,0x0,0x0,0x0,0x0,0x0,0x0
.long 0x3f800000,0x3f800000,0x3f800000,0x3f800000,0x0,0x0,0x0,0x0
.long 0x0,0x0,0x0,0x0,0x0,0x0,0x0,0x0
.long 0x3f800000,0x3f800000,0x3f800000,0x3f800000,0x0,0x0,0x0,0x0
.long 0x0,0x0,0x0,0x0,0x0,0x0,0x0,0x0
.long 0x3f800000,0x3f800000,0x3f800000,0x3f800000,0x0,0x0,0x0,0x0
.long 0x0,0x0,0x0,0x0,0x0,0x0,0x0,0x0
.long 0x3f800000,0x3f800000,0x3f800000,0x3f800000,0x0,0x0,0x0,0x0
.long 0x0,0x0,0x0,0x0,0x0,0x0,0x0,0x0
.long 0x3f800000,0x3f800000,0x3f800000,0x3f800000,0x0,0x0,0x0,0x0
.long 0x0,0x0,0x0,0x0,0x0,0x0,0x0,0x0
.long 0x3f800000,0x3f800000,0x3f800000,0x3f800000,0x0,0x0,0x0,0x0
.long 0x0,0x0,0x0,0x0,0x0,0x0,0x0,0x0
.long 0x3f800000,0x3f800000,0x3f800000,0x3f800000,0x0,0x0,0x0,0x0
.long 0x0,0x0,0x0,0x0,0x0,0x0,0x0,0x0
.long 0x3f800000,0x3f800000,0x3f800000,0x3f800000,0x0,0x0,0x0,0x0
.long 0x0,0x0,0x0,0x0,0x0,0x0,0x0,0x0
.long 0x3f800000,0x3f800000,0x3f800000,0x3f800000,0x0,0x0,0x0,0x0
.long 0x0,0x0,0x0,0x0,0x0,0x0,0x0,0x0
.long 0x3f800000,0x3f800000,0x3f800000,0x3f800000,0x0,0x0,0x0,0x0
.long 0x0,0x0,0x0,0x0,0x0,0x0,0x0,0x0
.long 0x3f800000,0x3f800000,0x3f800000,0x3f800000,0x0,0x0,0x0,0x0
.long 0x0,0x0,0x0,0x0,0x0,0x0,0x0,0x0
.long 0x3f800000,0x3f800000,0x3f800000,0x3f800000,0x0,0x0,0x0,0x0
.long 0x0,0x0,0x0,0x0,0x0,0x0,0x0,0x0
.long 0x3f800000,0x3f800000,0x3f800000,0x3f800000,0x0,0x0,0x0,0x0
.long 0xc6800000,0x0,0x0,0x0,0xc6800000,0x0,0x0,0x4
.long 0xc6800000,0x0,0x0,0x8,0xc6800000,0x0,0x0,0xc
.long 0xc6800000,0x0,0x0,0x10,0xc6800000,0x0,0x0,0x14
.long 0xc6800000,0x0,0x0,0x18,0xc6800000,0x0,0x0,0x1c
.long 0xc6800000,0x0,0x0,0x20,0xc6800000,0x0,0x0,0x24
.long 0xc6800000,0x0,0x0,0x28,0xc6800000,0x0,0x0,0x2c
.long 0xc6800000,0x0,0x0,0x30,0xc6800000,0x0,0x0,0x34
.long 0xc6800000,0x0,0x0,0x38,0xc6800000,0x0,0x0,0x3c
.long 0x0,0xffffffff,0x0,0x340,0x0,0xffffffff,0x0,0x344
.long 0x0,0xffffffff,0x0,0x348,0x0,0xffffffff,0x0,0x34c
.long 0x0,0xffffffff,0x0,0x350,0x0,0xffffffff,0x0,0x354
.long 0x0,0xffffffff,0x0,0x358,0x0,0xffffffff,0x0,0x35c
.long 0x0,0xffffffff,0x0,0x360,0x0,0xffffffff,0x0,0x364
.long 0x0,0xffffffff,0x0,0x368,0x0,0xffffffff,0x0,0x36c
.long 0x0,0xffffffff,0x0,0x370,0x0,0xffffffff,0x0,0x374
.long 0x0,0xffffffff,0x0,0x378,0x0,0xffffffff,0x0,0x37c
.long 0x0,0x0,0xffffffff,0x680,0x0,0x0,0xffffffff,0x684
.long 0x0,0x0,0xffffffff,0x688,0x0,0x0,0xffffffff,0x68c
.long 0x0,0x0,0xffffffff,0x690,0x0,0x0,0xffffffff,0x694
.long 0x0,0x0,0xffffffff,0x698,0x0,0x0,0xffffffff,0x69c
.long 0x0,0x0,0xffffffff,0x6a0,0x0,0x0,0xffffffff,0x6a4
.long 0x0,0x0,0xffffffff,0x6a8,0x0,0x0,0xffffffff,0x6ac
.long 0x0,0x0,0xffffffff,0x6b0,0x0,0x0,0xffffffff,0x6b4
.long 0x0,0x0,0xffffffff,0x6b8,0x0,0x0,0xffffffff,0x6bc
.long 0x0,0xffffffff,0xffffffff,0x9c0,0x0,0xffffffff,0xffffffff,0x9c4
.long 0x0,0xffffffff,0xffffffff,0x9c8,0x0,0xffffffff,0xffffffff,0x9cc
.long 0x0,0xffffffff,0xffffffff,0x9d0,0x0,0xffffffff,0xffffffff,0x9d4
.long 0x0,0xffffffff,0xffffffff,0x9d8,0x0,0xffffffff,0xffffffff,0x9dc
.long 0x0,0xffffffff,0xffffffff,0x9e0,0x0,0xffffffff,0xffffffff,0x9e4
.long 0x0,0xffffffff,0xffffffff,0x9e8,0x0,0xffffffff,0xffffffff,0x9ec
.long 0x0,0xffffffff,0xffffffff,0x9f0,0x0,0xffffffff,0xffffffff,0x9f4
.long 0x0,0xffffffff,0xffffffff,0x9f8,0x0,0xffffffff,0xffffffff,0x9fc
.long 0x0,0x4,0x8,0xc,0x0,0x4,0x8,0xc
.long 0x0,0x4,0x8,0xc,0x0,0x4,0x8,0xc
.long 0x0,0x4,0x8,0xc,0x0,0x4,0x8,0xc
.long 0x0,0x4,0x8,0xc,0x0,0x4,0x8,0xc
.long 0x0,0x4,0x8,0xc,0x0,0x4,0x8,0xc
.long 0x0,0x4,0x8,0xc,0x0,0x4,0x8,0xc
.long 0x0,0x4,0x8,0xc,0x0,0x4,0x8,0xc
.long 0x0,0x4,0x8,0xc,0x0,0x4,0x8,0xc
.long 0x10,0x14,0x18,0x34,0x10,0x14,0x18,0x34
.long 0x10,0x14,0x18,0x34,0x10,0x14,0x18,0x34
.long 0x10,0x14,0x18,0x34,0x10,0x14,0x18,0x34
.long 0x10,0x14,0x18,0x34,0x10,0x14,0x18,0x34
.long 0x10,0x14,0x18,0x34,0x10,0x14,0x18,0x34
.long 0x10,0x14,0x18,0x34,0x10,0x14,0x18,0x34
.long 0x10,0x14,0x18,0x34,0x10,0x14,0x18,0x34
.long 0x10,0x14,0x18,0x34,0x10,0x14,0x18,0x34
.long 0x38,0x3c,0x40,0x44,0x38,0x3c,0x40,0x44
.long 0x38,0x3c,0x40,0x44,0x38,0x3c,0x40,0x44
.long 0x38,0x3c,0x40,0x44,0x38,0x3c,0x40,0x44
.long 0x38,0x3c,0x40,0x44,0x38,0x3c,0x40,0x44
.long 0x38,0x3c,0x40,0x44,0x38,0x3c,0x40,0x44
.long 0x38,0x3c,0x40,0x44,0x38,0x3c,0x40,0x44
.long 0x38,0x3c,0x40,0x44,0x38,0x3c,0x40,0x44
.long 0x38,0x3c,0x40,0x44,0x38,0x3c,0x40,0x44
.long 0x48,0x4c,0x68,0x6c,0x48,0x4c,0x68,0x6c
.long 0x48,0x4c,0x68,0x6c,0x48,0x4c,0x68,0x6c
.long 0x48,0x4c,0x68,0x6c,0x48,0x4c,0x68,0x6c
.long 0x48,0x4c,0x68,0x6c,0x48,0x4c,0x68,0x6c
.long 0x48,0x4c,0x68,0x6c,0x48,0x4c,0x68,0x6c
.long 0x48,0x4c,0x68,0x6c,0x48,0x4c,0x68,0x6c
.long 0x48,0x4c,0x68,0x6c,0x48,0x4c,0x68,0x6c
.long 0x48,0x4c,0x68,0x6c,0x48,0x4c,0x68,0x6c
.long 0x70,0x74,0x78,0x7c,0x70,0x74,0x78,0x7c
.long 0x70,0x74,0x78,0x7c,0x70,0x74,0x78,0x7c
.long 0x70,0x74,0x78,0x7c,0x70,0x74,0x78,0x7c
.long 0x70,0x74,0x78,0x7c,0x70,0x74,0x78,0x7c
.long 0x70,0x74,0x78,0x7c,0x70,0x74,0x78,0x7c
.long 0x70,0x74,0x78,0x7c,0x70,0x74,0x78,0x7c
.long 0x70,0x74,0x78,0x7c,0x70,0x74,0x78,0x7c
.long 0x70,0x74,0x78,0x7c,0x70,0x74,0x78,0x7c
.long 0x80,0x9c,0xa0,0xa4,0x80,0x9c,0xa0,0xa4
.long 0x80,0x9c,0xa0,0xa4,0x80,0x9c,0xa0,0xa4
.long 0x80,0x9c,0xa0,0xa4,0x80,0x9c,0xa0,0xa4
.long 0x80,0x9c,0xa0,0xa4,0x80,0x9c,0xa0,0xa4
.long 0x80,0x9c,0xa0,0xa4,0x80,0x9c,0xa0,0xa4
.long 0x80,0x9c,0xa0,0xa4,0x80,0x9c,0xa0,0xa4
.long 0x80,0x9c,0xa0,0xa4,0x80,0x9c,0xa0,0xa4
.long 0x80,0x9c,0xa0,0xa4,0x80,0x9c,0xa0,0xa4
.long 0xa8,0xac,0xb0,0xb4,0xa8,0xac,0xb0,0xb4
.long 0xa8,0xac,0xb0,0xb4,0xa8,0xac,0xb0,0xb4
.long 0xa8,0xac,0xb0,0xb4,0xa8,0xac,0xb0,0xb4
.long 0xa8,0xac,0xb0,0xb4,0xa8,0xac,0xb0,0xb4
.long 0xa8,0xac,0xb0,0xb4,0xa8,0xac,0xb0,0xb4
.long 0xa8,0xac,0xb0,0xb4,0xa8,0xac,0xb0,0xb4
.long 0xa8,0xac,0xb0,0xb4,0xa8,0xac,0xb0,0xb4
.long 0xa8,0xac,0xb0,0xb4,0xa8,0xac,0xb0,0xb4
.long 0xd0,0xd4,0xd8,0xdc,0xd0,0xd4,0xd8,0xdc
.long 0xd0,0xd4,0xd8,0xdc,0xd0,0xd4,0xd8,0xdc
.long 0xd0,0xd4,0xd8,0xdc,0xd0,0xd4,0xd8,0xdc
.long 0xd0,0xd4,0xd8,0xdc,0xd0,0xd4,0xd8,0xdc
.long 0xd0,0xd4,0xd8,0xdc,0xd0,0xd4,0xd8,0xdc
.long 0xd0,0xd4,0xd8,0xdc,0xd0,0xd4,0xd8,0xdc
.long 0xd0,0xd4,0xd8,0xdc,0xd0,0xd4,0xd8,0xdc
.long 0xd0,0xd4,0xd8,0xdc,0xd0,0xd4,0xd8,0xdc
.long 0xe0,0xe4,0xe8,0x104,0xe0,0xe4,0xe8,0x104
.long 0xe0,0xe4,0xe8,0x104,0xe0,0xe4,0xe8,0x104
.long 0xe0,0xe4,0xe8,0x104,0xe0,0xe4,0xe8,0x104
.long 0xe0,0xe4,0xe8,0x104,0xe0,0xe4,0xe8,0x104
.long 0xe0,0xe4,0xe8,0x104,0xe0,0xe4,0xe8,0x104
.long 0xe0,0xe4,0xe8,0x104,0xe0,0xe4,0xe8,0x104
.long 0xe0,0xe4,0xe8,0x104,0xe0,0xe4,0xe8,0x104
.long 0xe0,0xe4,0xe8,0x104,0xe0,0xe4,0xe8,0x104
.long 0x108,0x10c,0x110,0x114,0x108,0x10c,0x110,0x114
.long 0x108,0x10c,0x110,0x114,0x108,0x10c,0x110,0x114
.long 0x108,0x10c,0x110,0x114,0x108,0x10c,0x110,0x114
.long 0x108,0x10c,0x110,0x114,0x108,0x10c,0x110,0x114
.long 0x108,0x10c,0x110,0x114,0x108,0x10c,0x110,0x114
.long 0x108,0x10c,0x110,0x114,0x108,0x10c,0x110,0x114
.long 0x108,0x10c,0x110,0x114,0x108,0x10c,0x110,0x114
.long 0x108,0x10c,0x110,0x114,0x108,0x10c,0x110,0x114
.long 0x118,0x11c,0x138,0x13c,0x118,0x11c,0x138,0x13c
.long 0x118,0x11c,0x138,0x13c,0x118,0x11c,0x138,0x13c
.long 0x118,0x11c,0x138,0x13c,0x118,0x11c,0x138,0x13c
.long 0x118,0x11c,0x138,0x13c,0x118,0x11c,0x138,0x13c
.long 0x118,0x11c,0x138,0x13c,0x118,0x11c,0x138,0x13c
.long 0x118,0x11c,0x138,0x13c,0x118,0x11c,0x138,0x13c
.long 0x118,0x11c,0x138,0x13c,0x118,0x11c,0x138,0x13c
.long 0x118,0x11c,0x138,0x13c,0x118,0x11c,0x138,0x13c
.long 0x140,0x144,0x148,0x14c,0x140,0x144,0x148,0x14c
.long 0x140,0x144,0x148,0x14c,0x140,0x144,0x148,0x14c
.long 0x140,0x144,0x148,0x14c,0x140,0x144,0x148,0x14c
.long 0x140,0x144,0x148,0x14c,0x140,0x144,0x148,0x14c
.long 0x140,0x144,0x148,0x14c,0x140,0x144,0x148,0x14c
.long 0x140,0x144,0x148,0x14c,0x140,0x144,0x148,0x14c
.long 0x140,0x144,0x148,0x14c,0x140,0x144,0x148,0x14c
.long 0x140,0x144,0x148,0x14c,0x140,0x144,0x148,0x14c
.long 0x23750,0x237c0,0x23830,0x238a0,0x23754,0x237c4,0x23834,0x2389c
.long 0x23758,0x237c8,0x23838,0x23898,0x2375c,0x237cc,0x23854,0x23894
.long 0x23760,0x237d0,0x23858,0x23890,0x23764,0x237ec,0x2385c,0x2388c
.long 0x23768,0x237f0,0x23860,0x23888,0x23784,0x237f4,0x23864,0x2386c
.long 0x23788,0x237f8,0x23868,0x23868,0x2378c,0x237fc,0x2386c,0x23864
.long 0x23790,0x23800,0x23888,0x23860,0x23794,0x23804,0x2388c,0x2385c
.long 0x23798,0x23820,0x23890,0x23858,0x2379c,0x23824,0x23894,0x23854
.long 0x237b8,0x23828,0x23898,0x23838,0x237bc,0x2382c,0x2389c,0x23834
.long 0x23750,0x237c0,0x23830,0x23830,0x23754,0x237c4,0x23834,0x2382c
.long 0x23758,0x237c8,0x23838,0x23828,0x2375c,0x237cc,0x23854,0x23824
.long 0x23760,0x237d0,0x23858,0x23820,0x23764,0x237ec,0x2385c,0x23804
.long 0x23768,0x237f0,0x23860,0x23800,0x23784,0x237f4,0x23864,0x237fc
.long 0x23788,0x237f8,0x23868,0x237f8,0x2378c,0x237fc,0x2386c,0x237f4
.long 0x23790,0x23800,0x23888,0x237f0,0x23794,0x23804,0x2388c,0x237ec
.long 0x23798,0x23820,0x23890,0x237d0,0x2379c,0x23824,0x23894,0x237cc
.long 0x237b8,0x23828,0x23898,0x237c8,0x237bc,0x2382c,0x2389c,0x237c4
.long 0x23750,0x237c0,0x23830,0x237c0,0x23754,0x237c4,0x23834,0x237bc
.long 0x23758,0x237c8,0x23838,0x237b8,0x2375c,0x237cc,0x23854,0x2379c
.long 0x23760,0x237d0,0x23858,0x23798,0x23764,0x237ec,0x2385c,0x23794
.long 0x23768,0x237f0,0x23860,0x23790,0x23784,0x237f4,0x23864,0x2378c
.long 0x23788,0x237f8,0x23868,0x23788,0x2378c,0x237fc,0x2386c,0x23784
.long 0x23790,0x23800,0x23888,0x23768,0x23794,0x23804,0x2388c,0x23764
.long 0x23798,0x23820,0x23890,0x23760,0x2379c,0x23824,0x23894,0x2375c
.long 0x237b8,0x23828,0x23898,0x23758,0x237bc,0x2382c,0x2389c,0x23754
.long 0x23750,0x237c0,0x23830,0x23750,0x23754,0x237c4,0x23834,0x23750
.long 0x23758,0x237c8,0x23838,0x23750,0x2375c,0x237cc,0x23854,0x23750
.long 0x23760,0x237d0,0x23858,0x23750,0x23764,0x237ec,0x2385c,0x23750
.long 0x23768,0x237f0,0x23860,0x23750,0x23784,0x237f4,0x23864,0x23750
.long 0x23788,0x237f8,0x23868,0x23750,0x2378c,0x237fc,0x2386c,0x23750
.long 0x23790,0x23800,0x23888,0x23750,0x23794,0x23804,0x2388c,0x23750
.long 0x23798,0x23820,0x23890,0x23750,0x2379c,0x23824,0x23894,0x23750
.long 0x237b8,0x23828,0x23898,0x23750,0x237bc,0x2382c,0x2389c,0x23750
.long 0x23b50,0x23bc0,0x23c30,0x23ca0,0x23b54,0x23bc4,0x23c34,0x23c9c
.long 0x23b58,0x23bc8,0x23c38,0x23c98,0x23b5c,0x23bcc,0x23c54,0x23c94
.long 0x23b60,0x23bd0,0x23c58,0x23c90,0x23b64,0x23bec,0x23c5c,0x23c8c
.long 0x23b68,0x23bf0,0x23c60,0x23c88,0x23b84,0x23bf4,0x23c64,0x23c6c
.long 0x23b88,0x23bf8,0x23c68,0x23c68,0x23b8c,0x23bfc,0x23c6c,0x23c64
.long 0x23b90,0x23c00,0x23c88,0x23c60,0x23b94,0x23c04,0x23c8c,0x23c5c
.long 0x23b98,0x23c20,0x23c90,0x23c58,0x23b9c,0x23c24,0x23c94,0x23c54
.long 0x23bb8,0x23c28,0x23c98,0x23c38,0x23bbc,0x23c2c,0x23c9c,0x23c34
.long 0x23b50,0x23bc0,0x23c30,0x23c30,0x23b54,0x23bc4,0x23c34,0x23c2c
.long 0x23b58,0x23bc8,0x23c38,0x23c28,0x23b5c,0x23bcc,0x23c54,0x23c24
.long 0x23b60,0x23bd0,0x23c58,0x23c20,0x23b64,0x23bec,0x23c5c,0x23c04
.long 0x23b68,0x23bf0,0x23c60,0x23c00,0x23b84,0x23bf4,0x23c64,0x23bfc
.long 0x23b88,0x23bf8,0x23c68,0x23bf8,0x23b8c,0x23bfc,0x23c6c,0x23bf4
.long 0x23b90,0x23c00,0x23c88,0x23bf0,0x23b94,0x23c04,0x23c8c,0x23bec
.long 0x23b98,0x23c20,0x23c90,0x23bd0,0x23b9c,0x23c24,0x23c94,0x23bcc
.long 0x23bb8,0x23c28,0x23c98,0x23bc8,0x23bbc,0x23c2c,0x23c9c,0x23bc4
.long 0x23b50,0x23bc0,0x23c30,0x23bc0,0x23b54,0x23bc4,0x23c34,0x23bbc
.long 0x23b58,0x23bc8,0x23c38,0x23bb8,0x23b5c,0x23bcc,0x23c54,0x23b9c
.long 0x23b60,0x23bd0,0x23c58,0x23b98,0x23b64,0x23bec,0x23c5c,0x23b94
.long 0x23b68,0x23bf0,0x23c60,0x23b90,0x23b84,0x23bf4,0x23c64,0x23b8c
.long 0x23b88,0x23bf8,0x23c68,0x23b88,0x23b8c,0x23bfc,0x23c6c,0x23b84
.long 0x23b90,0x23c00,0x23c88,0x23b68,0x23b94,0x23c04,0x23c8c,0x23b64
.long 0x23b98,0x23c20,0x23c90,0x23b60,0x23b9c,0x23c24,0x23c94,0x23b5c
.long 0x23bb8,0x23c28,0x23c98,0x23b58,0x23bbc,0x23c2c,0x23c9c,0x23b54
.long 0x23b50,0x23bc0,0x23c30,0x23b50,0x23b54,0x23bc4,0x23c34,0x23b50
.long 0x23b58,0x23bc8,0x23c38,0x23b50,0x23b5c,0x23bcc,0x23c54,0x23b50
.long 0x23b60,0x23bd0,0x23c58,0x23b50,0x23b64,0x23bec,0x23c5c,0x23b50
.long 0x23b68,0x23bf0,0x23c60,0x23b50,0x23b84,0x23bf4,0x23c64,0x23b50
.long 0x23b88,0x23bf8,0x23c68,0x23b50,0x23b8c,0x23bfc,0x23c6c,0x23b50
.long 0x23b90,0x23c00,0x23c88,0x23b50,0x23b94,0x23c04,0x23c8c,0x23b50
.long 0x23b98,0x23c20,0x23c90,0x23b50,0x23b9c,0x23c24,0x23c94,0x23b50
.long 0x23bb8,0x23c28,0x23c98,0x23b50,0x23bbc,0x23c2c,0x23c9c,0x23b50
.long 0x23f50,0x23fc0,0x24030,0x240a0,0x23f54,0x23fc4,0x24034,0x2409c
.long 0x23f58,0x23fc8,0x24038,0x24098,0x23f5c,0x23fcc,0x24054,0x24094
.long 0x23f60,0x23fd0,0x24058,0x24090,0x23f64,0x23fec,0x2405c,0x2408c
.long 0x23f68,0x23ff0,0x24060,0x24088,0x23f84,0x23ff4,0x24064,0x2406c
.long 0x23f88,0x23ff8,0x24068,0x24068,0x23f8c,0x23ffc,0x2406c,0x24064
.long 0x23f90,0x24000,0x24088,0x24060,0x23f94,0x24004,0x2408c,0x2405c
.long 0x23f98,0x24020,0x24090,0x24058,0x23f9c,0x24024,0x24094,0x24054
.long 0x23fb8,0x24028,0x24098,0x24038,0x23fbc,0x2402c,0x2409c,0x24034
.long 0x23f50,0x23fc0,0x24030,0x24030,0x23f54,0x23fc4,0x24034,0x2402c
.long 0x23f58,0x23fc8,0x24038,0x24028,0x23f5c,0x23fcc,0x24054,0x24024
.long 0x23f60,0x23fd0,0x24058,0x24020,0x23f64,0x23fec,0x2405c,0x24004
.long 0x23f68,0x23ff0,0x24060,0x24000,0x23f84,0x23ff4,0x24064,0x23ffc
.long 0x23f88,0x23ff8,0x24068,0x23ff8,0x23f8c,0x23ffc,0x2406c,0x23ff4
.long 0x23f90,0x24000,0x24088,0x23ff0,0x23f94,0x24004,0x2408c,0x23fec
.long 0x23f98,0x24020,0x24090,0x23fd0,0x23f9c,0x24024,0x24094,0x23fcc
.long 0x23fb8,0x24028,0x24098,0x23fc8,0x23fbc,0x2402c,0x2409c,0x23fc4
.long 0x23f50,0x23fc0,0x24030,0x23fc0,0x23f54,0x23fc4,0x24034,0x23fbc
.long 0x23f58,0x23fc8,0x24038,0x23fb8,0x23f5c,0x23fcc,0x24054,0x23f9c
.long 0x23f60,0x23fd0,0x24058,0x23f98,0x23f64,0x23fec,0x2405c,0x23f94
.long 0x23f68,0x23ff0,0x24060,0x23f90,0x23f84,0x23ff4,0x24064,0x23f8c
.long 0x23f88,0x23ff8,0x24068,0x23f88,0x23f8c,0x23ffc,0x2406c,0x23f84
.long 0x23f90,0x24000,0x24088,0x23f68,0x23f94,0x24004,0x2408c,0x23f64
.long 0x23f98,0x24020,0x24090,0x23f60,0x23f9c,0x24024,0x24094,0x23f5c
.long 0x23fb8,0x24028,0x24098,0x23f58,0x23fbc,0x2402c,0x2409c,0x23f54
.long 0x23f50,0x23fc0,0x24030,0x23f50,0x23f54,0x23fc4,0x24034,0x23f50
.long 0x23f58,0x23fc8,0x24038,0x23f50,0x23f5c,0x23fcc,0x24054,0x23f50
.long 0x23f60,0x23fd0,0x24058,0x23f50,0x23f64,0x23fec,0x2405c,0x23f50
.long 0x23f68,0x23ff0,0x24060,0x23f50,0x23f84,0x23ff4,0x24064,0x23f50
.long 0x23f88,0x23ff8,0x24068,0x23f50,0x23f8c,0x23ffc,0x2406c,0x23f50
.long 0x23f90,0x24000,0x24088,0x23f50,0x23f94,0x24004,0x2408c,0x23f50
.long 0x23f98,0x24020,0x24090,0x23f50,0x23f9c,0x24024,0x24094,0x23f50
.long 0x23fb8,0x24028,0x24098,0x23f50,0x23fbc,0x2402c,0x2409c,0x23f50
.long 0x24350,0x243c0,0x24430,0x244a0,0x24354,0x243c4,0x24434,0x2449c
.long 0x24358,0x243c8,0x24438,0x24498,0x2435c,0x243cc,0x24454,0x24494
.long 0x24360,0x243d0,0x24458,0x24490,0x24364,0x243ec,0x2445c,0x2448c
.long 0x24368,0x243f0,0x24460,0x24488,0x24384,0x243f4,0x24464,0x2446c
.long 0x24388,0x243f8,0x24468,0x24468,0x2438c,0x243fc,0x2446c,0x24464
.long 0x24390,0x24400,0x24488,0x24460,0x24394,0x24404,0x2448c,0x2445c
.long 0x24398,0x24420,0x24490,0x24458,0x2439c,0x24424,0x24494,0x24454
.long 0x243b8,0x24428,0x24498,0x24438,0x243bc,0x2442c,0x2449c,0x24434
.long 0x24350,0x243c0,0x24430,0x24430,0x24354,0x243c4,0x24434,0x2442c
.long 0x24358,0x243c8,0x24438,0x24428,0x2435c,0x243cc,0x24454,0x24424
.long 0x24360,0x243d0,0x24458,0x24420,0x24364,0x243ec,0x2445c,0x24404
.long 0x24368,0x243f0,0x24460,0x24400,0x24384,0x243f4,0x24464,0x243fc
.long 0x24388,0x243f8,0x24468,0x243f8,0x2438c,0x243fc,0x2446c,0x243f4
.long 0x24390,0x24400,0x24488,0x243f0,0x24394,0x24404,0x2448c,0x243ec
.long 0x24398,0x24420,0x24490,0x243d0,0x2439c,0x24424,0x24494,0x243cc
.long 0x243b8,0x24428,0x24498,0x243c8,0x243bc,0x2442c,0x2449c,0x243c4
.long 0x24350,0x243c0,0x24430,0x243c0,0x24354,0x243c4,0x24434,0x243bc
.long 0x24358,0x243c8,0x24438,0x243b8,0x2435c,0x243cc,0x24454,0x2439c
.long 0x24360,0x243d0,0x24458,0x24398,0x24364,0x243ec,0x2445c,0x24394
.long 0x24368,0x243f0,0x24460,0x24390,0x24384,0x243f4,0x24464,0x2438c
.long 0x24388,0x243f8,0x24468,0x24388,0x2438c,0x243fc,0x2446c,0x24384
.long 0x24390,0x24400,0x24488,0x24368,0x24394,0x24404,0x2448c,0x24364
.long 0x24398,0x24420,0x24490,0x24360,0x2439c,0x24424,0x24494,0x2435c
.long 0x243b8,0x24428,0x24498,0x24358,0x243bc,0x2442c,0x2449c,0x24354
.long 0x24350,0x243c0,0x24430,0x24350,0x24354,0x243c4,0x24434,0x24350
.long 0x24358,0x243c8,0x24438,0x24350,0x2435c,0x243cc,0x24454,0x24350
.long 0x24360,0x243d0,0x24458,0x24350,0x24364,0x243ec,0x2445c,0x24350
.long 0x24368,0x243f0,0x24460,0x24350,0x24384,0x243f4,0x24464,0x24350
.long 0x24388,0x243f8,0x24468,0x24350,0x2438c,0x243fc,0x2446c,0x24350
.long 0x24390,0x24400,0x24488,0x24350,0x24394,0x24404,0x2448c,0x24350
.long 0x24398,0x24420,0x24490,0x24350,0x2439c,0x24424,0x24494,0x24350
.long 0x243b8,0x24428,0x24498,0x24350,0x243bc,0x2442c,0x2449c,0x24350
.long 0x1f400,0x21400,0x21400,0x6c00,0x1f400,0x21402,0x21400,0x6e40
.long 0x1f400,0x21404,0x21400,0x7080,0x1f400,0x21406,0x21400,0x72c0
.long 0x1f400,0x21408,0x21400,0x7e00,0x1f400,0x2140a,0x21400,0x8040
.long 0x1f400,0x2140c,0x21400,0x8280,0x1f400,0x2140e,0x21400,0x84c0
.long 0x1f400,0x21410,0x21400,0x9000,0x1f400,0x21412,0x21400,0x9240
.long 0x1f400,0x21414,0x21400,0x9480,0x1f400,0x21416,0x21400,0x96c0
.long 0x1f400,0x21418,0x21400,0xa200,0x1f400,0x2141a,0x21400,0xa440
.long 0x1f400,0x2141c,0x21400,0xa680,0x1f400,0x2141e,0x21400,0xa8c0
.long 0x1f410,0x21420,0x21408,0x6c10,0x1f410,0x21422,0x21408,0x6e50
.long 0x1f410,0x21424,0x21408,0x7090,0x1f410,0x21426,0x21408,0x72d0
.long 0x1f410,0x21428,0x21408,0x7e10,0x1f410,0x2142a,0x21408,0x8050
.long 0x1f410,0x2142c,0x21408,0x8290,0x1f410,0x2142e,0x21408,0x84d0
.long 0x1f410,0x21430,0x21408,0x9010,0x1f410,0x21432,0x21408,0x9250
.long 0x1f410,0x21434,0x21408,0x9490,0x1f410,0x21436,0x21408,0x96d0
.long 0x1f410,0x21438,0x21408,0xa210,0x1f410,0x2143a,0x21408,0xa450
.long 0x1f410,0x2143c,0x21408,0xa690,0x1f410,0x2143e,0x21408,0xa8d0
.long 0x1f420,0x21440,0x21410,0x6c20,0x1f420,0x21442,0x21410,0x6e60
.long 0x1f420,0x21444,0x21410,0x70a0,0x1f420,0x21446,0x21410,0x72e0
.long 0x1f420,0x21448,0x21410,0x7e20,0x1f420,0x2144a,0x21410,0x8060
.long 0x1f420,0x2144c,0x21410,0x82a0,0x1f420,0x2144e,0x21410,0x84e0
.long 0x1f420,0x21450,0x21410,0x9020,0x1f420,0x21452,0x21410,0x9260
.long 0x1f420,0x21454,0x21410,0x94a0,0x1f420,0x21456,0x21410,0x96e0
.long 0x1f420,0x21458,0x21410,0xa220,0x1f420,0x2145a,0x21410,0xa460
.long 0x1f420,0x2145c,0x21410,0xa6a0,0x1f420,0x2145e,0x21410,0xa8e0
.long 0x1f430,0x21460,0x21418,0x6c20,0x1f430,0x21462,0x21418,0x6e60
.long 0x1f430,0x21464,0x21418,0x70a0,0x1f430,0x21466,0x21418,0x72e0
.long 0x1f430,0x21468,0x21418,0x7e20,0x1f430,0x2146a,0x21418,0x8060
.long 0x1f430,0x2146c,0x21418,0x82a0,0x1f430,0x2146e,0x21418,0x84e0
.long 0x1f430,0x21470,0x21418,0x9020,0x1f430,0x21472,0x21418,0x9260
.long 0x1f430,0x21474,0x21418,0x94a0,0x1f430,0x21476,0x21418,0x96e0
.long 0x1f430,0x21478,0x21418,0xa220,0x1f430,0x2147a,0x21418,0xa460
.long 0x1f430,0x2147c,0x21418,0xa6a0,0x1f430,0x2147e,0x21418,0xa8e0
.long 0x1fc00,0x21480,0x21480,0x6c30,0x1fc00,0x21482,0x21480,0x6e70
.long 0x1fc00,0x21484,0x21480,0x70b0,0x1fc00,0x21486,0x21480,0x72f0
.long 0x1fc00,0x21488,0x21480,0x7e30,0x1fc00,0x2148a,0x21480,0x8070
.long 0x1fc00,0x2148c,0x21480,0x82b0,0x1fc00,0x2148e,0x21480,0x84f0
.long 0x1fc00,0x21490,0x21480,0x9030,0x1fc00,0x21492,0x21480,0x9270
.long 0x1fc00,0x21494,0x21480,0x94b0,0x1fc00,0x21496,0x21480,0x96f0
.long 0x1fc00,0x21498,0x21480,0xa230,0x1fc00,0x2149a,0x21480,0xa470
.long 0x1fc00,0x2149c,0x21480,0xa6b0,0x1fc00,0x2149e,0x21480,0xa8f0
.long 0x1fc10,0x214a0,0x21488,0x6c40,0x1fc10,0x214a2,0x21488,0x6e80
.long 0x1fc10,0x214a4,0x21488,0x70c0,0x1fc10,0x214a6,0x21488,0x7300
.long 0x1fc10,0x214a8,0x21488,0x7e40,0x1fc10,0x214aa,0x21488,0x8080
.long 0x1fc10,0x214ac,0x21488,0x82c0,0x1fc10,0x214ae,0x21488,0x8500
.long 0x1fc10,0x214b0,0x21488,0x9040,0x1fc10,0x214b2,0x21488,0x9280
.long 0x1fc10,0x214b4,0x21488,0x94c0,0x1fc10,0x214b6,0x21488,0x9700
.long 0x1fc10,0x214b8,0x21488,0xa240,0x1fc10,0x214ba,0x21488,0xa480
.long 0x1fc10,0x214bc,0x21488,0xa6c0,0x1fc10,0x214be,0x21488,0xa900
.long 0x1fc20,0x214c0,0x21490,0x6c50,0x1fc20,0x214c2,0x21490,0x6e90
.long 0x1fc20,0x214c4,0x21490,0x70d0,0x1fc20,0x214c6,0x21490,0x7310
.long 0x1fc20,0x214c8,0x21490,0x7e50,0x1fc20,0x214ca,0x21490,0x8090
.long 0x1fc20,0x214cc,0x21490,0x82d0,0x1fc20,0x214ce,0x21490,0x8510
.long 0x1fc20,0x214d0,0x21490,0x9050,0x1fc20,0x214d2,0x21490,0x9290
.long 0x1fc20,0x214d4,0x21490,0x94d0,0x1fc20,0x214d6,0x21490,0x9710
.long 0x1fc20,0x214d8,0x21490,0xa250,0x1fc20,0x214da,0x21490,0xa490
.long 0x1fc20,0x214dc,0x21490,0xa6d0,0x1fc20,0x214de,0x21490,0xa910
.long 0x1fc30,0x214e0,0x21498,0x6c50,0x1fc30,0x214e2,0x21498,0x6e90
.long 0x1fc30,0x214e4,0x21498,0x70d0,0x1fc30,0x214e6,0x21498,0x7310
.long 0x1fc30,0x214e8,0x21498,0x7e50,0x1fc30,0x214ea,0x21498,0x8090
.long 0x1fc30,0x214ec,0x21498,0x82d0,0x1fc30,0x214ee,0x21498,0x8510
.long 0x1fc30,0x214f0,0x21498,0x9050,0x1fc30,0x214f2,0x21498,0x9290
.long 0x1fc30,0x214f4,0x21498,0x94d0,0x1fc30,0x214f6,0x21498,0x9710
.long 0x1fc30,0x214f8,0x21498,0xa250,0x1fc30,0x214fa,0x21498,0xa490
.long 0x1fc30,0x214fc,0x21498,0xa6d0,0x1fc30,0x214fe,0x21498,0xa910
.long 0x20400,0x21500,0x21500,0x6c60,0x20400,0x21502,0x21500,0x6ea0
.long 0x20400,0x21504,0x21500,0x70e0,0x20400,0x21506,0x21500,0x7320
.long 0x20400,0x21508,0x21500,0x7e60,0x20400,0x2150a,0x21500,0x80a0
.long 0x20400,0x2150c,0x21500,0x82e0,0x20400,0x2150e,0x21500,0x8520
.long 0x20400,0x21510,0x21500,0x9060,0x20400,0x21512,0x21500,0x92a0
.long 0x20400,0x21514,0x21500,0x94e0,0x20400,0x21516,0x21500,0x9720
.long 0x20400,0x21518,0x21500,0xa260,0x20400,0x2151a,0x21500,0xa4a0
.long 0x20400,0x2151c,0x21500,0xa6e0,0x20400,0x2151e,0x21500,0xa920
.long 0x20410,0x21520,0x21508,0x6c70,0x20410,0x21522,0x21508,0x6eb0
.long 0x20410,0x21524,0x21508,0x70f0,0x20410,0x21526,0x21508,0x7330
.long 0x20410,0x21528,0x21508,0x7e70,0x20410,0x2152a,0x21508,0x80b0
.long 0x20410,0x2152c,0x21508,0x82f0,0x20410,0x2152e,0x21508,0x8530
.long 0x20410,0x21530,0x21508,0x9070,0x20410,0x21532,0x21508,0x92b0
.long 0x20410,0x21534,0x21508,0x94f0,0x20410,0x21536,0x21508,0x9730
.long 0x20410,0x21538,0x21508,0xa270,0x20410,0x2153a,0x21508,0xa4b0
.long 0x20410,0x2153c,0x21508,0xa6f0,0x20410,0x2153e,0x21508,0xa930
.long 0x20420,0x21540,0x21510,0x6c80,0x20420,0x21542,0x21510,0x6ec0
.long 0x20420,0x21544,0x21510,0x7100,0x20420,0x21546,0x21510,0x7340
.long 0x20420,0x21548,0x21510,0x7e80,0x20420,0x2154a,0x21510,0x80c0
.long 0x20420,0x2154c,0x21510,0x8300,0x20420,0x2154e,0x21510,0x8540
.long 0x20420,0x21550,0x21510,0x9080,0x20420,0x21552,0x21510,0x92c0
.long 0x20420,0x21554,0x21510,0x9500,0x20420,0x21556,0x21510,0x9740
.long 0x20420,0x21558,0x21510,0xa280,0x20420,0x2155a,0x21510,0xa4c0
.long 0x20420,0x2155c,0x21510,0xa700,0x20420,0x2155e,0x21510,0xa940
.long 0x20430,0x21560,0x21518,0x6c80,0x20430,0x21562,0x21518,0x6ec0
.long 0x20430,0x21564,0x21518,0x7100,0x20430,0x21566,0x21518,0x7340
.long 0x20430,0x21568,0x21518,0x7e80,0x20430,0x2156a,0x21518,0x80c0
.long 0x20430,0x2156c,0x21518,0x8300,0x20430,0x2156e,0x21518,0x8540
.long 0x20430,0x21570,0x21518,0x9080,0x20430,0x21572,0x21518,0x92c0
.long 0x20430,0x21574,0x21518,0x9500,0x20430,0x21576,0x21518,0x9740
.long 0x20430,0x21578,0x21518,0xa280,0x20430,0x2157a,0x21518,0xa4c0
.long 0x20430,0x2157c,0x21518,0xa700,0x20430,0x2157e,0x21518,0xa940
.long 0x20c00,0x21580,0x21580,0x6c90,0x20c00,0x21582,0x21580,0x6ed0
.long 0x20c00,0x21584,0x21580,0x7110,0x20c00,0x21586,0x21580,0x7350
.long 0x20c00,0x21588,0x21580,0x7e90,0x20c00,0x2158a,0x21580,0x80d0
.long 0x20c00,0x2158c,0x21580,0x8310,0x20c00,0x2158e,0x21580,0x8550
.long 0x20c00,0x21590,0x21580,0x9090,0x20c00,0x21592,0x21580,0x92d0
.long 0x20c00,0x21594,0x21580,0x9510,0x20c00,0x21596,0x21580,0x9750
.long 0x20c00,0x21598,0x21580,0xa290,0x20c00,0x2159a,0x21580,0xa4d0
.long 0x20c00,0x2159c,0x21580,0xa710,0x20c00,0x2159e,0x21580,0xa950
.long 0x20c10,0x215a0,0x21588,0x6ca0,0x20c10,0x215a2,0x21588,0x6ee0
.long 0x20c10,0x215a4,0x21588,0x7120,0x20c10,0x215a6,0x21588,0x7360
.long 0x20c10,0x215a8,0x21588,0x7ea0,0x20c10,0x215aa,0x21588,0x80e0
.long 0x20c10,0x215ac,0x21588,0x8320,0x20c10,0x215ae,0x21588,0x8560
.long 0x20c10,0x215b0,0x21588,0x90a0,0x20c10,0x215b2,0x21588,0x92e0
.long 0x20c10,0x215b4,0x21588,0x9520,0x20c10,0x215b6,0x21588,0x9760
.long 0x20c10,0x215b8,0x21588,0xa2a0,0x20c10,0x215ba,0x21588,0xa4e0
.long 0x20c10,0x215bc,0x21588,0xa720,0x20c10,0x215be,0x21588,0xa960
.long 0x20c20,0x215c0,0x21590,0x6cb0,0x20c20,0x215c2,0x21590,0x6ef0
.long 0x20c20,0x215c4,0x21590,0x7130,0x20c20,0x215c6,0x21590,0x7370
.long 0x20c20,0x215c8,0x21590,0x7eb0,0x20c20,0x215ca,0x21590,0x80f0
.long 0x20c20,0x215cc,0x21590,0x8330,0x20c20,0x215ce,0x21590,0x8570
.long 0x20c20,0x215d0,0x21590,0x90b0,0x20c20,0x215d2,0x21590,0x92f0
.long 0x20c20,0x215d4,0x21590,0x9530,0x20c20,0x215d6,0x21590,0x9770
.long 0x20c20,0x215d8,0x21590,0xa2b0,0x20c20,0x215da,0x21590,0xa4f0
.long 0x20c20,0x215dc,0x21590,0xa730,0x20c20,0x215de,0x21590,0xa970
.long 0x20c30,0x215e0,0x21598,0x6cb0,0x20c30,0x215e2,0x21598,0x6ef0
.long 0x20c30,0x215e4,0x21598,0x7130,0x20c30,0x215e6,0x21598,0x7370
.long 0x20c30,0x215e8,0x21598,0x7eb0,0x20c30,0x215ea,0x21598,0x80f0
.long 0x20c30,0x215ec,0x21598,0x8330,0x20c30,0x215ee,0x21598,0x8570
.long 0x20c30,0x215f0,0x21598,0x90b0,0x20c30,0x215f2,0x21598,0x92f0
.long 0x20c30,0x215f4,0x21598,0x9530,0x20c30,0x215f6,0x21598,0x9770
.long 0x20c30,0x215f8,0x21598,0xa2b0,0x20c30,0x215fa,0x21598,0xa4f0
.long 0x20c30,0x215fc,0x21598,0xa730,0x20c30,0x215fe,0x21598,0xa970
.long 0x3f80,0x0,0x0,0x0,0x3f800000,0x0,0x0,0x0
.long 0x0,0x3f80,0x0,0x0,0x0,0x3f800000,0x0,0x0
.long 0x0,0x0,0x0,0x0,0x0,0x0,0x0,0x0
.long 0x0,0x0,0x0,0x0,0x0,0x0,0x0,0x0
.long 0x0,0x0,0x0,0x0,0x0,0x0,0x0,0x0
.long 0x0,0x0,0x0,0x0,0x0,0x0,0x0,0x0
.long 0x0,0x0,0x0,0x0,0x0,0x0,0x0,0x0
.long 0x0,0x0,0x0,0x0,0x0,0x0,0x0,0x0
.long 0x0,0x0,0x0,0x0,0x0,0x0,0x0,0x0
.long 0x0,0x0,0x0,0x0,0x0,0x0,0x0,0x0
.long 0x3f80,0x0,0x0,0x0,0x3f800000,0x0,0x0,0x0
.long 0x0,0x3f80,0x0,0x0,0x0,0x3f800000,0x0,0x0
.long 0x0,0x0,0x0,0x0,0x0,0x0,0x0,0x0
.long 0x0,0x0,0x0,0x0,0x0,0x0,0x0,0x0
.long 0x0,0x0,0x0,0x0,0x0,0x0,0x0,0x0
.long 0x0,0x0,0x0,0x0,0x0,0x0,0x0,0x0
.long 0x0,0x0,0x0,0x0,0x0,0x0,0x0,0x0
.long 0x0,0x0,0x0,0x0,0x0,0x0,0x0,0x0
.long 0x0,0x0,0x0,0x0,0x0,0x0,0x0,0x0
.long 0x0,0x0,0x0,0x0,0x0,0x0,0x0,0x0
.long 0x3f80,0x0,0x0,0x0,0x3f800000,0x0,0x0,0x0
.long 0x0,0x3f80,0x0,0x0,0x0,0x3f800000,0x0,0x0
.long 0x0,0x0,0x0,0x0,0x0,0x0,0x0,0x0
.long 0x0,0x0,0x0,0x0,0x0,0x0,0x0,0x0
.long 0x0,0x0,0x0,0x0,0x0,0x0,0x0,0x0
.long 0x0,0x0,0x0,0x0,0x0,0x0,0x0,0x0
.long 0x0,0x0,0x0,0x0,0x0,0x0,0x0,0x0
.long 0x0,0x0,0x0,0x0,0x0,0x0,0x0,0x0
.long 0x0,0x0,0x0,0x0,0x0,0x0,0x0,0x0
.long 0x0,0x0,0x0,0x0,0x0,0x0,0x0,0x0
.long 0x3f80,0x0,0x0,0x0,0x3f800000,0x0,0x0,0x0
.long 0x0,0x3f80,0x0,0x0,0x0,0x3f800000,0x0,0x0
.long 0x0,0x0,0x3f80,0x0,0x0,0x0,0x3f800000,0x0
.long 0x0,0x0,0x0,0x3f80,0x0,0x0,0x0,0x3f800000
.long 0x0,0x0,0x0,0x0,0x0,0x0,0x0,0x0
.long 0x0,0x0,0x0,0x0,0x0,0x0,0x0,0x0
.long 0x0,0x0,0x0,0x0,0x0,0x0,0x0,0x0
.long 0x0,0x0,0x0,0x0,0x0,0x0,0x0,0x0
.long 0x0,0x0,0x0,0x0,0x0,0x0,0x0,0x0
.long 0x0,0x0,0x0,0x0,0x0,0x0,0x0,0x0
.long 0x0,0x0,0x0,0x0,0x0,0x0,0x0,0x0
.long 0x0,0x0,0x0,0x0,0x0,0x0,0x0,0x0
.long 0x0,0x0,0x3f80,0x0,0x0,0x0,0x3f800000,0x0
.long 0x0,0x0,0x0,0x3f80,0x0,0x0,0x0,0x3f800000
.long 0x0,0x0,0x0,0x0,0x0,0x0,0x0,0x0
.long 0x0,0x0,0x0,0x0,0x0,0x0,0x0,0x0
.long 0x0,0x0,0x0,0x0,0x0,0x0,0x0,0x0
.long 0x0,0x0,0x0,0x0,0x0,0x0,0x0,0x0
.long 0x0,0x0,0x0,0x0,0x0,0x0,0x0,0x0
.long 0x0,0x0,0x0,0x0,0x0,0x0,0x0,0x0
.long 0x0,0x0,0x0,0x0,0x0,0x0,0x0,0x0
.long 0x0,0x0,0x0,0x0,0x0,0x0,0x0,0x0
.long 0x0,0x0,0x3f80,0x0,0x0,0x0,0x3f800000,0x0
.long 0x0,0x0,0x0,0x3f80,0x0,0x0,0x0,0x3f800000
.long 0x0,0x0,0x0,0x0,0x0,0x0,0x0,0x0
.long 0x0,0x0,0x0,0x0,0x0,0x0,0x0,0x0
.long 0x0,0x0,0x0,0x0,0x0,0x0,0x0,0x0
.long 0x0,0x0,0x0,0x0,0x0,0x0,0x0,0x0
.long 0x0,0x0,0x0,0x0,0x0,0x0,0x0,0x0
.long 0x0,0x0,0x0,0x0,0x0,0x0,0x0,0x0
.long 0x0,0x0,0x0,0x0,0x0,0x0,0x0,0x0
.long 0x0,0x0,0x0,0x0,0x0,0x0,0x0,0x0
.long 0x0,0x0,0x3f80,0x0,0x0,0x0,0x3f800000,0x0
.long 0x0,0x0,0x0,0x3f80,0x0,0x0,0x0,0x3f800000
.long 0x14400,0x14700,0x15780,0x16800,0x144c0,0x147c0,0x15840,0x168c0
.long 0x14580,0x15600,0x15900,0x16980,0x14640,0x156c0,0x159c0,0x16a40
.long 0x14880,0x14b80,0x15c00,0x16c80,0x14940,0x14c40,0x15cc0,0x16d40
.long 0x14a00,0x15a80,0x15d80,0x16e00,0x14ac0,0x15b40,0x15e40,0x16ec0
.long 0x14d00,0x15000,0x16080,0x17100,0x14dc0,0x150c0,0x16140,0x171c0
.long 0x14e80,0x15f00,0x16200,0x17280,0x14f40,0x15fc0,0x162c0,0x17340
.long 0x15180,0x15480,0x16500,0x17580,0x15240,0x15540,0x165c0,0x17640
.long 0x15300,0x16380,0x16680,0x17700,0x153c0,0x16440,0x16740,0x177c0
.long 0x14410,0x14710,0x15790,0x16810,0x144d0,0x147d0,0x15850,0x168d0
.long 0x14590,0x15610,0x15910,0x16990,0x14650,0x156d0,0x159d0,0x16a50
.long 0x14890,0x14b90,0x15c10,0x16c90,0x14950,0x14c50,0x15cd0,0x16d50
.long 0x14a10,0x15a90,0x15d90,0x16e10,0x14ad0,0x15b50,0x15e50,0x16ed0
.long 0x14d10,0x15010,0x16090,0x17110,0x14dd0,0x150d0,0x16150,0x171d0
.long 0x14e90,0x15f10,0x16210,0x17290,0x14f50,0x15fd0,0x162d0,0x17350
.long 0x15190,0x15490,0x16510,0x17590,0x15250,0x15550,0x165d0,0x17650
.long 0x15310,0x16390,0x16690,0x17710,0x153d0,0x16450,0x16750,0x177d0
.long 0x14420,0x14720,0x157a0,0x16820,0x144e0,0x147e0,0x15860,0x168e0
.long 0x145a0,0x15620,0x15920,0x169a0,0x14660,0x156e0,0x159e0,0x16a60
.long 0x148a0,0x14ba0,0x15c20,0x16ca0,0x14960,0x14c60,0x15ce0,0x16d60
.long 0x14a20,0x15aa0,0x15da0,0x16e20,0x14ae0,0x15b60,0x15e60,0x16ee0
.long 0x14d20,0x15020,0x160a0,0x17120,0x14de0,0x150e0,0x16160,0x171e0
.long 0x14ea0,0x15f20,0x16220,0x172a0,0x14f60,0x15fe0,0x162e0,0x17360
.long 0x151a0,0x154a0,0x16520,0x175a0,0x15260,0x15560,0x165e0,0x17660
.long 0x15320,0x163a0,0x166a0,0x17720,0x153e0,0x16460,0x16760,0x177e0
.long 0x14430,0x14730,0x157b0,0x16830,0x144f0,0x147f0,0x15870,0x168f0
.long 0x145b0,0x15630,0x15930,0x169b0,0x14670,0x156f0,0x159f0,0x16a70
.long 0x148b0,0x14bb0,0x15c30,0x16cb0,0x14970,0x14c70,0x15cf0,0x16d70
.long 0x14a30,0x15ab0,0x15db0,0x16e30,0x14af0,0x15b70,0x15e70,0x16ef0
.long 0x14d30,0x15030,0x160b0,0x17130,0x14df0,0x150f0,0x16170,0x171f0
.long 0x14eb0,0x15f30,0x16230,0x172b0,0x14f70,0x15ff0,0x162f0,0x17370
.long 0x151b0,0x154b0,0x16530,0x175b0,0x15270,0x15570,0x165f0,0x17670
.long 0x15330,0x163b0,0x166b0,0x17730,0x153f0,0x16470,0x16770,0x177f0
.long 0x16b00,0x17b80,0x3f80,0x0,0x16bc0,0x17c40,0x3f800000,0x0
.long 0x17a00,0x17d00,0x0,0x3f80,0x17ac0,0x17dc0,0x0,0x3f800000
.long 0x16f80,0x18000,0x3f80,0x0,0x17040,0x180c0,0x3f800000,0x0
.long 0x17e80,0x18180,0x0,0x3f80,0x17f40,0x18240,0x0,0x3f800000
.long 0x17400,0x18480,0x3f80,0x0,0x174c0,0x18540,0x3f800000,0x0
.long 0x18300,0x18600,0x0,0x3f80,0x183c0,0x186c0,0x0,0x3f800000
.long 0x17880,0x18900,0x3f80,0x0,0x17940,0x189c0,0x3f800000,0x0
.long 0x18780,0x18a80,0x0,0x3f80,0x18840,0x18b40,0x0,0x3f800000
.long 0x16b10,0x17b90,0x3f80,0x0,0x16bd0,0x17c50,0x3f800000,0x0
.long 0x17a10,0x17d10,0x0,0x3f80,0x17ad0,0x17dd0,0x0,0x3f800000
.long 0x16f90,0x18010,0x3f80,0x0,0x17050,0x180d0,0x3f800000,0x0
.long 0x17e90,0x18190,0x0,0x3f80,0x17f50,0x18250,0x0,0x3f800000
.long 0x17410,0x18490,0x3f80,0x0,0x174d0,0x18550,0x3f800000,0x0
.long 0x18310,0x18610,0x0,0x3f80,0x183d0,0x186d0,0x0,0x3f800000
.long 0x17890,0x18910,0x3f80,0x0,0x17950,0x189d0,0x3f800000,0x0
.long 0x18790,0x18a90,0x0,0x3f80,0x18850,0x18b50,0x0,0x3f800000
.long 0x16b20,0x17ba0,0x3f80,0x0,0x16be0,0x17c60,0x3f800000,0x0
.long 0x17a20,0x17d20,0x0,0x3f80,0x17ae0,0x17de0,0x0,0x3f800000
.long 0x16fa0,0x18020,0x3f80,0x0,0x17060,0x180e0,0x3f800000,0x0
.long 0x17ea0,0x181a0,0x0,0x3f80,0x17f60,0x18260,0x0,0x3f800000
.long 0x17420,0x184a0,0x3f80,0x0,0x174e0,0x18560,0x3f800000,0x0
.long 0x18320,0x18620,0x0,0x3f80,0x183e0,0x186e0,0x0,0x3f800000
.long 0x178a0,0x18920,0x3f80,0x0,0x17960,0x189e0,0x3f800000,0x0
.long 0x187a0,0x18aa0,0x0,0x3f80,0x18860,0x18b60,0x0,0x3f800000
.long 0x16b30,0x17bb0,0x3f80,0x0,0x16bf0,0x17c70,0x3f800000,0x0
.long 0x17a30,0x17d30,0x0,0x3f80,0x17af0,0x17df0,0x0,0x3f800000
.long 0x16fb0,0x18030,0x3f80,0x0,0x17070,0x180f0,0x3f800000,0x0
.long 0x17eb0,0x181b0,0x0,0x3f80,0x17f70,0x18270,0x0,0x3f800000
.long 0x17430,0x184b0,0x3f80,0x0,0x174f0,0x18570,0x3f800000,0x0
.long 0x18330,0x18630,0x0,0x3f80,0x183f0,0x186f0,0x0,0x3f800000
.long 0x178b0,0x18930,0x3f80,0x0,0x17970,0x189f0,0x3f800000,0x0
.long 0x187b0,0x18ab0,0x0,0x3f80,0x18870,0x18b70,0x0,0x3f800000
.long 0x0,0x30040,0x60080,0x0,0xc0,0x30100,0x60140,0xc0
.long 0x180,0x301c0,0x60200,0x180,0x240,0x30280,0x77cc0,0x240
.long 0x300,0x30340,0x77d80,0x300,0x3c0,0x47e00,0x77e40,0x3c0
.long 0x480,0x47ec0,0x77f00,0x480,0x17f40,0x47f80,0x77fc0,0x17f40
.long 0x18000,0x48040,0x78080,0x18000,0x180c0,0x48100,0x78140,0x180c0
.long 0x18180,0x481c0,0x8fc00,0x18180,0x18240,0x48280,0x8fcc0,0x18240
.long 0x18300,0x5fd40,0x8fd80,0x7f000000,0x183c0,0x5fe00,0x8fe40,0x7f000000
.long 0x2fe80,0x5fec0,0x8ff00,0x7f000000,0x2ff40,0x5ff80,0x8ffc0,0x7f000000
.long 0x10,0x30050,0x60090,0x10,0xd0,0x30110,0x60150,0xd0
.long 0x190,0x301d0,0x60210,0x190,0x250,0x30290,0x77cd0,0x250
.long 0x310,0x30350,0x77d90,0x310,0x3d0,0x47e10,0x77e50,0x3d0
.long 0x490,0x47ed0,0x77f10,0x490,0x17f50,0x47f90,0x77fd0,0x17f50
.long 0x18010,0x48050,0x78090,0x18010,0x180d0,0x48110,0x78150,0x180d0
.long 0x18190,0x481d0,0x8fc10,0x18190,0x18250,0x48290,0x8fcd0,0x18250
.long 0x18310,0x5fd50,0x8fd90,0x7f000000,0x183d0,0x5fe10,0x8fe50,0x7f000000
.long 0x2fe90,0x5fed0,0x8ff10,0x7f000000,0x2ff50,0x5ff90,0x8ffd0,0x7f000000
.long 0x20,0x30060,0x600a0,0x20,0xe0,0x30120,0x60160,0xe0
.long 0x1a0,0x301e0,0x60220,0x1a0,0x260,0x302a0,0x77ce0,0x260
.long 0x320,0x30360,0x77da0,0x320,0x3e0,0x47e20,0x77e60,0x3e0
.long 0x4a0,0x47ee0,0x77f20,0x4a0,0x17f60,0x47fa0,0x77fe0,0x17f60
.long 0x18020,0x48060,0x780a0,0x18020,0x180e0,0x48120,0x78160,0x180e0
.long 0x181a0,0x481e0,0x8fc20,0x181a0,0x18260,0x482a0,0x8fce0,0x18260
.long 0x18320,0x5fd60,0x8fda0,0x7f000000,0x183e0,0x5fe20,0x8fe60,0x7f000000
.long 0x2fea0,0x5fee0,0x8ff20,0x7f000000,0x2ff60,0x5ffa0,0x8ffe0,0x7f000000
.long 0x30,0x30070,0x600b0,0x30,0xf0,0x30130,0x60170,0xf0
.long 0x1b0,0x301f0,0x60230,0x1b0,0x270,0x302b0,0x77cf0,0x270
.long 0x330,0x30370,0x77db0,0x330,0x3f0,0x47e30,0x77e70,0x3f0
.long 0x4b0,0x47ef0,0x77f30,0x4b0,0x17f70,0x47fb0,0x77ff0,0x17f70
.long 0x18030,0x48070,0x780b0,0x18030,0x180f0,0x48130,0x78170,0x180f0
.long 0x181b0,0x481f0,0x8fc30,0x181b0,0x18270,0x482b0,0x8fcf0,0x18270
.long 0x18330,0x5fd70,0x8fdb0,0x7f000000,0x183f0,0x5fe30,0x8fe70,0x7f000000
.long 0x2feb0,0x5fef0,0x8ff30,0x7f000000,0x2ff70,0x5ffb0,0x8fff0,0x7f000000
.long 0x40,0x30080,0x60080,0x18300,0x100,0x30140,0x60140,0x183c0
.long 0x1c0,0x30200,0x60200,0x2fe80,0x280,0x302c0,0x77cc0,0x2ff40
.long 0x340,0x30380,0x77d80,0x30000,0x400,0x47e40,0x77e40,0x300c0
.long 0x4c0,0x47f00,0x77f00,0x30180,0x17f80,0x47fc0,0x77fc0,0x30240
.long 0x18040,0x48080,0x78080,0x30300,0x18100,0x48140,0x78140,0x47dc0
.long 0x181c0,0x48200,0x8fc00,0x47e80,0x18280,0x482c0,0x8fcc0,0x47f40
.long 0x18340,0x5fd80,0x8fd80,0x7f000000,0x18400,0x5fe40,0x8fe40,0x7f000000
.long 0x2fec0,0x5ff00,0x8ff00,0x7f000000,0x2ff80,0x5ffc0,0x8ffc0,0x7f000000
.long 0x50,0x30090,0x60090,0x18310,0x110,0x30150,0x60150,0x183d0
.long 0x1d0,0x30210,0x60210,0x2fe90,0x290,0x302d0,0x77cd0,0x2ff50
.long 0x350,0x30390,0x77d90,0x30010,0x410,0x47e50,0x77e50,0x300d0
.long 0x4d0,0x47f10,0x77f10,0x30190,0x17f90,0x47fd0,0x77fd0,0x30250
.long 0x18050,0x48090,0x78090,0x30310,0x18110,0x48150,0x78150,0x47dd0
.long 0x181d0,0x48210,0x8fc10,0x47e90,0x18290,0x482d0,0x8fcd0,0x47f50
.long 0x18350,0x5fd90,0x8fd90,0x7f000000,0x18410,0x5fe50,0x8fe50,0x7f000000
.long 0x2fed0,0x5ff10,0x8ff10,0x7f000000,0x2ff90,0x5ffd0,0x8ffd0,0x7f000000
.long 0x60,0x300a0,0x600a0,0x18320,0x120,0x30160,0x60160,0x183e0
.long 0x1e0,0x30220,0x60220,0x2fea0,0x2a0,0x302e0,0x77ce0,0x2ff60
.long 0x360,0x303a0,0x77da0,0x30020,0x420,0x47e60,0x77e60,0x300e0
.long 0x4e0,0x47f20,0x77f20,0x301a0,0x17fa0,0x47fe0,0x77fe0,0x30260
.long 0x18060,0x480a0,0x780a0,0x30320,0x18120,0x48160,0x78160,0x47de0
.long 0x181e0,0x48220,0x8fc20,0x47ea0,0x182a0,0x482e0,0x8fce0,0x47f60
.long 0x18360,0x5fda0,0x8fda0,0x7f000000,0x18420,0x5fe60,0x8fe60,0x7f000000
.long 0x2fee0,0x5ff20,0x8ff20,0x7f000000,0x2ffa0,0x5ffe0,0x8ffe0,0x7f000000
.long 0x70,0x300b0,0x600b0,0x18330,0x130,0x30170,0x60170,0x183f0
.long 0x1f0,0x30230,0x60230,0x2feb0,0x2b0,0x302f0,0x77cf0,0x2ff70
.long 0x370,0x303b0,0x77db0,0x30030,0x430,0x47e70,0x77e70,0x300f0
.long 0x4f0,0x47f30,0x77f30,0x301b0,0x17fb0,0x47ff0,0x77ff0,0x30270
.long 0x18070,0x480b0,0x780b0,0x30330,0x18130,0x48170,0x78170,0x47df0
.long 0x181f0,0x48230,0x8fc30,0x47eb0,0x182b0,0x482f0,0x8fcf0,0x47f70
.long 0x18370,0x5fdb0,0x8fdb0,0x7f000000,0x18430,0x5fe70,0x8fe70,0x7f000000
.long 0x2fef0,0x5ff30,0x8ff30,0x7f000000,0x2ffb0,0x5fff0,0x8fff0,0x7f000000
.long 0x80,0x60000,0x60080,0x48000,0x140,0x600c0,0x60140,0x480c0
.long 0x200,0x60180,0x60200,0x48180,0x2c0,0x77c40,0x77cc0,0x48240
.long 0x380,0x77d00,0x77d80,0x5fd00,0x440,0x77dc0,0x77e40,0x5fdc0
.long 0x500,0x77e80,0x77f00,0x5fe80,0x17fc0,0x77f40,0x77fc0,0x5ff40
.long 0x18080,0x78000,0x78080,0x60000,0x18140,0x780c0,0x78140,0x600c0
.long 0x18200,0x8fb80,0x8fc00,0x60180,0x182c0,0x8fc40,0x8fcc0,0x77c40
.long 0x18380,0x8fd00,0x8fd80,0x7f000000,0x18440,0x8fdc0,0x8fe40,0x7f000000
.long 0x2ff00,0x8fe80,0x8ff00,0x7f000000,0x2ffc0,0x8ff40,0x8ffc0,0x7f000000
.long 0x90,0x60010,0x60090,0x48010,0x150,0x600d0,0x60150,0x480d0
.long 0x210,0x60190,0x60210,0x48190,0x2d0,0x77c50,0x77cd0,0x48250
.long 0x390,0x77d10,0x77d90,0x5fd10,0x450,0x77dd0,0x77e50,0x5fdd0
.long 0x510,0x77e90,0x77f10,0x5fe90,0x17fd0,0x77f50,0x77fd0,0x5ff50
.long 0x18090,0x78010,0x78090,0x60010,0x18150,0x780d0,0x78150,0x600d0
.long 0x18210,0x8fb90,0x8fc10,0x60190,0x182d0,0x8fc50,0x8fcd0,0x77c50
.long 0x18390,0x8fd10,0x8fd90,0x7f000000,0x18450,0x8fdd0,0x8fe50,0x7f000000
.long 0x2ff10,0x8fe90,0x8ff10,0x7f000000,0x2ffd0,0x8ff50,0x8ffd0,0x7f000000
.long 0xa0,0x60020,0x600a0,0x48020,0x160,0x600e0,0x60160,0x480e0
.long 0x220,0x601a0,0x60220,0x481a0,0x2e0,0x77c60,0x77ce0,0x48260
.long 0x3a0,0x77d20,0x77da0,0x5fd20,0x460,0x77de0,0x77e60,0x5fde0
.long 0x520,0x77ea0,0x77f20,0x5fea0,0x17fe0,0x77f60,0x77fe0,0x5ff60
.long 0x180a0,0x78020,0x780a0,0x60020,0x18160,0x780e0,0x78160,0x600e0
.long 0x18220,0x8fba0,0x8fc20,0x601a0,0x182e0,0x8fc60,0x8fce0,0x77c60
.long 0x183a0,0x8fd20,0x8fda0,0x7f000000,0x18460,0x8fde0,0x8fe60,0x7f000000
.long 0x2ff20,0x8fea0,0x8ff20,0x7f000000,0x2ffe0,0x8ff60,0x8ffe0,0x7f000000
.long 0xb0,0x60030,0x600b0,0x48030,0x170,0x600f0,0x60170,0x480f0
.long 0x230,0x601b0,0x60230,0x481b0,0x2f0,0x77c70,0x77cf0,0x48270
.long 0x3b0,0x77d30,0x77db0,0x5fd30,0x470,0x77df0,0x77e70,0x5fdf0
.long 0x530,0x77eb0,0x77f30,0x5feb0,0x17ff0,0x77f70,0x77ff0,0x5ff70
.long 0x180b0,0x78030,0x780b0,0x60030,0x18170,0x780f0,0x78170,0x600f0
.long 0x18230,0x8fbb0,0x8fc30,0x601b0,0x182f0,0x8fc70,0x8fcf0,0x77c70
.long 0x183b0,0x8fd30,0x8fdb0,0x7f000000,0x18470,0x8fdf0,0x8fe70,0x7f000000
.long 0x2ff30,0x8feb0,0x8ff30,0x7f000000,0x2fff0,0x8ff70,0x8fff0,0x7f000000
.long 0x30000,0x60040,0x60080,0x77d00,0x300c0,0x60100,0x60140,0x77dc0
.long 0x30180,0x601c0,0x60200,0x77e80,0x30240,0x77c80,0x77cc0,0x77f40
.long 0x30300,0x77d40,0x77d80,0x78000,0x47dc0,0x77e00,0x77e40,0x780c0
.long 0x47e80,0x77ec0,0x77f00,0x8fb80,0x47f40,0x77f80,0x77fc0,0x8fc40
.long 0x48000,0x78040,0x78080,0x8fd00,0x480c0,0x78100,0x78140,0x8fdc0
.long 0x48180,0x8fbc0,0x8fc00,0x8fe80,0x48240,0x8fc80,0x8fcc0,0x8ff40
.long 0x5fd00,0x8fd40,0x8fd80,0x90000,0x5fdc0,0x8fe00,0x8fe40,0x7f000000
.long 0x5fe80,0x8fec0,0x8ff00,0x7f000000,0x5ff40,0x8ff80,0x8ffc0,0x7f000000
.long 0x30010,0x60050,0x60090,0x77d10,0x300d0,0x60110,0x60150,0x77dd0
.long 0x30190,0x601d0,0x60210,0x77e90,0x30250,0x77c90,0x77cd0,0x77f50
.long 0x30310,0x77d50,0x77d90,0x78010,0x47dd0,0x77e10,0x77e50,0x780d0
.long 0x47e90,0x77ed0,0x77f10,0x8fb90,0x47f50,0x77f90,0x77fd0,0x8fc50
.long 0x48010,0x78050,0x78090,0x8fd10,0x480d0,0x78110,0x78150,0x8fdd0
.long 0x48190,0x8fbd0,0x8fc10,0x8fe90,0x48250,0x8fc90,0x8fcd0,0x8ff50
.long 0x5fd10,0x8fd50,0x8fd90,0x90010,0x5fdd0,0x8fe10,0x8fe50,0x7f000000
.long 0x5fe90,0x8fed0,0x8ff10,0x7f000000,0x5ff50,0x8ff90,0x8ffd0,0x7f000000
.long 0x30020,0x60060,0x600a0,0x77d20,0x300e0,0x60120,0x60160,0x77de0
.long 0x301a0,0x601e0,0x60220,0x77ea0,0x30260,0x77ca0,0x77ce0,0x77f60
.long 0x30320,0x77d60,0x77da0,0x78020,0x47de0,0x77e20,0x77e60,0x780e0
.long 0x47ea0,0x77ee0,0x77f20,0x8fba0,0x47f60,0x77fa0,0x77fe0,0x8fc60
.long 0x48020,0x78060,0x780a0,0x8fd20,0x480e0,0x78120,0x78160,0x8fde0
.long 0x481a0,0x8fbe0,0x8fc20,0x8fea0,0x48260,0x8fca0,0x8fce0,0x8ff60
.long 0x5fd20,0x8fd60,0x8fda0,0x90020,0x5fde0,0x8fe20,0x8fe60,0x7f000000
.long 0x5fea0,0x8fee0,0x8ff20,0x7f000000,0x5ff60,0x8ffa0,0x8ffe0,0x7f000000
.long 0x30030,0x60070,0x600b0,0x77d30,0x300f0,0x60130,0x60170,0x77df0
.long 0x301b0,0x601f0,0x60230,0x77eb0,0x30270,0x77cb0,0x77cf0,0x77f70
.long 0x30330,0x77d70,0x77db0,0x78030,0x47df0,0x77e30,0x77e70,0x780f0
.long 0x47eb0,0x77ef0,0x77f30,0x8fbb0,0x47f70,0x77fb0,0x77ff0,0x8fc70
.long 0x48030,0x78070,0x780b0,0x8fd30,0x480f0,0x78130,0x78170,0x8fdf0
.long 0x481b0,0x8fbf0,0x8fc30,0x8feb0,0x48270,0x8fcb0,0x8fcf0,0x8ff70
.long 0x5fd30,0x8fd70,0x8fdb0,0x90030,0x5fdf0,0x8fe30,0x8fe70,0x7f000000
.long 0x5feb0,0x8fef0,0x8ff30,0x7f000000,0x5ff70,0x8ffb0,0x8fff0,0x7f000000
.long 0x2f703c0,0x2fa0400,0x380,0x2f703c0,0x2f70480,0x2fa04c0,0x440,0x2f70480
.long 0x2f70540,0x2fa0580,0x500,0x2f70540,0x2f70600,0x2fa0640,0x17fc0,0x2f70600
.long 0x2f706c0,0x2fa0700,0x18080,0x2f706c0,0x2f70780,0x2fb81c0,0x18140,0x2f70780
.long 0x2f70840,0x2fb8280,0x18200,0x2f70840,0x2f88300,0x2fb8340,0x182c0,0x2f88300
.long 0x2f883c0,0x2fb8400,0x18380,0x2f883c0,0x2f88480,0x2fb84c0,0x18440,0x2f88480
.long 0x2f88540,0x2fb8580,0x2ff00,0x2f88540,0x2f88600,0x2fb8640,0x2ffc0,0x2f88600
.long 0x2f886c0,0x40,0x30080,0x7f000000,0x2f88780,0x100,0x30140,0x7f000000
.long 0x2fa0240,0x1c0,0x30200,0x7f000000,0x2fa0300,0x280,0x302c0,0x7f000000
.long 0x2f703d0,0x2fa0410,0x390,0x2f703d0,0x2f70490,0x2fa04d0,0x450,0x2f70490
.long 0x2f70550,0x2fa0590,0x510,0x2f70550,0x2f70610,0x2fa0650,0x17fd0,0x2f70610
.long 0x2f706d0,0x2fa0710,0x18090,0x2f706d0,0x2f70790,0x2fb81d0,0x18150,0x2f70790
.long 0x2f70850,0x2fb8290,0x18210,0x2f70850,0x2f88310,0x2fb8350,0x182d0,0x2f88310
.long 0x2f883d0,0x2fb8410,0x18390,0x2f883d0,0x2f88490,0x2fb84d0,0x18450,0x2f88490
.long 0x2f88550,0x2fb8590,0x2ff10,0x2f88550,0x2f88610,0x2fb8650,0x2ffd0,0x2f88610
.long 0x2f886d0,0x50,0x30090,0x7f000000,0x2f88790,0x110,0x30150,0x7f000000
.long 0x2fa0250,0x1d0,0x30210,0x7f000000,0x2fa0310,0x290,0x302d0,0x7f000000
.long 0x2f703e0,0x2fa0420,0x3a0,0x2f703e0,0x2f704a0,0x2fa04e0,0x460,0x2f704a0
.long 0x2f70560,0x2fa05a0,0x520,0x2f70560,0x2f70620,0x2fa0660,0x17fe0,0x2f70620
.long 0x2f706e0,0x2fa0720,0x180a0,0x2f706e0,0x2f707a0,0x2fb81e0,0x18160,0x2f707a0
.long 0x2f70860,0x2fb82a0,0x18220,0x2f70860,0x2f88320,0x2fb8360,0x182e0,0x2f88320
.long 0x2f883e0,0x2fb8420,0x183a0,0x2f883e0,0x2f884a0,0x2fb84e0,0x18460,0x2f884a0
.long 0x2f88560,0x2fb85a0,0x2ff20,0x2f88560,0x2f88620,0x2fb8660,0x2ffe0,0x2f88620
.long 0x2f886e0,0x60,0x300a0,0x7f000000,0x2f887a0,0x120,0x30160,0x7f000000
.long 0x2fa0260,0x1e0,0x30220,0x7f000000,0x2fa0320,0x2a0,0x302e0,0x7f000000
.long 0x2f703f0,0x2fa0430,0x3b0,0x2f703f0,0x2f704b0,0x2fa04f0,0x470,0x2f704b0
.long 0x2f70570,0x2fa05b0,0x530,0x2f70570,0x2f70630,0x2fa0670,0x17ff0,0x2f70630
.long 0x2f706f0,0x2fa0730,0x180b0,0x2f706f0,0x2f707b0,0x2fb81f0,0x18170,0x2f707b0
.long 0x2f70870,0x2fb82b0,0x18230,0x2f70870,0x2f88330,0x2fb8370,0x182f0,0x2f88330
.long 0x2f883f0,0x2fb8430,0x183b0,0x2f883f0,0x2f884b0,0x2fb84f0,0x18470,0x2f884b0
.long 0x2f88570,0x2fb85b0,0x2ff30,0x2f88570,0x2f88630,0x2fb8670,0x2fff0,0x2f88630
.long 0x2f886f0,0x70,0x300b0,0x7f000000,0x2f887b0,0x130,0x30170,0x7f000000
.long 0x2fa0270,0x1f0,0x30230,0x7f000000,0x2fa0330,0x2b0,0x302f0,0x7f000000
.long 0x2f70400,0x2fa0440,0x380,0x2f886c0,0x2f704c0,0x2fa0500,0x440,0x2f88780
.long 0x2f70580,0x2fa05c0,0x500,0x2fa0240,0x2f70640,0x2fa0680,0x17fc0,0x2fa0300
.long 0x2f70700,0x2fa0740,0x18080,0x2fa03c0,0x2f707c0,0x2fb8200,0x18140,0x2fa0480
.long 0x2f70880,0x2fb82c0,0x18200,0x2fa0540,0x2f88340,0x2fb8380,0x182c0,0x2fa0600
.long 0x2f88400,0x2fb8440,0x18380,0x2fa06c0,0x2f884c0,0x2fb8500,0x18440,0x2fb8180
.long 0x2f88580,0x2fb85c0,0x2ff00,0x2fb8240,0x2f88640,0x2fb8680,0x2ffc0,0x2fb8300
.long 0x2f88700,0x80,0x30080,0x7f000000,0x2f887c0,0x140,0x30140,0x7f000000
.long 0x2fa0280,0x200,0x30200,0x7f000000,0x2fa0340,0x2c0,0x302c0,0x7f000000
.long 0x2f70410,0x2fa0450,0x390,0x2f886d0,0x2f704d0,0x2fa0510,0x450,0x2f88790
.long 0x2f70590,0x2fa05d0,0x510,0x2fa0250,0x2f70650,0x2fa0690,0x17fd0,0x2fa0310
.long 0x2f70710,0x2fa0750,0x18090,0x2fa03d0,0x2f707d0,0x2fb8210,0x18150,0x2fa0490
.long 0x2f70890,0x2fb82d0,0x18210,0x2fa0550,0x2f88350,0x2fb8390,0x182d0,0x2fa0610
.long 0x2f88410,0x2fb8450,0x18390,0x2fa06d0,0x2f884d0,0x2fb8510,0x18450,0x2fb8190
.long 0x2f88590,0x2fb85d0,0x2ff10,0x2fb8250,0x2f88650,0x2fb8690,0x2ffd0,0x2fb8310
.long 0x2f88710,0x90,0x30090,0x7f000000,0x2f887d0,0x150,0x30150,0x7f000000
.long 0x2fa0290,0x210,0x30210,0x7f000000,0x2fa0350,0x2d0,0x302d0,0x7f000000
.long 0x2f70420,0x2fa0460,0x3a0,0x2f886e0,0x2f704e0,0x2fa0520,0x460,0x2f887a0
.long 0x2f705a0,0x2fa05e0,0x520,0x2fa0260,0x2f70660,0x2fa06a0,0x17fe0,0x2fa0320
.long 0x2f70720,0x2fa0760,0x180a0,0x2fa03e0,0x2f707e0,0x2fb8220,0x18160,0x2fa04a0
.long 0x2f708a0,0x2fb82e0,0x18220,0x2fa0560,0x2f88360,0x2fb83a0,0x182e0,0x2fa0620
.long 0x2f88420,0x2fb8460,0x183a0,0x2fa06e0,0x2f884e0,0x2fb8520,0x18460,0x2fb81a0
.long 0x2f885a0,0x2fb85e0,0x2ff20,0x2fb8260,0x2f88660,0x2fb86a0,0x2ffe0,0x2fb8320
.long 0x2f88720,0xa0,0x300a0,0x7f000000,0x2f887e0,0x160,0x30160,0x7f000000
.long 0x2fa02a0,0x220,0x30220,0x7f000000,0x2fa0360,0x2e0,0x302e0,0x7f000000
.long 0x2f70430,0x2fa0470,0x3b0,0x2f886f0,0x2f704f0,0x2fa0530,0x470,0x2f887b0
.long 0x2f705b0,0x2fa05f0,0x530,0x2fa0270,0x2f70670,0x2fa06b0,0x17ff0,0x2fa0330
.long 0x2f70730,0x2fa0770,0x180b0,0x2fa03f0,0x2f707f0,0x2fb8230,0x18170,0x2fa04b0
.long 0x2f708b0,0x2fb82f0,0x18230,0x2fa0570,0x2f88370,0x2fb83b0,0x182f0,0x2fa0630
.long 0x2f88430,0x2fb8470,0x183b0,0x2fa06f0,0x2f884f0,0x2fb8530,0x18470,0x2fb81b0
.long 0x2f885b0,0x2fb85f0,0x2ff30,0x2fb8270,0x2f88670,0x2fb86b0,0x2fff0,0x2fb8330
.long 0x2f88730,0xb0,0x300b0,0x7f000000,0x2f887f0,0x170,0x30170,0x7f000000
.long 0x2fa02b0,0x230,0x30230,0x7f000000,0x2fa0370,0x2f0,0x302f0,0x7f000000
.long 0x2f70440,0x300,0x380,0x2fb83c0,0x2f70500,0x3c0,0x440,0x2fb8480
.long 0x2f705c0,0x480,0x500,0x2fb8540,0x2f70680,0x17f40,0x17fc0,0x2fb8600
.long 0x2f70740,0x18000,0x18080,0x0,0x2f70800,0x180c0,0x18140,0xc0
.long 0x2f708c0,0x18180,0x18200,0x180,0x2f88380,0x18240,0x182c0,0x240
.long 0x2f88440,0x18300,0x18380,0x300,0x2f88500,0x183c0,0x18440,0x3c0
.long 0x2f885c0,0x2fe80,0x2ff00,0x480,0x2f88680,0x2ff40,0x2ffc0,0x17f40
.long 0x2f88740,0x30000,0x30080,0x7f000000,0x2f88800,0x300c0,0x30140,0x7f000000
.long 0x2fa02c0,0x30180,0x30200,0x7f000000,0x2fa0380,0x30240,0x302c0,0x7f000000
.long 0x2f70450,0x310,0x390,0x2fb83d0,0x2f70510,0x3d0,0x450,0x2fb8490
.long 0x2f705d0,0x490,0x510,0x2fb8550,0x2f70690,0x17f50,0x17fd0,0x2fb8610
.long 0x2f70750,0x18010,0x18090,0x10,0x2f70810,0x180d0,0x18150,0xd0
.long 0x2f708d0,0x18190,0x18210,0x190,0x2f88390,0x18250,0x182d0,0x250
.long 0x2f88450,0x18310,0x18390,0x310,0x2f88510,0x183d0,0x18450,0x3d0
.long 0x2f885d0,0x2fe90,0x2ff10,0x490,0x2f88690,0x2ff50,0x2ffd0,0x17f50
.long 0x2f88750,0x30010,0x30090,0x7f000000,0x2f88810,0x300d0,0x30150,0x7f000000
.long 0x2fa02d0,0x30190,0x30210,0x7f000000,0x2fa0390,0x30250,0x302d0,0x7f000000
.long 0x2f70460,0x320,0x3a0,0x2fb83e0,0x2f70520,0x3e0,0x460,0x2fb84a0
.long 0x2f705e0,0x4a0,0x520,0x2fb8560,0x2f706a0,0x17f60,0x17fe0,0x2fb8620
.long 0x2f70760,0x18020,0x180a0,0x20,0x2f70820,0x180e0,0x18160,0xe0
.long 0x2f708e0,0x181a0,0x18220,0x1a0,0x2f883a0,0x18260,0x182e0,0x260
.long 0x2f88460,0x18320,0x183a0,0x320,0x2f88520,0x183e0,0x18460,0x3e0
.long 0x2f885e0,0x2fea0,0x2ff20,0x4a0,0x2f886a0,0x2ff60,0x2ffe0,0x17f60
.long 0x2f88760,0x30020,0x300a0,0x7f000000,0x2f88820,0x300e0,0x30160,0x7f000000
.long 0x2fa02e0,0x301a0,0x30220,0x7f000000,0x2fa03a0,0x30260,0x302e0,0x7f000000
.long 0x2f70470,0x330,0x3b0,0x2fb83f0,0x2f70530,0x3f0,0x470,0x2fb84b0
.long 0x2f705f0,0x4b0,0x530,0x2fb8570,0x2f706b0,0x17f70,0x17ff0,0x2fb8630
.long 0x2f70770,0x18030,0x180b0,0x30,0x2f70830,0x180f0,0x18170,0xf0
.long 0x2f708f0,0x181b0,0x18230,0x1b0,0x2f883b0,0x18270,0x182f0,0x270
.long 0x2f88470,0x18330,0x183b0,0x330,0x2f88530,0x183f0,0x18470,0x3f0
.long 0x2f885f0,0x2feb0,0x2ff30,0x4b0,0x2f886b0,0x2ff70,0x2fff0,0x17f70
.long 0x2f88770,0x30030,0x300b0,0x7f000000,0x2f88830,0x300f0,0x30170,0x7f000000
.long 0x2fa02f0,0x301b0,0x30230,0x7f000000,0x2fa03b0,0x30270,0x302f0,0x7f000000
.long 0x2fa03c0,0x340,0x380,0x18000,0x2fa0480,0x400,0x440,0x180c0
.long 0x2fa0540,0x4c0,0x500,0x18180,0x2fa0600,0x17f80,0x17fc0,0x18240
.long 0x2fa06c0,0x18040,0x18080,0x18300,0x2fb8180,0x18100,0x18140,0x183c0
.long 0x2fb8240,0x181c0,0x18200,0x2fe80,0x2fb8300,0x18280,0x182c0,0x2ff40
.long 0x2fb83c0,0x18340,0x18380,0x30000,0x2fb8480,0x18400,0x18440,0x300c0
.long 0x2fb8540,0x2fec0,0x2ff00,0x30180,0x2fb8600,0x2ff80,0x2ffc0,0x30240
.long 0x0,0x30040,0x30080,0x30300,0xc0,0x30100,0x30140,0x7f000000
.long 0x180,0x301c0,0x30200,0x7f000000,0x240,0x30280,0x302c0,0x7f000000
.long 0x2fa03d0,0x350,0x390,0x18010,0x2fa0490,0x410,0x450,0x180d0
.long 0x2fa0550,0x4d0,0x510,0x18190,0x2fa0610,0x17f90,0x17fd0,0x18250
.long 0x2fa06d0,0x18050,0x18090,0x18310,0x2fb8190,0x18110,0x18150,0x183d0
.long 0x2fb8250,0x181d0,0x18210,0x2fe90,0x2fb8310,0x18290,0x182d0,0x2ff50
.long 0x2fb83d0,0x18350,0x18390,0x30010,0x2fb8490,0x18410,0x18450,0x300d0
.long 0x2fb8550,0x2fed0,0x2ff10,0x30190,0x2fb8610,0x2ff90,0x2ffd0,0x30250
.long 0x10,0x30050,0x30090,0x30310,0xd0,0x30110,0x30150,0x7f000000
.long 0x190,0x301d0,0x30210,0x7f000000,0x250,0x30290,0x302d0,0x7f000000
.long 0x2fa03e0,0x360,0x3a0,0x18020,0x2fa04a0,0x420,0x460,0x180e0
.long 0x2fa0560,0x4e0,0x520,0x181a0,0x2fa0620,0x17fa0,0x17fe0,0x18260
.long 0x2fa06e0,0x18060,0x180a0,0x18320,0x2fb81a0,0x18120,0x18160,0x183e0
.long 0x2fb8260,0x181e0,0x18220,0x2fea0,0x2fb8320,0x182a0,0x182e0,0x2ff60
.long 0x2fb83e0,0x18360,0x183a0,0x30020,0x2fb84a0,0x18420,0x18460,0x300e0
.long 0x2fb8560,0x2fee0,0x2ff20,0x301a0,0x2fb8620,0x2ffa0,0x2ffe0,0x30260
.long 0x20,0x30060,0x300a0,0x30320,0xe0,0x30120,0x30160,0x7f000000
.long 0x1a0,0x301e0,0x30220,0x7f000000,0x260,0x302a0,0x302e0,0x7f000000
.long 0x2fa03f0,0x370,0x3b0,0x18030,0x2fa04b0,0x430,0x470,0x180f0
.long 0x2fa0570,0x4f0,0x530,0x181b0,0x2fa0630,0x17fb0,0x17ff0,0x18270
.long 0x2fa06f0,0x18070,0x180b0,0x18330,0x2fb81b0,0x18130,0x18170,0x183f0
.long 0x2fb8270,0x181f0,0x18230,0x2feb0,0x2fb8330,0x182b0,0x182f0,0x2ff70
.long 0x2fb83f0,0x18370,0x183b0,0x30030,0x2fb84b0,0x18430,0x18470,0x300f0
.long 0x2fb8570,0x2fef0,0x2ff30,0x301b0,0x2fb8630,0x2ffb0,0x2fff0,0x30270
.long 0x30,0x30070,0x300b0,0x30330,0xf0,0x30130,0x30170,0x7f000000
.long 0x1b0,0x301f0,0x30230,0x7f000000,0x270,0x302b0,0x302f0,0x7f000000
.long 0x17c40,0x47c80,0x5fd80,0x17c40,0x17d00,0x47d40,0x5fe40,0x17d00
.long 0x17dc0,0x2fec0,0x5ff00,0x17dc0,0x17e80,0x2ff80,0x8f900,0x17e80
.long 0x0,0x30040,0x8f9c0,0x0,0xc0,0x5fa40,0x8fa80,0xc0
.long 0x180,0x5fb00,0x8fb40,0x180,0x2fb80,0x5fbc0,0x77cc0,0x2fb80
.long 0x2fc40,0x5fc80,0x77d80,0x2fc40,0x2fd00,0x47e00,0x77e40,0x2fd00
.long 0x2fdc0,0x47ec0,0xa7840,0x2fdc0,0x17f40,0x47f80,0xa7900,0x17f40
.long 0x18000,0x77980,0xa79c0,0x7f000000,0x180c0,0x77a40,0xa7a80,0x7f000000
.long 0x47ac0,0x77b00,0x8fc00,0x7f000000,0x47b80,0x77bc0,0x8fcc0,0x7f000000
.long 0x17c50,0x47c90,0x5fd90,0x17c50,0x17d10,0x47d50,0x5fe50,0x17d10
.long 0x17dd0,0x2fed0,0x5ff10,0x17dd0,0x17e90,0x2ff90,0x8f910,0x17e90
.long 0x10,0x30050,0x8f9d0,0x10,0xd0,0x5fa50,0x8fa90,0xd0
.long 0x190,0x5fb10,0x8fb50,0x190,0x2fb90,0x5fbd0,0x77cd0,0x2fb90
.long 0x2fc50,0x5fc90,0x77d90,0x2fc50,0x2fd10,0x47e10,0x77e50,0x2fd10
.long 0x2fdd0,0x47ed0,0xa7850,0x2fdd0,0x17f50,0x47f90,0xa7910,0x17f50
.long 0x18010,0x77990,0xa79d0,0x7f000000,0x180d0,0x77a50,0xa7a90,0x7f000000
.long 0x47ad0,0x77b10,0x8fc10,0x7f000000,0x47b90,0x77bd0,0x8fcd0,0x7f000000
.long 0x17c60,0x47ca0,0x5fda0,0x17c60,0x17d20,0x47d60,0x5fe60,0x17d20
.long 0x17de0,0x2fee0,0x5ff20,0x17de0,0x17ea0,0x2ffa0,0x8f920,0x17ea0
.long 0x20,0x30060,0x8f9e0,0x20,0xe0,0x5fa60,0x8faa0,0xe0
.long 0x1a0,0x5fb20,0x8fb60,0x1a0,0x2fba0,0x5fbe0,0x77ce0,0x2fba0
.long 0x2fc60,0x5fca0,0x77da0,0x2fc60,0x2fd20,0x47e20,0x77e60,0x2fd20
.long 0x2fde0,0x47ee0,0xa7860,0x2fde0,0x17f60,0x47fa0,0xa7920,0x17f60
.long 0x18020,0x779a0,0xa79e0,0x7f000000,0x180e0,0x77a60,0xa7aa0,0x7f000000
.long 0x47ae0,0x77b20,0x8fc20,0x7f000000,0x47ba0,0x77be0,0x8fce0,0x7f000000
.long 0x17c70,0x47cb0,0x5fdb0,0x17c70,0x17d30,0x47d70,0x5fe70,0x17d30
.long 0x17df0,0x2fef0,0x5ff30,0x17df0,0x17eb0,0x2ffb0,0x8f930,0x17eb0
.long 0x30,0x30070,0x8f9f0,0x30,0xf0,0x5fa70,0x8fab0,0xf0
.long 0x1b0,0x5fb30,0x8fb70,0x1b0,0x2fbb0,0x5fbf0,0x77cf0,0x2fbb0
.long 0x2fc70,0x5fcb0,0x77db0,0x2fc70,0x2fd30,0x47e30,0x77e70,0x2fd30
.long 0x2fdf0,0x47ef0,0xa7870,0x2fdf0,0x17f70,0x47fb0,0xa7930,0x17f70
.long 0x18030,0x779b0,0xa79f0,0x7f000000,0x180f0,0x77a70,0xa7ab0,0x7f000000
.long 0x47af0,0x77b30,0x8fc30,0x7f000000,0x47bb0,0x77bf0,0x8fcf0,0x7f000000
.long 0x17c80,0x47cc0,0x5fd80,0x18000,0x17d40,0x47d80,0x5fe40,0x180c0
.long 0x17e00,0x2ff00,0x5ff00,0x47ac0,0x17ec0,0x2ffc0,0x8f900,0x47b80
.long 0x40,0x30080,0x8f9c0,0x47c40,0x100,0x5fa80,0x8fa80,0x47d00
.long 0x1c0,0x5fb40,0x8fb40,0x2fe80,0x2fbc0,0x5fc00,0x77cc0,0x2ff40
.long 0x2fc80,0x5fcc0,0x77d80,0x30000,0x2fd40,0x47e40,0x77e40,0x5fa00
.long 0x2fe00,0x47f00,0xa7840,0x5fac0,0x17f80,0x47fc0,0xa7900,0x5fb80
.long 0x18040,0x779c0,0xa79c0,0x7f000000,0x18100,0x77a80,0xa7a80,0x7f000000
.long 0x47b00,0x77b40,0x8fc00,0x7f000000,0x47bc0,0x77c00,0x8fcc0,0x7f000000
.long 0x17c90,0x47cd0,0x5fd90,0x18010,0x17d50,0x47d90,0x5fe50,0x180d0
.long 0x17e10,0x2ff10,0x5ff10,0x47ad0,0x17ed0,0x2ffd0,0x8f910,0x47b90
.long 0x50,0x30090,0x8f9d0,0x47c50,0x110,0x5fa90,0x8fa90,0x47d10
.long 0x1d0,0x5fb50,0x8fb50,0x2fe90,0x2fbd0,0x5fc10,0x77cd0,0x2ff50
.long 0x2fc90,0x5fcd0,0x77d90,0x30010,0x2fd50,0x47e50,0x77e50,0x5fa10
.long 0x2fe10,0x47f10,0xa7850,0x5fad0,0x17f90,0x47fd0,0xa7910,0x5fb90
.long 0x18050,0x779d0,0xa79d0,0x7f000000,0x18110,0x77a90,0xa7a90,0x7f000000
.long 0x47b10,0x77b50,0x8fc10,0x7f000000,0x47bd0,0x77c10,0x8fcd0,0x7f000000
.long 0x17ca0,0x47ce0,0x5fda0,0x18020,0x17d60,0x47da0,0x5fe60,0x180e0
.long 0x17e20,0x2ff20,0x5ff20,0x47ae0,0x17ee0,0x2ffe0,0x8f920,0x47ba0
.long 0x60,0x300a0,0x8f9e0,0x47c60,0x120,0x5faa0,0x8faa0,0x47d20
.long 0x1e0,0x5fb60,0x8fb60,0x2fea0,0x2fbe0,0x5fc20,0x77ce0,0x2ff60
.long 0x2fca0,0x5fce0,0x77da0,0x30020,0x2fd60,0x47e60,0x77e60,0x5fa20
.long 0x2fe20,0x47f20,0xa7860,0x5fae0,0x17fa0,0x47fe0,0xa7920,0x5fba0
.long 0x18060,0x779e0,0xa79e0,0x7f000000,0x18120,0x77aa0,0xa7aa0,0x7f000000
.long 0x47b20,0x77b60,0x8fc20,0x7f000000,0x47be0,0x77c20,0x8fce0,0x7f000000
.long 0x17cb0,0x47cf0,0x5fdb0,0x18030,0x17d70,0x47db0,0x5fe70,0x180f0
.long 0x17e30,0x2ff30,0x5ff30,0x47af0,0x17ef0,0x2fff0,0x8f930,0x47bb0
.long 0x70,0x300b0,0x8f9f0,0x47c70,0x130,0x5fab0,0x8fab0,0x47d30
.long 0x1f0,0x5fb70,0x8fb70,0x2feb0,0x2fbf0,0x5fc30,0x77cf0,0x2ff70
.long 0x2fcb0,0x5fcf0,0x77db0,0x30030,0x2fd70,0x47e70,0x77e70,0x5fa30
.long 0x2fe30,0x47f30,0xa7870,0x5faf0,0x17fb0,0x47ff0,0xa7930,0x5fbb0
.long 0x18070,0x779f0,0xa79f0,0x7f000000,0x18130,0x77ab0,0xa7ab0,0x7f000000
.long 0x47b30,0x77b70,0x8fc30,0x7f000000,0x47bf0,0x77c30,0x8fcf0,0x7f000000
.long 0x17cc0,0x5fd00,0x5fd80,0x5fc40,0x17d80,0x5fdc0,0x5fe40,0x47dc0
.long 0x17e40,0x5fe80,0x5ff00,0x47e80,0x17f00,0x8f880,0x8f900,0x47f40
.long 0x80,0x8f940,0x8f9c0,0x77940,0x140,0x8fa00,0x8fa80,0x77a00
.long 0x200,0x8fac0,0x8fb40,0x77ac0,0x2fc00,0x77c40,0x77cc0,0x77b80
.long 0x2fcc0,0x77d00,0x77d80,0x5fd00,0x2fd80,0x77dc0,0x77e40,0x5fdc0
.long 0x2fe40,0xa77c0,0xa7840,0x5fe80,0x17fc0,0xa7880,0xa7900,0x8f880
.long 0x18080,0xa7940,0xa79c0,0x7f000000,0x18140,0xa7a00,0xa7a80,0x7f000000
.long 0x47b40,0x8fb80,0x8fc00,0x7f000000,0x47c00,0x8fc40,0x8fcc0,0x7f000000
.long 0x17cd0,0x5fd10,0x5fd90,0x5fc50,0x17d90,0x5fdd0,0x5fe50,0x47dd0
.long 0x17e50,0x5fe90,0x5ff10,0x47e90,0x17f10,0x8f890,0x8f910,0x47f50
.long 0x90,0x8f950,0x8f9d0,0x77950,0x150,0x8fa10,0x8fa90,0x77a10
.long 0x210,0x8fad0,0x8fb50,0x77ad0,0x2fc10,0x77c50,0x77cd0,0x77b90
.long 0x2fcd0,0x77d10,0x77d90,0x5fd10,0x2fd90,0x77dd0,0x77e50,0x5fdd0
.long 0x2fe50,0xa77d0,0xa7850,0x5fe90,0x17fd0,0xa7890,0xa7910,0x8f890
.long 0x18090,0xa7950,0xa79d0,0x7f000000,0x18150,0xa7a10,0xa7a90,0x7f000000
.long 0x47b50,0x8fb90,0x8fc10,0x7f000000,0x47c10,0x8fc50,0x8fcd0,0x7f000000
.long 0x17ce0,0x5fd20,0x5fda0,0x5fc60,0x17da0,0x5fde0,0x5fe60,0x47de0
.long 0x17e60,0x5fea0,0x5ff20,0x47ea0,0x17f20,0x8f8a0,0x8f920,0x47f60
.long 0xa0,0x8f960,0x8f9e0,0x77960,0x160,0x8fa20,0x8faa0,0x77a20
.long 0x220,0x8fae0,0x8fb60,0x77ae0,0x2fc20,0x77c60,0x77ce0,0x77ba0
.long 0x2fce0,0x77d20,0x77da0,0x5fd20,0x2fda0,0x77de0,0x77e60,0x5fde0
.long 0x2fe60,0xa77e0,0xa7860,0x5fea0,0x17fe0,0xa78a0,0xa7920,0x8f8a0
.long 0x180a0,0xa7960,0xa79e0,0x7f000000,0x18160,0xa7a20,0xa7aa0,0x7f000000
.long 0x47b60,0x8fba0,0x8fc20,0x7f000000,0x47c20,0x8fc60,0x8fce0,0x7f000000
.long 0x17cf0,0x5fd30,0x5fdb0,0x5fc70,0x17db0,0x5fdf0,0x5fe70,0x47df0
.long 0x17e70,0x5feb0,0x5ff30,0x47eb0,0x17f30,0x8f8b0,0x8f930,0x47f70
.long 0xb0,0x8f970,0x8f9f0,0x77970,0x170,0x8fa30,0x8fab0,0x77a30
.long 0x230,0x8faf0,0x8fb70,0x77af0,0x2fc30,0x77c70,0x77cf0,0x77bb0
.long 0x2fcf0,0x77d30,0x77db0,0x5fd30,0x2fdb0,0x77df0,0x77e70,0x5fdf0
.long 0x2fe70,0xa77f0,0xa7870,0x5feb0,0x17ff0,0xa78b0,0xa7930,0x8f8b0
.long 0x180b0,0xa7970,0xa79f0,0x7f000000,0x18170,0xa7a30,0xa7ab0,0x7f000000
.long 0x47b70,0x8fbb0,0x8fc30,0x7f000000,0x47c30,0x8fc70,0x8fcf0,0x7f000000
.long 0x47c40,0x5fd40,0x5fd80,0x8f940,0x47d00,0x5fe00,0x5fe40,0x8fa00
.long 0x2fe80,0x5fec0,0x5ff00,0x8fac0,0x2ff40,0x8f8c0,0x8f900,0x77c40
.long 0x30000,0x8f980,0x8f9c0,0x77d00,0x5fa00,0x8fa40,0x8fa80,0x77dc0
.long 0x5fac0,0x8fb00,0x8fb40,0xa77c0,0x5fb80,0x77c80,0x77cc0,0xa7880
.long 0x5fc40,0x77d40,0x77d80,0xa7940,0x47dc0,0x77e00,0x77e40,0xa7a00
.long 0x47e80,0xa7800,0xa7840,0x8fb80,0x47f40,0xa78c0,0xa7900,0x8fc40
.long 0x77940,0xa7980,0xa79c0,0x8fd00,0x77a00,0xa7a40,0xa7a80,0x7f000000
.long 0x77ac0,0x8fbc0,0x8fc00,0x7f000000,0x77b80,0x8fc80,0x8fcc0,0x7f000000
.long 0x47c50,0x5fd50,0x5fd90,0x8f950,0x47d10,0x5fe10,0x5fe50,0x8fa10
.long 0x2fe90,0x5fed0,0x5ff10,0x8fad0,0x2ff50,0x8f8d0,0x8f910,0x77c50
.long 0x30010,0x8f990,0x8f9d0,0x77d10,0x5fa10,0x8fa50,0x8fa90,0x77dd0
.long 0x5fad0,0x8fb10,0x8fb50,0xa77d0,0x5fb90,0x77c90,0x77cd0,0xa7890
.long 0x5fc50,0x77d50,0x77d90,0xa7950,0x47dd0,0x77e10,0x77e50,0xa7a10
.long 0x47e90,0xa7810,0xa7850,0x8fb90,0x47f50,0xa78d0,0xa7910,0x8fc50
.long 0x77950,0xa7990,0xa79d0,0x8fd10,0x77a10,0xa7a50,0xa7a90,0x7f000000
.long 0x77ad0,0x8fbd0,0x8fc10,0x7f000000,0x77b90,0x8fc90,0x8fcd0,0x7f000000
.long 0x47c60,0x5fd60,0x5fda0,0x8f960,0x47d20,0x5fe20,0x5fe60,0x8fa20
.long 0x2fea0,0x5fee0,0x5ff20,0x8fae0,0x2ff60,0x8f8e0,0x8f920,0x77c60
.long 0x30020,0x8f9a0,0x8f9e0,0x77d20,0x5fa20,0x8fa60,0x8faa0,0x77de0
.long 0x5fae0,0x8fb20,0x8fb60,0xa77e0,0x5fba0,0x77ca0,0x77ce0,0xa78a0
.long 0x5fc60,0x77d60,0x77da0,0xa7960,0x47de0,0x77e20,0x77e60,0xa7a20
.long 0x47ea0,0xa7820,0xa7860,0x8fba0,0x47f60,0xa78e0,0xa7920,0x8fc60
.long 0x77960,0xa79a0,0xa79e0,0x8fd20,0x77a20,0xa7a60,0xa7aa0,0x7f000000
.long 0x77ae0,0x8fbe0,0x8fc20,0x7f000000,0x77ba0,0x8fca0,0x8fce0,0x7f000000
.long 0x47c70,0x5fd70,0x5fdb0,0x8f970,0x47d30,0x5fe30,0x5fe70,0x8fa30
.long 0x2feb0,0x5fef0,0x5ff30,0x8faf0,0x2ff70,0x8f8f0,0x8f930,0x77c70
.long 0x30030,0x8f9b0,0x8f9f0,0x77d30,0x5fa30,0x8fa70,0x8fab0,0x77df0
.long 0x5faf0,0x8fb30,0x8fb70,0xa77f0,0x5fbb0,0x77cb0,0x77cf0,0xa78b0
.long 0x5fc70,0x77d70,0x77db0,0xa7970,0x47df0,0x77e30,0x77e70,0xa7a30
.long 0x47eb0,0xa7830,0xa7870,0x8fbb0,0x47f70,0xa78f0,0xa7930,0x8fc70
.long 0x77970,0xa79b0,0xa79f0,0x8fd30,0x77a30,0xa7a70,0xa7ab0,0x7f000000
.long 0x77af0,0x8fbf0,0x8fc30,0x7f000000,0x77bb0,0x8fcb0,0x8fcf0,0x7f000000
.long 0x2f88000,0x2fb8040,0x80,0x2f88000,0x2f880c0,0x2fb8100,0x140,0x2f880c0
.long 0x2f88180,0x2fa0280,0x200,0x2f88180,0x2f88240,0x2fa0340,0x2fc00,0x2f88240
.long 0x2f703c0,0x2fa0400,0x2fcc0,0x2f703c0,0x2f70480,0x2fcfe00,0x2fd80,0x2f70480
.long 0x2f70540,0x2fcfec0,0x2fe40,0x2f70540,0x2f9ff40,0x2fcff80,0x17fc0,0x2f9ff40
.long 0x2fa0000,0x2fd0040,0x18080,0x2fa0000,0x2fa00c0,0x2fb81c0,0x18140,0x2fa00c0
.long 0x2fa0180,0x2fb8280,0x47b40,0x2fa0180,0x2f88300,0x2fb8340,0x47c00,0x2f88300
.long 0x2f883c0,0x17c80,0x47cc0,0x7f000000,0x2f88480,0x17d40,0x47d80,0x7f000000
.long 0x2fb7e80,0x17e00,0x2ff00,0x7f000000,0x2fb7f40,0x17ec0,0x2ffc0,0x7f000000
.long 0x2f88010,0x2fb8050,0x90,0x2f88010,0x2f880d0,0x2fb8110,0x150,0x2f880d0
.long 0x2f88190,0x2fa0290,0x210,0x2f88190,0x2f88250,0x2fa0350,0x2fc10,0x2f88250
.long 0x2f703d0,0x2fa0410,0x2fcd0,0x2f703d0,0x2f70490,0x2fcfe10,0x2fd90,0x2f70490
.long 0x2f70550,0x2fcfed0,0x2fe50,0x2f70550,0x2f9ff50,0x2fcff90,0x17fd0,0x2f9ff50
.long 0x2fa0010,0x2fd0050,0x18090,0x2fa0010,0x2fa00d0,0x2fb81d0,0x18150,0x2fa00d0
.long 0x2fa0190,0x2fb8290,0x47b50,0x2fa0190,0x2f88310,0x2fb8350,0x47c10,0x2f88310
.long 0x2f883d0,0x17c90,0x47cd0,0x7f000000,0x2f88490,0x17d50,0x47d90,0x7f000000
.long 0x2fb7e90,0x17e10,0x2ff10,0x7f000000,0x2fb7f50,0x17ed0,0x2ffd0,0x7f000000
.long 0x2f88020,0x2fb8060,0xa0,0x2f88020,0x2f880e0,0x2fb8120,0x160,0x2f880e0
.long 0x2f881a0,0x2fa02a0,0x220,0x2f881a0,0x2f88260,0x2fa0360,0x2fc20,0x2f88260
.long 0x2f703e0,0x2fa0420,0x2fce0,0x2f703e0,0x2f704a0,0x2fcfe20,0x2fda0,0x2f704a0
.long 0x2f70560,0x2fcfee0,0x2fe60,0x2f70560,0x2f9ff60,0x2fcffa0,0x17fe0,0x2f9ff60
.long 0x2fa0020,0x2fd0060,0x180a0,0x2fa0020,0x2fa00e0,0x2fb81e0,0x18160,0x2fa00e0
.long 0x2fa01a0,0x2fb82a0,0x47b60,0x2fa01a0,0x2f88320,0x2fb8360,0x47c20,0x2f88320
.long 0x2f883e0,0x17ca0,0x47ce0,0x7f000000,0x2f884a0,0x17d60,0x47da0,0x7f000000
.long 0x2fb7ea0,0x17e20,0x2ff20,0x7f000000,0x2fb7f60,0x17ee0,0x2ffe0,0x7f000000
.long 0x2f88030,0x2fb8070,0xb0,0x2f88030,0x2f880f0,0x2fb8130,0x170,0x2f880f0
.long 0x2f881b0,0x2fa02b0,0x230,0x2f881b0,0x2f88270,0x2fa0370,0x2fc30,0x2f88270
.long 0x2f703f0,0x2fa0430,0x2fcf0,0x2f703f0,0x2f704b0,0x2fcfe30,0x2fdb0,0x2f704b0
.long 0x2f70570,0x2fcfef0,0x2fe70,0x2f70570,0x2f9ff70,0x2fcffb0,0x17ff0,0x2f9ff70
.long 0x2fa0030,0x2fd0070,0x180b0,0x2fa0030,0x2fa00f0,0x2fb81f0,0x18170,0x2fa00f0
.long 0x2fa01b0,0x2fb82b0,0x47b70,0x2fa01b0,0x2f88330,0x2fb8370,0x47c30,0x2f88330
.long 0x2f883f0,0x17cb0,0x47cf0,0x7f000000,0x2f884b0,0x17d70,0x47db0,0x7f000000
.long 0x2fb7eb0,0x17e30,0x2ff30,0x7f000000,0x2fb7f70,0x17ef0,0x2fff0,0x7f000000
.long 0x2f88040,0x2fb8080,0x80,0x2f883c0,0x2f88100,0x2fb8140,0x140,0x2f88480
.long 0x2f881c0,0x2fa02c0,0x200,0x2fb7e80,0x2f88280,0x2fa0380,0x2fc00,0x2fb7f40
.long 0x2f70400,0x2fa0440,0x2fcc0,0x2fb8000,0x2f704c0,0x2fcfe40,0x2fd80,0x2fb80c0
.long 0x2f70580,0x2fcff00,0x2fe40,0x2fa0240,0x2f9ff80,0x2fcffc0,0x17fc0,0x2fa0300
.long 0x2fa0040,0x2fd0080,0x18080,0x2fa03c0,0x2fa0100,0x2fb8200,0x18140,0x2fcfdc0
.long 0x2fa01c0,0x2fb82c0,0x47b40,0x2fcfe80,0x2f88340,0x2fb8380,0x47c00,0x2fcff40
.long 0x2f88400,0x17cc0,0x47cc0,0x7f000000,0x2f884c0,0x17d80,0x47d80,0x7f000000
.long 0x2fb7ec0,0x17e40,0x2ff00,0x7f000000,0x2fb7f80,0x17f00,0x2ffc0,0x7f000000
.long 0x2f88050,0x2fb8090,0x90,0x2f883d0,0x2f88110,0x2fb8150,0x150,0x2f88490
.long 0x2f881d0,0x2fa02d0,0x210,0x2fb7e90,0x2f88290,0x2fa0390,0x2fc10,0x2fb7f50
.long 0x2f70410,0x2fa0450,0x2fcd0,0x2fb8010,0x2f704d0,0x2fcfe50,0x2fd90,0x2fb80d0
.long 0x2f70590,0x2fcff10,0x2fe50,0x2fa0250,0x2f9ff90,0x2fcffd0,0x17fd0,0x2fa0310
.long 0x2fa0050,0x2fd0090,0x18090,0x2fa03d0,0x2fa0110,0x2fb8210,0x18150,0x2fcfdd0
.long 0x2fa01d0,0x2fb82d0,0x47b50,0x2fcfe90,0x2f88350,0x2fb8390,0x47c10,0x2fcff50
.long 0x2f88410,0x17cd0,0x47cd0,0x7f000000,0x2f884d0,0x17d90,0x47d90,0x7f000000
.long 0x2fb7ed0,0x17e50,0x2ff10,0x7f000000,0x2fb7f90,0x17f10,0x2ffd0,0x7f000000
.long 0x2f88060,0x2fb80a0,0xa0,0x2f883e0,0x2f88120,0x2fb8160,0x160,0x2f884a0
.long 0x2f881e0,0x2fa02e0,0x220,0x2fb7ea0,0x2f882a0,0x2fa03a0,0x2fc20,0x2fb7f60
.long 0x2f70420,0x2fa0460,0x2fce0,0x2fb8020,0x2f704e0,0x2fcfe60,0x2fda0,0x2fb80e0
.long 0x2f705a0,0x2fcff20,0x2fe60,0x2fa0260,0x2f9ffa0,0x2fcffe0,0x17fe0,0x2fa0320
.long 0x2fa0060,0x2fd00a0,0x180a0,0x2fa03e0,0x2fa0120,0x2fb8220,0x18160,0x2fcfde0
.long 0x2fa01e0,0x2fb82e0,0x47b60,0x2fcfea0,0x2f88360,0x2fb83a0,0x47c20,0x2fcff60
.long 0x2f88420,0x17ce0,0x47ce0,0x7f000000,0x2f884e0,0x17da0,0x47da0,0x7f000000
.long 0x2fb7ee0,0x17e60,0x2ff20,0x7f000000,0x2fb7fa0,0x17f20,0x2ffe0,0x7f000000
.long 0x2f88070,0x2fb80b0,0xb0,0x2f883f0,0x2f88130,0x2fb8170,0x170,0x2f884b0
.long 0x2f881f0,0x2fa02f0,0x230,0x2fb7eb0,0x2f882b0,0x2fa03b0,0x2fc30,0x2fb7f70
.long 0x2f70430,0x2fa0470,0x2fcf0,0x2fb8030,0x2f704f0,0x2fcfe70,0x2fdb0,0x2fb80f0
.long 0x2f705b0,0x2fcff30,0x2fe70,0x2fa0270,0x2f9ffb0,0x2fcfff0,0x17ff0,0x2fa0330
.long 0x2fa0070,0x2fd00b0,0x180b0,0x2fa03f0,0x2fa0130,0x2fb8230,0x18170,0x2fcfdf0
.long 0x2fa01f0,0x2fb82f0,0x47b70,0x2fcfeb0,0x2f88370,0x2fb83b0,0x47c30,0x2fcff70
.long 0x2f88430,0x17cf0,0x47cf0,0x7f000000,0x2f884f0,0x17db0,0x47db0,0x7f000000
.long 0x2fb7ef0,0x17e70,0x2ff30,0x7f000000,0x2fb7fb0,0x17f30,0x2fff0,0x7f000000
.long 0x2f88080,0x0,0x80,0x2fd0000,0x2f88140,0xc0,0x140,0x2fb8180
.long 0x2f88200,0x180,0x200,0x2fb8240,0x2f882c0,0x2fb80,0x2fc00,0x2fb8300
.long 0x2f70440,0x2fc40,0x2fcc0,0x17c40,0x2f70500,0x2fd00,0x2fd80,0x17d00
.long 0x2f705c0,0x2fdc0,0x2fe40,0x17dc0,0x2f9ffc0,0x17f40,0x17fc0,0x17e80
.long 0x2fa0080,0x18000,0x18080,0x0,0x2fa0140,0x180c0,0x18140,0xc0
.long 0x2fa0200,0x47ac0,0x47b40,0x180,0x2f88380,0x47b80,0x47c00,0x2fb80
.long 0x2f88440,0x47c40,0x47cc0,0x7f000000,0x2f88500,0x47d00,0x47d80,0x7f000000
.long 0x2fb7f00,0x2fe80,0x2ff00,0x7f000000,0x2fb7fc0,0x2ff40,0x2ffc0,0x7f000000
.long 0x2f88090,0x10,0x90,0x2fd0010,0x2f88150,0xd0,0x150,0x2fb8190
.long 0x2f88210,0x190,0x210,0x2fb8250,0x2f882d0,0x2fb90,0x2fc10,0x2fb8310
.long 0x2f70450,0x2fc50,0x2fcd0,0x17c50,0x2f70510,0x2fd10,0x2fd90,0x17d10
.long 0x2f705d0,0x2fdd0,0x2fe50,0x17dd0,0x2f9ffd0,0x17f50,0x17fd0,0x17e90
.long 0x2fa0090,0x18010,0x18090,0x10,0x2fa0150,0x180d0,0x18150,0xd0
.long 0x2fa0210,0x47ad0,0x47b50,0x190,0x2f88390,0x47b90,0x47c10,0x2fb90
.long 0x2f88450,0x47c50,0x47cd0,0x7f000000,0x2f88510,0x47d10,0x47d90,0x7f000000
.long 0x2fb7f10,0x2fe90,0x2ff10,0x7f000000,0x2fb7fd0,0x2ff50,0x2ffd0,0x7f000000
.long 0x2f880a0,0x20,0xa0,0x2fd0020,0x2f88160,0xe0,0x160,0x2fb81a0
.long 0x2f88220,0x1a0,0x220,0x2fb8260,0x2f882e0,0x2fba0,0x2fc20,0x2fb8320
.long 0x2f70460,0x2fc60,0x2fce0,0x17c60,0x2f70520,0x2fd20,0x2fda0,0x17d20
.long 0x2f705e0,0x2fde0,0x2fe60,0x17de0,0x2f9ffe0,0x17f60,0x17fe0,0x17ea0
.long 0x2fa00a0,0x18020,0x180a0,0x20,0x2fa0160,0x180e0,0x18160,0xe0
.long 0x2fa0220,0x47ae0,0x47b60,0x1a0,0x2f883a0,0x47ba0,0x47c20,0x2fba0
.long 0x2f88460,0x47c60,0x47ce0,0x7f000000,0x2f88520,0x47d20,0x47da0,0x7f000000
.long 0x2fb7f20,0x2fea0,0x2ff20,0x7f000000,0x2fb7fe0,0x2ff60,0x2ffe0,0x7f000000
.long 0x2f880b0,0x30,0xb0,0x2fd0030,0x2f88170,0xf0,0x170,0x2fb81b0
.long 0x2f88230,0x1b0,0x230,0x2fb8270,0x2f882f0,0x2fbb0,0x2fc30,0x2fb8330
.long 0x2f70470,0x2fc70,0x2fcf0,0x17c70,0x2f70530,0x2fd30,0x2fdb0,0x17d30
.long 0x2f705f0,0x2fdf0,0x2fe70,0x17df0,0x2f9fff0,0x17f70,0x17ff0,0x17eb0
.long 0x2fa00b0,0x18030,0x180b0,0x30,0x2fa0170,0x180f0,0x18170,0xf0
.long 0x2fa0230,0x47af0,0x47b70,0x1b0,0x2f883b0,0x47bb0,0x47c30,0x2fbb0
.long 0x2f88470,0x47c70,0x47cf0,0x7f000000,0x2f88530,0x47d30,0x47db0,0x7f000000
.long 0x2fb7f30,0x2feb0,0x2ff30,0x7f000000,0x2fb7ff0,0x2ff70,0x2fff0,0x7f000000
.long 0x2fb8000,0x40,0x80,0x2fc40,0x2fb80c0,0x100,0x140,0x2fd00
.long 0x2fa0240,0x1c0,0x200,0x2fdc0,0x2fa0300,0x2fbc0,0x2fc00,0x17f40
.long 0x2fa03c0,0x2fc80,0x2fcc0,0x18000,0x2fcfdc0,0x2fd40,0x2fd80,0x180c0
.long 0x2fcfe80,0x2fe00,0x2fe40,0x47ac0,0x2fcff40,0x17f80,0x17fc0,0x47b80
.long 0x2fd0000,0x18040,0x18080,0x47c40,0x2fb8180,0x18100,0x18140,0x47d00
.long 0x2fb8240,0x47b00,0x47b40,0x2fe80,0x2fb8300,0x47bc0,0x47c00,0x2ff40
.long 0x17c40,0x47c80,0x47cc0,0x30000,0x17d00,0x47d40,0x47d80,0x7f000000
.long 0x17dc0,0x2fec0,0x2ff00,0x7f000000,0x17e80,0x2ff80,0x2ffc0,0x7f000000
.long 0x2fb8010,0x50,0x90,0x2fc50,0x2fb80d0,0x110,0x150,0x2fd10
.long 0x2fa0250,0x1d0,0x210,0x2fdd0,0x2fa0310,0x2fbd0,0x2fc10,0x17f50
.long 0x2fa03d0,0x2fc90,0x2fcd0,0x18010,0x2fcfdd0,0x2fd50,0x2fd90,0x180d0
.long 0x2fcfe90,0x2fe10,0x2fe50,0x47ad0,0x2fcff50,0x17f90,0x17fd0,0x47b90
.long 0x2fd0010,0x18050,0x18090,0x47c50,0x2fb8190,0x18110,0x18150,0x47d10
.long 0x2fb8250,0x47b10,0x47b50,0x2fe90,0x2fb8310,0x47bd0,0x47c10,0x2ff50
.long 0x17c50,0x47c90,0x47cd0,0x30010,0x17d10,0x47d50,0x47d90,0x7f000000
.long 0x17dd0,0x2fed0,0x2ff10,0x7f000000,0x17e90,0x2ff90,0x2ffd0,0x7f000000
.long 0x2fb8020,0x60,0xa0,0x2fc60,0x2fb80e0,0x120,0x160,0x2fd20
.long 0x2fa0260,0x1e0,0x220,0x2fde0,0x2fa0320,0x2fbe0,0x2fc20,0x17f60
.long 0x2fa03e0,0x2fca0,0x2fce0,0x18020,0x2fcfde0,0x2fd60,0x2fda0,0x180e0
.long 0x2fcfea0,0x2fe20,0x2fe60,0x47ae0,0x2fcff60,0x17fa0,0x17fe0,0x47ba0
.long 0x2fd0020,0x18060,0x180a0,0x47c60,0x2fb81a0,0x18120,0x18160,0x47d20
.long 0x2fb8260,0x47b20,0x47b60,0x2fea0,0x2fb8320,0x47be0,0x47c20,0x2ff60
.long 0x17c60,0x47ca0,0x47ce0,0x30020,0x17d20,0x47d60,0x47da0,0x7f000000
.long 0x17de0,0x2fee0,0x2ff20,0x7f000000,0x17ea0,0x2ffa0,0x2ffe0,0x7f000000
.long 0x2fb8030,0x70,0xb0,0x2fc70,0x2fb80f0,0x130,0x170,0x2fd30
.long 0x2fa0270,0x1f0,0x230,0x2fdf0,0x2fa0330,0x2fbf0,0x2fc30,0x17f70
.long 0x2fa03f0,0x2fcb0,0x2fcf0,0x18030,0x2fcfdf0,0x2fd70,0x2fdb0,0x180f0
.long 0x2fcfeb0,0x2fe30,0x2fe70,0x47af0,0x2fcff70,0x17fb0,0x17ff0,0x47bb0
.long 0x2fd0030,0x18070,0x180b0,0x47c70,0x2fb81b0,0x18130,0x18170,0x47d30
.long 0x2fb8270,0x47b30,0x47b70,0x2feb0,0x2fb8330,0x47bf0,0x47c30,0x2ff70
.long 0x17c70,0x47cb0,0x47cf0,0x30030,0x17d30,0x47d70,0x47db0,0x7f000000
.long 0x17df0,0x2fef0,0x2ff30,0x7f000000,0x17eb0,0x2ffb0,0x2fff0,0x7f000000
.long 0x90000,0x0,0x0,0x0,0x90000,0x4,0x4,0x17f40
.long 0x90000,0x8,0x8,0x2fe80,0x90000,0xc,0xc,0x47dc0
.long 0x90000,0x1,0x10,0x5fd00,0x90000,0x5,0x14,0x77c40
.long 0x90000,0x9,0x18,0x8fb80,0x90000,0xd,0x1c,0x7f000000
.long 0x90000,0x2,0x20,0x7f000000,0x90000,0x6,0x24,0x7f000000
.long 0x90000,0xa,0x28,0x7f000000,0x90000,0xe,0x2c,0x7f000000
.long 0x90000,0x3,0xc0,0x7f000000,0x90000,0x7,0xc0,0x7f000000
.long 0x90000,0xb,0xc0,0x7f000000,0x90000,0xf,0xc0,0x7f000000
.long 0x90010,0x0,0x340,0x7f000000,0x90010,0x4,0x344,0x7f000000
.long 0x90010,0x8,0x348,0x7f000000,0x90010,0xc,0x34c,0x7f000000
.long 0x90010,0x1,0x350,0x7f000000,0x90010,0x5,0x354,0x7f000000
.long 0x90010,0x9,0x358,0x7f000000,0x90010,0xd,0x35c,0x7f000000
.long 0x90010,0x2,0x360,0x7f000000,0x90010,0x6,0x364,0x7f000000
.long 0x90010,0xa,0x368,0x7f000000,0x90010,0xe,0x36c,0x7f000000
.long 0x90010,0x3,0x400,0x7f000000,0x90010,0x7,0x400,0x7f000000
.long 0x90010,0xb,0x400,0x7f000000,0x90010,0xf,0x400,0x7f000000
.long 0x90020,0x0,0x680,0x7f000000,0x90020,0x4,0x684,0x7f000000
.long 0x90020,0x8,0x688,0x7f000000,0x90020,0xc,0x68c,0x7f000000
.long 0x90020,0x1,0x690,0x7f000000,0x90020,0x5,0x694,0x7f000000
.long 0x90020,0x9,0x698,0x7f000000,0x90020,0xd,0x69c,0x7f000000
.long 0x90020,0x2,0x6a0,0x7f000000,0x90020,0x6,0x6a4,0x7f000000
.long 0x90020,0xa,0x6a8,0x7f000000,0x90020,0xe,0x6ac,0x7f000000
.long 0x90020,0x3,0x740,0x7f000000,0x90020,0x7,0x740,0x7f000000
.long 0x90020,0xb,0x740,0x7f000000,0x90020,0xf,0x740,0x7f000000
.long 0x90030,0x0,0x9c0,0x7f000000,0x90030,0x4,0x9c4,0x7f000000
.long 0x90030,0x8,0x9c8,0x7f000000,0x90030,0xc,0x9cc,0x7f000000
.long 0x90030,0x1,0x9d0,0x7f000000,0x90030,0x5,0x9d4,0x7f000000
.long 0x90030,0x9,0x9d8,0x7f000000,0x90030,0xd,0x9dc,0x7f000000
.long 0x90030,0x2,0x9e0,0x7f000000,0x90030,0x6,0x9e4,0x7f000000
.long 0x90030,0xa,0x9e8,0x7f000000,0x90030,0xe,0x9ec,0x7f000000
.long 0x90030,0x3,0xa80,0x7f000000,0x90030,0x7,0xa80,0x7f000000
.long 0x90030,0xb,0xa80,0x7f000000,0x90030,0xf,0xa80,0x7f000000
.long 0x90000,0x0,0x30,0x0,0x90000,0x4,0x34,0x17f40
.long 0x90000,0x8,0x38,0x2fe80,0x90000,0xc,0x3c,0x47dc0
.long 0x90000,0x1,0x40,0x5fd00,0x90000,0x5,0x44,0x77c40
.long 0x90000,0x9,0x48,0x8fb80,0x90000,0xd,0x4c,0x7f000000
.long 0x90000,0x2,0x50,0x7f000000,0x90000,0x6,0x54,0x7f000000
.long 0x90000,0xa,0x58,0x7f000000,0x90000,0xe,0x5c,0x7f000000
.long 0x90000,0x3,0xc0,0x7f000000,0x90000,0x7,0xc0,0x7f000000
.long 0x90000,0xb,0xc0,0x7f000000,0x90000,0xf,0xc0,0x7f000000
.long 0x90010,0x0,0x370,0x7f000000,0x90010,0x4,0x374,0x7f000000
.long 0x90010,0x8,0x378,0x7f000000,0x90010,0xc,0x37c,0x7f000000
.long 0x90010,0x1,0x380,0x7f000000,0x90010,0x5,0x384,0x7f000000
.long 0x90010,0x9,0x388,0x7f000000,0x90010,0xd,0x38c,0x7f000000
.long 0x90010,0x2,0x390,0x7f000000,0x90010,0x6,0x394,0x7f000000
.long 0x90010,0xa,0x398,0x7f000000,0x90010,0xe,0x39c,0x7f000000
.long 0x90010,0x3,0x400,0x7f000000,0x90010,0x7,0x400,0x7f000000
.long 0x90010,0xb,0x400,0x7f000000,0x90010,0xf,0x400,0x7f000000
.long 0x90020,0x0,0x6b0,0x7f000000,0x90020,0x4,0x6b4,0x7f000000
.long 0x90020,0x8,0x6b8,0x7f000000,0x90020,0xc,0x6bc,0x7f000000
.long 0x90020,0x1,0x6c0,0x7f000000,0x90020,0x5,0x6c4,0x7f000000
.long 0x90020,0x9,0x6c8,0x7f000000,0x90020,0xd,0x6cc,0x7f000000
.long 0x90020,0x2,0x6d0,0x7f000000,0x90020,0x6,0x6d4,0x7f000000
.long 0x90020,0xa,0x6d8,0x7f000000,0x90020,0xe,0x6dc,0x7f000000
.long 0x90020,0x3,0x740,0x7f000000,0x90020,0x7,0x740,0x7f000000
.long 0x90020,0xb,0x740,0x7f000000,0x90020,0xf,0x740,0x7f000000
.long 0x90030,0x0,0x9f0,0x7f000000,0x90030,0x4,0x9f4,0x7f000000
.long 0x90030,0x8,0x9f8,0x7f000000,0x90030,0xc,0x9fc,0x7f000000
.long 0x90030,0x1,0xa00,0x7f000000,0x90030,0x5,0xa04,0x7f000000
.long 0x90030,0x9,0xa08,0x7f000000,0x90030,0xd,0xa0c,0x7f000000
.long 0x90030,0x2,0xa10,0x7f000000,0x90030,0x6,0xa14,0x7f000000
.long 0x90030,0xa,0xa18,0x7f000000,0x90030,0xe,0xa1c,0x7f000000
.long 0x90030,0x3,0xa80,0x7f000000,0x90030,0x7,0xa80,0x7f000000
.long 0x90030,0xb,0xa80,0x7f000000,0x90030,0xf,0xa80,0x7f000000
.long 0x90000,0x0,0x60,0x0,0x90000,0x4,0x64,0x17f40
.long 0x90000,0x8,0x68,0x2fe80,0x90000,0xc,0x6c,0x47dc0
.long 0x90000,0x1,0x70,0x5fd00,0x90000,0x5,0x74,0x77c40
.long 0x90000,0x9,0x78,0x8fb80,0x90000,0xd,0x7c,0x7f000000
.long 0x90000,0x2,0x80,0x7f000000,0x90000,0x6,0x84,0x7f000000
.long 0x90000,0xa,0x88,0x7f000000,0x90000,0xe,0x8c,0x7f000000
.long 0x90000,0x3,0xc0,0x7f000000,0x90000,0x7,0xc0,0x7f000000
.long 0x90000,0xb,0xc0,0x7f000000,0x90000,0xf,0xc0,0x7f000000
.long 0x90010,0x0,0x3a0,0x7f000000,0x90010,0x4,0x3a4,0x7f000000
.long 0x90010,0x8,0x3a8,0x7f000000,0x90010,0xc,0x3ac,0x7f000000
.long 0x90010,0x1,0x3b0,0x7f000000,0x90010,0x5,0x3b4,0x7f000000
.long 0x90010,0x9,0x3b8,0x7f000000,0x90010,0xd,0x3bc,0x7f000000
.long 0x90010,0x2,0x3c0,0x7f000000,0x90010,0x6,0x3c4,0x7f000000
.long 0x90010,0xa,0x3c8,0x7f000000,0x90010,0xe,0x3cc,0x7f000000
.long 0x90010,0x3,0x400,0x7f000000,0x90010,0x7,0x400,0x7f000000
.long 0x90010,0xb,0x400,0x7f000000,0x90010,0xf,0x400,0x7f000000
.long 0x90020,0x0,0x6e0,0x7f000000,0x90020,0x4,0x6e4,0x7f000000
.long 0x90020,0x8,0x6e8,0x7f000000,0x90020,0xc,0x6ec,0x7f000000
.long 0x90020,0x1,0x6f0,0x7f000000,0x90020,0x5,0x6f4,0x7f000000
.long 0x90020,0x9,0x6f8,0x7f000000,0x90020,0xd,0x6fc,0x7f000000
.long 0x90020,0x2,0x700,0x7f000000,0x90020,0x6,0x704,0x7f000000
.long 0x90020,0xa,0x708,0x7f000000,0x90020,0xe,0x70c,0x7f000000
.long 0x90020,0x3,0x740,0x7f000000,0x90020,0x7,0x740,0x7f000000
.long 0x90020,0xb,0x740,0x7f000000,0x90020,0xf,0x740,0x7f000000
.long 0x90030,0x0,0xa20,0x7f000000,0x90030,0x4,0xa24,0x7f000000
.long 0x90030,0x8,0xa28,0x7f000000,0x90030,0xc,0xa2c,0x7f000000
.long 0x90030,0x1,0xa30,0x7f000000,0x90030,0x5,0xa34,0x7f000000
.long 0x90030,0x9,0xa38,0x7f000000,0x90030,0xd,0xa3c,0x7f000000
.long 0x90030,0x2,0xa40,0x7f000000,0x90030,0x6,0xa44,0x7f000000
.long 0x90030,0xa,0xa48,0x7f000000,0x90030,0xe,0xa4c,0x7f000000
.long 0x90030,0x3,0xa80,0x7f000000,0x90030,0x7,0xa80,0x7f000000
.long 0x90030,0xb,0xa80,0x7f000000,0x90030,0xf,0xa80,0x7f000000
.long 0x90000,0x0,0x90,0x0,0x90000,0x4,0x94,0x17f40
.long 0x90000,0x8,0x98,0x2fe80,0x90000,0xc,0x9c,0x47dc0
.long 0x90000,0x1,0xa0,0x5fd00,0x90000,0x5,0xa4,0x77c40
.long 0x90000,0x9,0xa8,0x8fb80,0x90000,0xd,0xac,0x7f000000
.long 0x90000,0x2,0xb0,0x7f000000,0x90000,0x6,0xb4,0x7f000000
.long 0x90000,0xa,0xb8,0x7f000000,0x90000,0xe,0xbc,0x7f000000
.long 0x90000,0x3,0xc0,0x7f000000,0x90000,0x7,0xc0,0x7f000000
.long 0x90000,0xb,0xc0,0x7f000000,0x90000,0xf,0xc0,0x7f000000
.long 0x90010,0x0,0x3d0,0x7f000000,0x90010,0x4,0x3d4,0x7f000000
.long 0x90010,0x8,0x3d8,0x7f000000,0x90010,0xc,0x3dc,0x7f000000
.long 0x90010,0x1,0x3e0,0x7f000000,0x90010,0x5,0x3e4,0x7f000000
.long 0x90010,0x9,0x3e8,0x7f000000,0x90010,0xd,0x3ec,0x7f000000
.long 0x90010,0x2,0x3f0,0x7f000000,0x90010,0x6,0x3f4,0x7f000000
.long 0x90010,0xa,0x3f8,0x7f000000,0x90010,0xe,0x3fc,0x7f000000
.long 0x90010,0x3,0x400,0x7f000000,0x90010,0x7,0x400,0x7f000000
.long 0x90010,0xb,0x400,0x7f000000,0x90010,0xf,0x400,0x7f000000
.long 0x90020,0x0,0x710,0x7f000000,0x90020,0x4,0x714,0x7f000000
.long 0x90020,0x8,0x718,0x7f000000,0x90020,0xc,0x71c,0x7f000000
.long 0x90020,0x1,0x720,0x7f000000,0x90020,0x5,0x724,0x7f000000
.long 0x90020,0x9,0x728,0x7f000000,0x90020,0xd,0x72c,0x7f000000
.long 0x90020,0x2,0x730,0x7f000000,0x90020,0x6,0x734,0x7f000000
.long 0x90020,0xa,0x738,0x7f000000,0x90020,0xe,0x73c,0x7f000000
.long 0x90020,0x3,0x740,0x7f000000,0x90020,0x7,0x740,0x7f000000
.long 0x90020,0xb,0x740,0x7f000000,0x90020,0xf,0x740,0x7f000000
.long 0x90030,0x0,0xa50,0x7f000000,0x90030,0x4,0xa54,0x7f000000
.long 0x90030,0x8,0xa58,0x7f000000,0x90030,0xc,0xa5c,0x7f000000
.long 0x90030,0x1,0xa60,0x7f000000,0x90030,0x5,0xa64,0x7f000000
.long 0x90030,0x9,0xa68,0x7f000000,0x90030,0xd,0xa6c,0x7f000000
.long 0x90030,0x2,0xa70,0x7f000000,0x90030,0x6,0xa74,0x7f000000
.long 0x90030,0xa,0xa78,0x7f000000,0x90030,0xe,0xa7c,0x7f000000
.long 0x90030,0x3,0xa80,0x7f000000,0x90030,0x7,0xa80,0x7f000000
.long 0x90030,0xb,0xa80,0x7f000000,0x90030,0xf,0xa80,0x7f000000
.long 0x30300,0x0,0x0,0x2f703c0,0x30300,0x4,0x4,0x2f88300
.long 0x30300,0x8,0x8,0x2fa0240,0x30300,0xc,0xc,0x2fb8180
.long 0x30300,0x1,0x10,0x0,0x30300,0x5,0x14,0x17f40
.long 0x30300,0x9,0x18,0x2fe80,0x30300,0xd,0x1c,0x7f000000
.long 0x30300,0x2,0x20,0x7f000000,0x30300,0x6,0x24,0x7f000000
.long 0x30300,0xa,0x28,0x7f000000,0x30300,0xe,0x2c,0x7f000000
.long 0x30300,0x3,0xc0,0x7f000000,0x30300,0x7,0xc0,0x7f000000
.long 0x30300,0xb,0xc0,0x7f000000,0x30300,0xf,0xc0,0x7f000000
.long 0x30310,0x0,0x340,0x7f000000,0x30310,0x4,0x344,0x7f000000
.long 0x30310,0x8,0x348,0x7f000000,0x30310,0xc,0x34c,0x7f000000
.long 0x30310,0x1,0x350,0x7f000000,0x30310,0x5,0x354,0x7f000000
.long 0x30310,0x9,0x358,0x7f000000,0x30310,0xd,0x35c,0x7f000000
.long 0x30310,0x2,0x360,0x7f000000,0x30310,0x6,0x364,0x7f000000
.long 0x30310,0xa,0x368,0x7f000000,0x30310,0xe,0x36c,0x7f000000
.long 0x30310,0x3,0x400,0x7f000000,0x30310,0x7,0x400,0x7f000000
.long 0x30310,0xb,0x400,0x7f000000,0x30310,0xf,0x400,0x7f000000
.long 0x30320,0x0,0x680,0x7f000000,0x30320,0x4,0x684,0x7f000000
.long 0x30320,0x8,0x688,0x7f000000,0x30320,0xc,0x68c,0x7f000000
.long 0x30320,0x1,0x690,0x7f000000,0x30320,0x5,0x694,0x7f000000
.long 0x30320,0x9,0x698,0x7f000000,0x30320,0xd,0x69c,0x7f000000
.long 0x30320,0x2,0x6a0,0x7f000000,0x30320,0x6,0x6a4,0x7f000000
.long 0x30320,0xa,0x6a8,0x7f000000,0x30320,0xe,0x6ac,0x7f000000
.long 0x30320,0x3,0x740,0x7f000000,0x30320,0x7,0x740,0x7f000000
.long 0x30320,0xb,0x740,0x7f000000,0x30320,0xf,0x740,0x7f000000
.long 0x30330,0x0,0x9c0,0x7f000000,0x30330,0x4,0x9c4,0x7f000000
.long 0x30330,0x8,0x9c8,0x7f000000,0x30330,0xc,0x9cc,0x7f000000
.long 0x30330,0x1,0x9d0,0x7f000000,0x30330,0x5,0x9d4,0x7f000000
.long 0x30330,0x9,0x9d8,0x7f000000,0x30330,0xd,0x9dc,0x7f000000
.long 0x30330,0x2,0x9e0,0x7f000000,0x30330,0x6,0x9e4,0x7f000000
.long 0x30330,0xa,0x9e8,0x7f000000,0x30330,0xe,0x9ec,0x7f000000
.long 0x30330,0x3,0xa80,0x7f000000,0x30330,0x7,0xa80,0x7f000000
.long 0x30330,0xb,0xa80,0x7f000000,0x30330,0xf,0xa80,0x7f000000
.long 0x30300,0x0,0x30,0x2f703c0,0x30300,0x4,0x34,0x2f88300
.long 0x30300,0x8,0x38,0x2fa0240,0x30300,0xc,0x3c,0x2fb8180
.long 0x30300,0x1,0x40,0x0,0x30300,0x5,0x44,0x17f40
.long 0x30300,0x9,0x48,0x2fe80,0x30300,0xd,0x4c,0x7f000000
.long 0x30300,0x2,0x50,0x7f000000,0x30300,0x6,0x54,0x7f000000
.long 0x30300,0xa,0x58,0x7f000000,0x30300,0xe,0x5c,0x7f000000
.long 0x30300,0x3,0xc0,0x7f000000,0x30300,0x7,0xc0,0x7f000000
.long 0x30300,0xb,0xc0,0x7f000000,0x30300,0xf,0xc0,0x7f000000
.long 0x30310,0x0,0x370,0x7f000000,0x30310,0x4,0x374,0x7f000000
.long 0x30310,0x8,0x378,0x7f000000,0x30310,0xc,0x37c,0x7f000000
.long 0x30310,0x1,0x380,0x7f000000,0x30310,0x5,0x384,0x7f000000
.long 0x30310,0x9,0x388,0x7f000000,0x30310,0xd,0x38c,0x7f000000
.long 0x30310,0x2,0x390,0x7f000000,0x30310,0x6,0x394,0x7f000000
.long 0x30310,0xa,0x398,0x7f000000,0x30310,0xe,0x39c,0x7f000000
.long 0x30310,0x3,0x400,0x7f000000,0x30310,0x7,0x400,0x7f000000
.long 0x30310,0xb,0x400,0x7f000000,0x30310,0xf,0x400,0x7f000000
.long 0x30320,0x0,0x6b0,0x7f000000,0x30320,0x4,0x6b4,0x7f000000
.long 0x30320,0x8,0x6b8,0x7f000000,0x30320,0xc,0x6bc,0x7f000000
.long 0x30320,0x1,0x6c0,0x7f000000,0x30320,0x5,0x6c4,0x7f000000
.long 0x30320,0x9,0x6c8,0x7f000000,0x30320,0xd,0x6cc,0x7f000000
.long 0x30320,0x2,0x6d0,0x7f000000,0x30320,0x6,0x6d4,0x7f000000
.long 0x30320,0xa,0x6d8,0x7f000000,0x30320,0xe,0x6dc,0x7f000000
.long 0x30320,0x3,0x740,0x7f000000,0x30320,0x7,0x740,0x7f000000
.long 0x30320,0xb,0x740,0x7f000000,0x30320,0xf,0x740,0x7f000000
.long 0x30330,0x0,0x9f0,0x7f000000,0x30330,0x4,0x9f4,0x7f000000
.long 0x30330,0x8,0x9f8,0x7f000000,0x30330,0xc,0x9fc,0x7f000000
.long 0x30330,0x1,0xa00,0x7f000000,0x30330,0x5,0xa04,0x7f000000
.long 0x30330,0x9,0xa08,0x7f000000,0x30330,0xd,0xa0c,0x7f000000
.long 0x30330,0x2,0xa10,0x7f000000,0x30330,0x6,0xa14,0x7f000000
.long 0x30330,0xa,0xa18,0x7f000000,0x30330,0xe,0xa1c,0x7f000000
.long 0x30330,0x3,0xa80,0x7f000000,0x30330,0x7,0xa80,0x7f000000
.long 0x30330,0xb,0xa80,0x7f000000,0x30330,0xf,0xa80,0x7f000000
.long 0x30300,0x0,0x60,0x2f703c0,0x30300,0x4,0x64,0x2f88300
.long 0x30300,0x8,0x68,0x2fa0240,0x30300,0xc,0x6c,0x2fb8180
.long 0x30300,0x1,0x70,0x0,0x30300,0x5,0x74,0x17f40
.long 0x30300,0x9,0x78,0x2fe80,0x30300,0xd,0x7c,0x7f000000
.long 0x30300,0x2,0x80,0x7f000000,0x30300,0x6,0x84,0x7f000000
.long 0x30300,0xa,0x88,0x7f000000,0x30300,0xe,0x8c,0x7f000000
.long 0x30300,0x3,0xc0,0x7f000000,0x30300,0x7,0xc0,0x7f000000
.long 0x30300,0xb,0xc0,0x7f000000,0x30300,0xf,0xc0,0x7f000000
.long 0x30310,0x0,0x3a0,0x7f000000,0x30310,0x4,0x3a4,0x7f000000
.long 0x30310,0x8,0x3a8,0x7f000000,0x30310,0xc,0x3ac,0x7f000000
.long 0x30310,0x1,0x3b0,0x7f000000,0x30310,0x5,0x3b4,0x7f000000
.long 0x30310,0x9,0x3b8,0x7f000000,0x30310,0xd,0x3bc,0x7f000000
.long 0x30310,0x2,0x3c0,0x7f000000,0x30310,0x6,0x3c4,0x7f000000
.long 0x30310,0xa,0x3c8,0x7f000000,0x30310,0xe,0x3cc,0x7f000000
.long 0x30310,0x3,0x400,0x7f000000,0x30310,0x7,0x400,0x7f000000
.long 0x30310,0xb,0x400,0x7f000000,0x30310,0xf,0x400,0x7f000000
.long 0x30320,0x0,0x6e0,0x7f000000,0x30320,0x4,0x6e4,0x7f000000
.long 0x30320,0x8,0x6e8,0x7f000000,0x30320,0xc,0x6ec,0x7f000000
.long 0x30320,0x1,0x6f0,0x7f000000,0x30320,0x5,0x6f4,0x7f000000
.long 0x30320,0x9,0x6f8,0x7f000000,0x30320,0xd,0x6fc,0x7f000000
.long 0x30320,0x2,0x700,0x7f000000,0x30320,0x6,0x704,0x7f000000
.long 0x30320,0xa,0x708,0x7f000000,0x30320,0xe,0x70c,0x7f000000
.long 0x30320,0x3,0x740,0x7f000000,0x30320,0x7,0x740,0x7f000000
.long 0x30320,0xb,0x740,0x7f000000,0x30320,0xf,0x740,0x7f000000
.long 0x30330,0x0,0xa20,0x7f000000,0x30330,0x4,0xa24,0x7f000000
.long 0x30330,0x8,0xa28,0x7f000000,0x30330,0xc,0xa2c,0x7f000000
.long 0x30330,0x1,0xa30,0x7f000000,0x30330,0x5,0xa34,0x7f000000
.long 0x30330,0x9,0xa38,0x7f000000,0x30330,0xd,0xa3c,0x7f000000
.long 0x30330,0x2,0xa40,0x7f000000,0x30330,0x6,0xa44,0x7f000000
.long 0x30330,0xa,0xa48,0x7f000000,0x30330,0xe,0xa4c,0x7f000000
.long 0x30330,0x3,0xa80,0x7f000000,0x30330,0x7,0xa80,0x7f000000
.long 0x30330,0xb,0xa80,0x7f000000,0x30330,0xf,0xa80,0x7f000000
.long 0x30300,0x0,0x90,0x2f703c0,0x30300,0x4,0x94,0x2f88300
.long 0x30300,0x8,0x98,0x2fa0240,0x30300,0xc,0x9c,0x2fb8180
.long 0x30300,0x1,0xa0,0x0,0x30300,0x5,0xa4,0x17f40
.long 0x30300,0x9,0xa8,0x2fe80,0x30300,0xd,0xac,0x7f000000
.long 0x30300,0x2,0xb0,0x7f000000,0x30300,0x6,0xb4,0x7f000000
.long 0x30300,0xa,0xb8,0x7f000000,0x30300,0xe,0xbc,0x7f000000
.long 0x30300,0x3,0xc0,0x7f000000,0x30300,0x7,0xc0,0x7f000000
.long 0x30300,0xb,0xc0,0x7f000000,0x30300,0xf,0xc0,0x7f000000
.long 0x30310,0x0,0x3d0,0x7f000000,0x30310,0x4,0x3d4,0x7f000000
.long 0x30310,0x8,0x3d8,0x7f000000,0x30310,0xc,0x3dc,0x7f000000
.long 0x30310,0x1,0x3e0,0x7f000000,0x30310,0x5,0x3e4,0x7f000000
.long 0x30310,0x9,0x3e8,0x7f000000,0x30310,0xd,0x3ec,0x7f000000
.long 0x30310,0x2,0x3f0,0x7f000000,0x30310,0x6,0x3f4,0x7f000000
.long 0x30310,0xa,0x3f8,0x7f000000,0x30310,0xe,0x3fc,0x7f000000
.long 0x30310,0x3,0x400,0x7f000000,0x30310,0x7,0x400,0x7f000000
.long 0x30310,0xb,0x400,0x7f000000,0x30310,0xf,0x400,0x7f000000
.long 0x30320,0x0,0x710,0x7f000000,0x30320,0x4,0x714,0x7f000000
.long 0x30320,0x8,0x718,0x7f000000,0x30320,0xc,0x71c,0x7f000000
.long 0x30320,0x1,0x720,0x7f000000,0x30320,0x5,0x724,0x7f000000
.long 0x30320,0x9,0x728,0x7f000000,0x30320,0xd,0x72c,0x7f000000
.long 0x30320,0x2,0x730,0x7f000000,0x30320,0x6,0x734,0x7f000000
.long 0x30320,0xa,0x738,0x7f000000,0x30320,0xe,0x73c,0x7f000000
.long 0x30320,0x3,0x740,0x7f000000,0x30320,0x7,0x740,0x7f000000
.long 0x30320,0xb,0x740,0x7f000000,0x30320,0xf,0x740,0x7f000000
.long 0x30330,0x0,0xa50,0x7f000000,0x30330,0x4,0xa54,0x7f000000
.long 0x30330,0x8,0xa58,0x7f000000,0x30330,0xc,0xa5c,0x7f000000
.long 0x30330,0x1,0xa60,0x7f000000,0x30330,0x5,0xa64,0x7f000000
.long 0x30330,0x9,0xa68,0x7f000000,0x30330,0xd,0xa6c,0x7f000000
.long 0x30330,0x2,0xa70,0x7f000000,0x30330,0x6,0xa74,0x7f000000
.long 0x30330,0xa,0xa78,0x7f000000,0x30330,0xe,0xa7c,0x7f000000
.long 0x30330,0x3,0xa80,0x7f000000,0x30330,0x7,0xa80,0x7f000000
.long 0x30330,0xb,0xa80,0x7f000000,0x30330,0xf,0xa80,0x7f000000
.long 0x8fd00,0x0,0x0,0x17c40,0x8fd00,0x4,0x4,0x2fb80
.long 0x8fd00,0x8,0x8,0x47ac0,0x8fd00,0xc,0xc,0x5fa00
.long 0x8fd00,0x1,0x10,0x77940,0x8fd00,0x5,0x14,0x8f880
.long 0x8fd00,0x9,0x18,0xa77c0,0x8fd00,0xd,0x1c,0x7f000000
.long 0x8fd00,0x2,0x20,0x7f000000,0x8fd00,0x6,0x24,0x7f000000
.long 0x8fd00,0xa,0x28,0x7f000000,0x8fd00,0xe,0x2c,0x7f000000
.long 0x8fd00,0x3,0xc0,0x7f000000,0x8fd00,0x7,0xc0,0x7f000000
.long 0x8fd00,0xb,0xc0,0x7f000000,0x8fd00,0xf,0xc0,0x7f000000
.long 0x8fd10,0x0,0x340,0x7f000000,0x8fd10,0x4,0x344,0x7f000000
.long 0x8fd10,0x8,0x348,0x7f000000,0x8fd10,0xc,0x34c,0x7f000000
.long 0x8fd10,0x1,0x350,0x7f000000,0x8fd10,0x5,0x354,0x7f000000
.long 0x8fd10,0x9,0x358,0x7f000000,0x8fd10,0xd,0x35c,0x7f000000
.long 0x8fd10,0x2,0x360,0x7f000000,0x8fd10,0x6,0x364,0x7f000000
.long 0x8fd10,0xa,0x368,0x7f000000,0x8fd10,0xe,0x36c,0x7f000000
.long 0x8fd10,0x3,0x400,0x7f000000,0x8fd10,0x7,0x400,0x7f000000
.long 0x8fd10,0xb,0x400,0x7f000000,0x8fd10,0xf,0x400,0x7f000000
.long 0x8fd20,0x0,0x680,0x7f000000,0x8fd20,0x4,0x684,0x7f000000
.long 0x8fd20,0x8,0x688,0x7f000000,0x8fd20,0xc,0x68c,0x7f000000
.long 0x8fd20,0x1,0x690,0x7f000000,0x8fd20,0x5,0x694,0x7f000000
.long 0x8fd20,0x9,0x698,0x7f000000,0x8fd20,0xd,0x69c,0x7f000000
.long 0x8fd20,0x2,0x6a0,0x7f000000,0x8fd20,0x6,0x6a4,0x7f000000
.long 0x8fd20,0xa,0x6a8,0x7f000000,0x8fd20,0xe,0x6ac,0x7f000000
.long 0x8fd20,0x3,0x740,0x7f000000,0x8fd20,0x7,0x740,0x7f000000
.long 0x8fd20,0xb,0x740,0x7f000000,0x8fd20,0xf,0x740,0x7f000000
.long 0x8fd30,0x0,0x9c0,0x7f000000,0x8fd30,0x4,0x9c4,0x7f000000
.long 0x8fd30,0x8,0x9c8,0x7f000000,0x8fd30,0xc,0x9cc,0x7f000000
.long 0x8fd30,0x1,0x9d0,0x7f000000,0x8fd30,0x5,0x9d4,0x7f000000
.long 0x8fd30,0x9,0x9d8,0x7f000000,0x8fd30,0xd,0x9dc,0x7f000000
.long 0x8fd30,0x2,0x9e0,0x7f000000,0x8fd30,0x6,0x9e4,0x7f000000
.long 0x8fd30,0xa,0x9e8,0x7f000000,0x8fd30,0xe,0x9ec,0x7f000000
.long 0x8fd30,0x3,0xa80,0x7f000000,0x8fd30,0x7,0xa80,0x7f000000
.long 0x8fd30,0xb,0xa80,0x7f000000,0x8fd30,0xf,0xa80,0x7f000000
.long 0x8fd00,0x0,0x30,0x17c40,0x8fd00,0x4,0x34,0x2fb80
.long 0x8fd00,0x8,0x38,0x47ac0,0x8fd00,0xc,0x3c,0x5fa00
.long 0x8fd00,0x1,0x40,0x77940,0x8fd00,0x5,0x44,0x8f880
.long 0x8fd00,0x9,0x48,0xa77c0,0x8fd00,0xd,0x4c,0x7f000000
.long 0x8fd00,0x2,0x50,0x7f000000,0x8fd00,0x6,0x54,0x7f000000
.long 0x8fd00,0xa,0x58,0x7f000000,0x8fd00,0xe,0x5c,0x7f000000
.long 0x8fd00,0x3,0xc0,0x7f000000,0x8fd00,0x7,0xc0,0x7f000000
.long 0x8fd00,0xb,0xc0,0x7f000000,0x8fd00,0xf,0xc0,0x7f000000
.long 0x8fd10,0x0,0x370,0x7f000000,0x8fd10,0x4,0x374,0x7f000000
.long 0x8fd10,0x8,0x378,0x7f000000,0x8fd10,0xc,0x37c,0x7f000000
.long 0x8fd10,0x1,0x380,0x7f000000,0x8fd10,0x5,0x384,0x7f000000
.long 0x8fd10,0x9,0x388,0x7f000000,0x8fd10,0xd,0x38c,0x7f000000
.long 0x8fd10,0x2,0x390,0x7f000000,0x8fd10,0x6,0x394,0x7f000000
.long 0x8fd10,0xa,0x398,0x7f000000,0x8fd10,0xe,0x39c,0x7f000000
.long 0x8fd10,0x3,0x400,0x7f000000,0x8fd10,0x7,0x400,0x7f000000
.long 0x8fd10,0xb,0x400,0x7f000000,0x8fd10,0xf,0x400,0x7f000000
.long 0x8fd20,0x0,0x6b0,0x7f000000,0x8fd20,0x4,0x6b4,0x7f000000
.long 0x8fd20,0x8,0x6b8,0x7f000000,0x8fd20,0xc,0x6bc,0x7f000000
.long 0x8fd20,0x1,0x6c0,0x7f000000,0x8fd20,0x5,0x6c4,0x7f000000
.long 0x8fd20,0x9,0x6c8,0x7f000000,0x8fd20,0xd,0x6cc,0x7f000000
.long 0x8fd20,0x2,0x6d0,0x7f000000,0x8fd20,0x6,0x6d4,0x7f000000
.long 0x8fd20,0xa,0x6d8,0x7f000000,0x8fd20,0xe,0x6dc,0x7f000000
.long 0x8fd20,0x3,0x740,0x7f000000,0x8fd20,0x7,0x740,0x7f000000
.long 0x8fd20,0xb,0x740,0x7f000000,0x8fd20,0xf,0x740,0x7f000000
.long 0x8fd30,0x0,0x9f0,0x7f000000,0x8fd30,0x4,0x9f4,0x7f000000
.long 0x8fd30,0x8,0x9f8,0x7f000000,0x8fd30,0xc,0x9fc,0x7f000000
.long 0x8fd30,0x1,0xa00,0x7f000000,0x8fd30,0x5,0xa04,0x7f000000
.long 0x8fd30,0x9,0xa08,0x7f000000,0x8fd30,0xd,0xa0c,0x7f000000
.long 0x8fd30,0x2,0xa10,0x7f000000,0x8fd30,0x6,0xa14,0x7f000000
.long 0x8fd30,0xa,0xa18,0x7f000000,0x8fd30,0xe,0xa1c,0x7f000000
.long 0x8fd30,0x3,0xa80,0x7f000000,0x8fd30,0x7,0xa80,0x7f000000
.long 0x8fd30,0xb,0xa80,0x7f000000,0x8fd30,0xf,0xa80,0x7f000000
.long 0x8fd00,0x0,0x60,0x17c40,0x8fd00,0x4,0x64,0x2fb80
.long 0x8fd00,0x8,0x68,0x47ac0,0x8fd00,0xc,0x6c,0x5fa00
.long 0x8fd00,0x1,0x70,0x77940,0x8fd00,0x5,0x74,0x8f880
.long 0x8fd00,0x9,0x78,0xa77c0,0x8fd00,0xd,0x7c,0x7f000000
.long 0x8fd00,0x2,0x80,0x7f000000,0x8fd00,0x6,0x84,0x7f000000
.long 0x8fd00,0xa,0x88,0x7f000000,0x8fd00,0xe,0x8c,0x7f000000
.long 0x8fd00,0x3,0xc0,0x7f000000,0x8fd00,0x7,0xc0,0x7f000000
.long 0x8fd00,0xb,0xc0,0x7f000000,0x8fd00,0xf,0xc0,0x7f000000
.long 0x8fd10,0x0,0x3a0,0x7f000000,0x8fd10,0x4,0x3a4,0x7f000000
.long 0x8fd10,0x8,0x3a8,0x7f000000,0x8fd10,0xc,0x3ac,0x7f000000
.long 0x8fd10,0x1,0x3b0,0x7f000000,0x8fd10,0x5,0x3b4,0x7f000000
.long 0x8fd10,0x9,0x3b8,0x7f000000,0x8fd10,0xd,0x3bc,0x7f000000
.long 0x8fd10,0x2,0x3c0,0x7f000000,0x8fd10,0x6,0x3c4,0x7f000000
.long 0x8fd10,0xa,0x3c8,0x7f000000,0x8fd10,0xe,0x3cc,0x7f000000
.long 0x8fd10,0x3,0x400,0x7f000000,0x8fd10,0x7,0x400,0x7f000000
.long 0x8fd10,0xb,0x400,0x7f000000,0x8fd10,0xf,0x400,0x7f000000
.long 0x8fd20,0x0,0x6e0,0x7f000000,0x8fd20,0x4,0x6e4,0x7f000000
.long 0x8fd20,0x8,0x6e8,0x7f000000,0x8fd20,0xc,0x6ec,0x7f000000
.long 0x8fd20,0x1,0x6f0,0x7f000000,0x8fd20,0x5,0x6f4,0x7f000000
.long 0x8fd20,0x9,0x6f8,0x7f000000,0x8fd20,0xd,0x6fc,0x7f000000
.long 0x8fd20,0x2,0x700,0x7f000000,0x8fd20,0x6,0x704,0x7f000000
.long 0x8fd20,0xa,0x708,0x7f000000,0x8fd20,0xe,0x70c,0x7f000000
.long 0x8fd20,0x3,0x740,0x7f000000,0x8fd20,0x7,0x740,0x7f000000
.long 0x8fd20,0xb,0x740,0x7f000000,0x8fd20,0xf,0x740,0x7f000000
.long 0x8fd30,0x0,0xa20,0x7f000000,0x8fd30,0x4,0xa24,0x7f000000
.long 0x8fd30,0x8,0xa28,0x7f000000,0x8fd30,0xc,0xa2c,0x7f000000
.long 0x8fd30,0x1,0xa30,0x7f000000,0x8fd30,0x5,0xa34,0x7f000000
.long 0x8fd30,0x9,0xa38,0x7f000000,0x8fd30,0xd,0xa3c,0x7f000000
.long 0x8fd30,0x2,0xa40,0x7f000000,0x8fd30,0x6,0xa44,0x7f000000
.long 0x8fd30,0xa,0xa48,0x7f000000,0x8fd30,0xe,0xa4c,0x7f000000
.long 0x8fd30,0x3,0xa80,0x7f000000,0x8fd30,0x7,0xa80,0x7f000000
.long 0x8fd30,0xb,0xa80,0x7f000000,0x8fd30,0xf,0xa80,0x7f000000
.long 0x8fd00,0x0,0x90,0x17c40,0x8fd00,0x4,0x94,0x2fb80
.long 0x8fd00,0x8,0x98,0x47ac0,0x8fd00,0xc,0x9c,0x5fa00
.long 0x8fd00,0x1,0xa0,0x77940,0x8fd00,0x5,0xa4,0x8f880
.long 0x8fd00,0x9,0xa8,0xa77c0,0x8fd00,0xd,0xac,0x7f000000
.long 0x8fd00,0x2,0xb0,0x7f000000,0x8fd00,0x6,0xb4,0x7f000000
.long 0x8fd00,0xa,0xb8,0x7f000000,0x8fd00,0xe,0xbc,0x7f000000
.long 0x8fd00,0x3,0xc0,0x7f000000,0x8fd00,0x7,0xc0,0x7f000000
.long 0x8fd00,0xb,0xc0,0x7f000000,0x8fd00,0xf,0xc0,0x7f000000
.long 0x8fd10,0x0,0x3d0,0x7f000000,0x8fd10,0x4,0x3d4,0x7f000000
.long 0x8fd10,0x8,0x3d8,0x7f000000,0x8fd10,0xc,0x3dc,0x7f000000
.long 0x8fd10,0x1,0x3e0,0x7f000000,0x8fd10,0x5,0x3e4,0x7f000000
.long 0x8fd10,0x9,0x3e8,0x7f000000,0x8fd10,0xd,0x3ec,0x7f000000
.long 0x8fd10,0x2,0x3f0,0x7f000000,0x8fd10,0x6,0x3f4,0x7f000000
.long 0x8fd10,0xa,0x3f8,0x7f000000,0x8fd10,0xe,0x3fc,0x7f000000
.long 0x8fd10,0x3,0x400,0x7f000000,0x8fd10,0x7,0x400,0x7f000000
.long 0x8fd10,0xb,0x400,0x7f000000,0x8fd10,0xf,0x400,0x7f000000
.long 0x8fd20,0x0,0x710,0x7f000000,0x8fd20,0x4,0x714,0x7f000000
.long 0x8fd20,0x8,0x718,0x7f000000,0x8fd20,0xc,0x71c,0x7f000000
.long 0x8fd20,0x1,0x720,0x7f000000,0x8fd20,0x5,0x724,0x7f000000
.long 0x8fd20,0x9,0x728,0x7f000000,0x8fd20,0xd,0x72c,0x7f000000
.long 0x8fd20,0x2,0x730,0x7f000000,0x8fd20,0x6,0x734,0x7f000000
.long 0x8fd20,0xa,0x738,0x7f000000,0x8fd20,0xe,0x73c,0x7f000000
.long 0x8fd20,0x3,0x740,0x7f000000,0x8fd20,0x7,0x740,0x7f000000
.long 0x8fd20,0xb,0x740,0x7f000000,0x8fd20,0xf,0x740,0x7f000000
.long 0x8fd30,0x0,0xa50,0x7f000000,0x8fd30,0x4,0xa54,0x7f000000
.long 0x8fd30,0x8,0xa58,0x7f000000,0x8fd30,0xc,0xa5c,0x7f000000
.long 0x8fd30,0x1,0xa60,0x7f000000,0x8fd30,0x5,0xa64,0x7f000000
.long 0x8fd30,0x9,0xa68,0x7f000000,0x8fd30,0xd,0xa6c,0x7f000000
.long 0x8fd30,0x2,0xa70,0x7f000000,0x8fd30,0x6,0xa74,0x7f000000
.long 0x8fd30,0xa,0xa78,0x7f000000,0x8fd30,0xe,0xa7c,0x7f000000
.long 0x8fd30,0x3,0xa80,0x7f000000,0x8fd30,0x7,0xa80,0x7f000000
.long 0x8fd30,0xb,0xa80,0x7f000000,0x8fd30,0xf,0xa80,0x7f000000
.long 0x30000,0x0,0x0,0x2f88000,0x30000,0x4,0x4,0x2f9ff40
.long 0x30000,0x8,0x8,0x2fb7e80,0x30000,0xc,0xc,0x2fcfdc0
.long 0x30000,0x1,0x10,0x17c40,0x30000,0x5,0x14,0x2fb80
.long 0x30000,0x9,0x18,0x47ac0,0x30000,0xd,0x1c,0x7f000000
.long 0x30000,0x2,0x20,0x7f000000,0x30000,0x6,0x24,0x7f000000
.long 0x30000,0xa,0x28,0x7f000000,0x30000,0xe,0x2c,0x7f000000
.long 0x30000,0x3,0xc0,0x7f000000,0x30000,0x7,0xc0,0x7f000000
.long 0x30000,0xb,0xc0,0x7f000000,0x30000,0xf,0xc0,0x7f000000
.long 0x30010,0x0,0x340,0x7f000000,0x30010,0x4,0x344,0x7f000000
.long 0x30010,0x8,0x348,0x7f000000,0x30010,0xc,0x34c,0x7f000000
.long 0x30010,0x1,0x350,0x7f000000,0x30010,0x5,0x354,0x7f000000
.long 0x30010,0x9,0x358,0x7f000000,0x30010,0xd,0x35c,0x7f000000
.long 0x30010,0x2,0x360,0x7f000000,0x30010,0x6,0x364,0x7f000000
.long 0x30010,0xa,0x368,0x7f000000,0x30010,0xe,0x36c,0x7f000000
.long 0x30010,0x3,0x400,0x7f000000,0x30010,0x7,0x400,0x7f000000
.long 0x30010,0xb,0x400,0x7f000000,0x30010,0xf,0x400,0x7f000000
.long 0x30020,0x0,0x680,0x7f000000,0x30020,0x4,0x684,0x7f000000
.long 0x30020,0x8,0x688,0x7f000000,0x30020,0xc,0x68c,0x7f000000
.long 0x30020,0x1,0x690,0x7f000000,0x30020,0x5,0x694,0x7f000000
.long 0x30020,0x9,0x698,0x7f000000,0x30020,0xd,0x69c,0x7f000000
.long 0x30020,0x2,0x6a0,0x7f000000,0x30020,0x6,0x6a4,0x7f000000
.long 0x30020,0xa,0x6a8,0x7f000000,0x30020,0xe,0x6ac,0x7f000000
.long 0x30020,0x3,0x740,0x7f000000,0x30020,0x7,0x740,0x7f000000
.long 0x30020,0xb,0x740,0x7f000000,0x30020,0xf,0x740,0x7f000000
.long 0x30030,0x0,0x9c0,0x7f000000,0x30030,0x4,0x9c4,0x7f000000
.long 0x30030,0x8,0x9c8,0x7f000000,0x30030,0xc,0x9cc,0x7f000000
.long 0x30030,0x1,0x9d0,0x7f000000,0x30030,0x5,0x9d4,0x7f000000
.long 0x30030,0x9,0x9d8,0x7f000000,0x30030,0xd,0x9dc,0x7f000000
.long 0x30030,0x2,0x9e0,0x7f000000,0x30030,0x6,0x9e4,0x7f000000
.long 0x30030,0xa,0x9e8,0x7f000000,0x30030,0xe,0x9ec,0x7f000000
.long 0x30030,0x3,0xa80,0x7f000000,0x30030,0x7,0xa80,0x7f000000
.long 0x30030,0xb,0xa80,0x7f000000,0x30030,0xf,0xa80,0x7f000000
.long 0x30000,0x0,0x30,0x2f88000,0x30000,0x4,0x34,0x2f9ff40
.long 0x30000,0x8,0x38,0x2fb7e80,0x30000,0xc,0x3c,0x2fcfdc0
.long 0x30000,0x1,0x40,0x17c40,0x30000,0x5,0x44,0x2fb80
.long 0x30000,0x9,0x48,0x47ac0,0x30000,0xd,0x4c,0x7f000000
.long 0x30000,0x2,0x50,0x7f000000,0x30000,0x6,0x54,0x7f000000
.long 0x30000,0xa,0x58,0x7f000000,0x30000,0xe,0x5c,0x7f000000
.long 0x30000,0x3,0xc0,0x7f000000,0x30000,0x7,0xc0,0x7f000000
.long 0x30000,0xb,0xc0,0x7f000000,0x30000,0xf,0xc0,0x7f000000
.long 0x30010,0x0,0x370,0x7f000000,0x30010,0x4,0x374,0x7f000000
.long 0x30010,0x8,0x378,0x7f000000,0x30010,0xc,0x37c,0x7f000000
.long 0x30010,0x1,0x380,0x7f000000,0x30010,0x5,0x384,0x7f000000
.long 0x30010,0x9,0x388,0x7f000000,0x30010,0xd,0x38c,0x7f000000
.long 0x30010,0x2,0x390,0x7f000000,0x30010,0x6,0x394,0x7f000000
.long 0x30010,0xa,0x398,0x7f000000,0x30010,0xe,0x39c,0x7f000000
.long 0x30010,0x3,0x400,0x7f000000,0x30010,0x7,0x400,0x7f000000
.long 0x30010,0xb,0x400,0x7f000000,0x30010,0xf,0x400,0x7f000000
.long 0x30020,0x0,0x6b0,0x7f000000,0x30020,0x4,0x6b4,0x7f000000
.long 0x30020,0x8,0x6b8,0x7f000000,0x30020,0xc,0x6bc,0x7f000000
.long 0x30020,0x1,0x6c0,0x7f000000,0x30020,0x5,0x6c4,0x7f000000
.long 0x30020,0x9,0x6c8,0x7f000000,0x30020,0xd,0x6cc,0x7f000000
.long 0x30020,0x2,0x6d0,0x7f000000,0x30020,0x6,0x6d4,0x7f000000
.long 0x30020,0xa,0x6d8,0x7f000000,0x30020,0xe,0x6dc,0x7f000000
.long 0x30020,0x3,0x740,0x7f000000,0x30020,0x7,0x740,0x7f000000
.long 0x30020,0xb,0x740,0x7f000000,0x30020,0xf,0x740,0x7f000000
.long 0x30030,0x0,0x9f0,0x7f000000,0x30030,0x4,0x9f4,0x7f000000
.long 0x30030,0x8,0x9f8,0x7f000000,0x30030,0xc,0x9fc,0x7f000000
.long 0x30030,0x1,0xa00,0x7f000000,0x30030,0x5,0xa04,0x7f000000
.long 0x30030,0x9,0xa08,0x7f000000,0x30030,0xd,0xa0c,0x7f000000
.long 0x30030,0x2,0xa10,0x7f000000,0x30030,0x6,0xa14,0x7f000000
.long 0x30030,0xa,0xa18,0x7f000000,0x30030,0xe,0xa1c,0x7f000000
.long 0x30030,0x3,0xa80,0x7f000000,0x30030,0x7,0xa80,0x7f000000
.long 0x30030,0xb,0xa80,0x7f000000,0x30030,0xf,0xa80,0x7f000000
.long 0x30000,0x0,0x60,0x2f88000,0x30000,0x4,0x64,0x2f9ff40
.long 0x30000,0x8,0x68,0x2fb7e80,0x30000,0xc,0x6c,0x2fcfdc0
.long 0x30000,0x1,0x70,0x17c40,0x30000,0x5,0x74,0x2fb80
.long 0x30000,0x9,0x78,0x47ac0,0x30000,0xd,0x7c,0x7f000000
.long 0x30000,0x2,0x80,0x7f000000,0x30000,0x6,0x84,0x7f000000
.long 0x30000,0xa,0x88,0x7f000000,0x30000,0xe,0x8c,0x7f000000
.long 0x30000,0x3,0xc0,0x7f000000,0x30000,0x7,0xc0,0x7f000000
.long 0x30000,0xb,0xc0,0x7f000000,0x30000,0xf,0xc0,0x7f000000
.long 0x30010,0x0,0x3a0,0x7f000000,0x30010,0x4,0x3a4,0x7f000000
.long 0x30010,0x8,0x3a8,0x7f000000,0x30010,0xc,0x3ac,0x7f000000
.long 0x30010,0x1,0x3b0,0x7f000000,0x30010,0x5,0x3b4,0x7f000000
.long 0x30010,0x9,0x3b8,0x7f000000,0x30010,0xd,0x3bc,0x7f000000
.long 0x30010,0x2,0x3c0,0x7f000000,0x30010,0x6,0x3c4,0x7f000000
.long 0x30010,0xa,0x3c8,0x7f000000,0x30010,0xe,0x3cc,0x7f000000
.long 0x30010,0x3,0x400,0x7f000000,0x30010,0x7,0x400,0x7f000000
.long 0x30010,0xb,0x400,0x7f000000,0x30010,0xf,0x400,0x7f000000
.long 0x30020,0x0,0x6e0,0x7f000000,0x30020,0x4,0x6e4,0x7f000000
.long 0x30020,0x8,0x6e8,0x7f000000,0x30020,0xc,0x6ec,0x7f000000
.long 0x30020,0x1,0x6f0,0x7f000000,0x30020,0x5,0x6f4,0x7f000000
.long 0x30020,0x9,0x6f8,0x7f000000,0x30020,0xd,0x6fc,0x7f000000
.long 0x30020,0x2,0x700,0x7f000000,0x30020,0x6,0x704,0x7f000000
.long 0x30020,0xa,0x708,0x7f000000,0x30020,0xe,0x70c,0x7f000000
.long 0x30020,0x3,0x740,0x7f000000,0x30020,0x7,0x740,0x7f000000
.long 0x30020,0xb,0x740,0x7f000000,0x30020,0xf,0x740,0x7f000000
.long 0x30030,0x0,0xa20,0x7f000000,0x30030,0x4,0xa24,0x7f000000
.long 0x30030,0x8,0xa28,0x7f000000,0x30030,0xc,0xa2c,0x7f000000
.long 0x30030,0x1,0xa30,0x7f000000,0x30030,0x5,0xa34,0x7f000000
.long 0x30030,0x9,0xa38,0x7f000000,0x30030,0xd,0xa3c,0x7f000000
.long 0x30030,0x2,0xa40,0x7f000000,0x30030,0x6,0xa44,0x7f000000
.long 0x30030,0xa,0xa48,0x7f000000,0x30030,0xe,0xa4c,0x7f000000
.long 0x30030,0x3,0xa80,0x7f000000,0x30030,0x7,0xa80,0x7f000000
.long 0x30030,0xb,0xa80,0x7f000000,0x30030,0xf,0xa80,0x7f000000
.long 0x30000,0x0,0x90,0x2f88000,0x30000,0x4,0x94,0x2f9ff40
.long 0x30000,0x8,0x98,0x2fb7e80,0x30000,0xc,0x9c,0x2fcfdc0
.long 0x30000,0x1,0xa0,0x17c40,0x30000,0x5,0xa4,0x2fb80
.long 0x30000,0x9,0xa8,0x47ac0,0x30000,0xd,0xac,0x7f000000
.long 0x30000,0x2,0xb0,0x7f000000,0x30000,0x6,0xb4,0x7f000000
.long 0x30000,0xa,0xb8,0x7f000000,0x30000,0xe,0xbc,0x7f000000
.long 0x30000,0x3,0xc0,0x7f000000,0x30000,0x7,0xc0,0x7f000000
.long 0x30000,0xb,0xc0,0x7f000000,0x30000,0xf,0xc0,0x7f000000
.long 0x30010,0x0,0x3d0,0x7f000000,0x30010,0x4,0x3d4,0x7f000000
.long 0x30010,0x8,0x3d8,0x7f000000,0x30010,0xc,0x3dc,0x7f000000
.long 0x30010,0x1,0x3e0,0x7f000000,0x30010,0x5,0x3e4,0x7f000000
.long 0x30010,0x9,0x3e8,0x7f000000,0x30010,0xd,0x3ec,0x7f000000
.long 0x30010,0x2,0x3f0,0x7f000000,0x30010,0x6,0x3f4,0x7f000000
.long 0x30010,0xa,0x3f8,0x7f000000,0x30010,0xe,0x3fc,0x7f000000
.long 0x30010,0x3,0x400,0x7f000000,0x30010,0x7,0x400,0x7f000000
.long 0x30010,0xb,0x400,0x7f000000,0x30010,0xf,0x400,0x7f000000
.long 0x30020,0x0,0x710,0x7f000000,0x30020,0x4,0x714,0x7f000000
.long 0x30020,0x8,0x718,0x7f000000,0x30020,0xc,0x71c,0x7f000000
.long 0x30020,0x1,0x720,0x7f000000,0x30020,0x5,0x724,0x7f000000
.long 0x30020,0x9,0x728,0x7f000000,0x30020,0xd,0x72c,0x7f000000
.long 0x30020,0x2,0x730,0x7f000000,0x30020,0x6,0x734,0x7f000000
.long 0x30020,0xa,0x738,0x7f000000,0x30020,0xe,0x73c,0x7f000000
.long 0x30020,0x3,0x740,0x7f000000,0x30020,0x7,0x740,0x7f000000
.long 0x30020,0xb,0x740,0x7f000000,0x30020,0xf,0x740,0x7f000000
.long 0x30030,0x0,0xa50,0x7f000000,0x30030,0x4,0xa54,0x7f000000
.long 0x30030,0x8,0xa58,0x7f000000,0x30030,0xc,0xa5c,0x7f000000
.long 0x30030,0x1,0xa60,0x7f000000,0x30030,0x5,0xa64,0x7f000000
.long 0x30030,0x9,0xa68,0x7f000000,0x30030,0xd,0xa6c,0x7f000000
.long 0x30030,0x2,0xa70,0x7f000000,0x30030,0x6,0xa74,0x7f000000
.long 0x30030,0xa,0xa78,0x7f000000,0x30030,0xe,0xa7c,0x7f000000
.long 0x30030,0x3,0xa80,0x7f000000,0x30030,0x7,0xa80,0x7f000000
.long 0x30030,0xb,0xa80,0x7f000000,0x30030,0xf,0xa80,0x7f000000
.long 0xfff00f00,0xb0,0x0,0x0,0xfff00f00,0xb0,0x0,0x0
.long 0xfff00f00,0xb0,0x0,0x0,0xfff00f00,0xb0,0x0,0x0
.long 0xfff00f00,0xb0,0x0,0x0,0xfff00f00,0xb0,0x0,0x0
.long 0xfff00f00,0xb0,0x0,0x0,0xfff00f00,0xb0,0x0,0x0
.long 0xfff00f00,0xb0,0x0,0x0,0xfff00f00,0xb0,0x0,0x0
.long 0xfff00f00,0xb0,0x0,0x0,0xfff00f00,0xb0,0x0,0x0
.long 0xfff0ff0,0x90,0x0,0x0,0xfff0ff0,0x90,0x0,0x0
.long 0xfff0ff0,0x90,0x0,0x0,0xfff0ff0,0x90,0x0,0x0
.long 0xfff00f00,0xb0,0x0,0x0,0xfff00f00,0xb0,0x0,0x0
.long 0xfff00f00,0xb0,0x0,0x0,0xfff00f00,0xb0,0x0,0x0
.long 0xfff00f00,0xb0,0x0,0x0,0xfff00f00,0xb0,0x0,0x0
.long 0xfff00f00,0xb0,0x0,0x0,0xfff00f00,0xb0,0x0,0x0
.long 0xfff00f00,0xb0,0x0,0x0,0xfff00f00,0xb0,0x0,0x0
.long 0xfff00f00,0xb0,0x0,0x0,0xfff00f00,0xb0,0x0,0x0
.long 0xfff0ff0,0x10,0x0,0x0,0xfff0ff0,0x10,0x0,0x0
.long 0xfff0ff0,0x10,0x0,0x0,0xfff0ff0,0x10,0x0,0x0
.long 0xfff00f00,0x30,0x0,0x0,0xfff00f00,0x30,0x0,0x0
.long 0xfff00f00,0x30,0x0,0x0,0xfff00f00,0x30,0x0,0x0
.long 0xfff00f00,0x30,0x0,0x0,0xfff00f00,0x30,0x0,0x0
.long 0xfff00f00,0x30,0x0,0x0,0xfff00f00,0x30,0x0,0x0
.long 0xfff00f00,0x30,0x0,0x0,0xfff00f00,0x30,0x0,0x0
.long 0xfff00f00,0x30,0x0,0x0,0xfff00f00,0x30,0x0,0x0
.long 0xfff0ff0,0x10,0x0,0x0,0xfff0ff0,0x10,0x0,0x0
.long 0xfff0ff0,0x10,0x0,0x0,0xfff0ff0,0x10,0x0,0x0
.long 0xff0fff00,0x30,0x0,0x0,0xff0fff00,0x30,0x0,0x0
.long 0xff0fff00,0x30,0x0,0x0,0xff0fff00,0x30,0x0,0x0
.long 0xff0fff00,0x30,0x0,0x0,0xff0fff00,0x30,0x0,0x0
.long 0xff0fff00,0x30,0x0,0x0,0xff0fff00,0x30,0x0,0x0
.long 0xff0fff00,0x30,0x0,0x0,0xff0fff00,0x30,0x0,0x0
.long 0xff0fff00,0x30,0x0,0x0,0xff0fff00,0x30,0x0,0x0
.long 0xf00fff0,0x10,0x0,0x0,0xf00fff0,0x10,0x0,0x0
.long 0xf00fff0,0x10,0x0,0x0,0xf00fff0,0x10,0x0,0x0
.long 0x773ccf00,0xb8,0x0,0x0,0x773ccf00,0xb8,0x0,0x0
.long 0x8733cff0,0x98,0x0,0x0,0x87c3c0f0,0xd7,0x0,0x0
.long 0x88c330ff,0x47,0x0,0x0,0x78cc300f,0x67,0x0,0x0
.long 0x78cc300f,0x67,0x0,0x0,0x773ccf00,0xb8,0x0,0x0
.long 0x773ccf00,0xb8,0x0,0x0,0x8733cff0,0x98,0x0,0x0
.long 0x87c3c0f0,0xd7,0x0,0x0,0x88c330ff,0x47,0x0,0x0
.long 0x78cc300f,0x67,0x0,0x0,0x78cc300f,0x67,0x0,0x0
.long 0x773ccf00,0xb8,0x0,0x0,0x773ccf00,0xb8,0x0,0x0
.long 0x88e11877,0xb7,0x0,0x0,0x88e11877,0xb7,0x0,0x0
.long 0x78ee1887,0x17,0x0,0x0,0x781e1787,0x58,0x0,0x0
.long 0x771ee788,0x48,0x0,0x0,0x8711e778,0xe8,0x0,0x0
.long 0x8711e778,0xe8,0x0,0x0,0x88e11877,0xb7,0x0,0x0
.long 0x88e11877,0xb7,0x0,0x0,0x78ee1887,0x17,0x0,0x0
.long 0x781e1787,0x58,0x0,0x0,0x771ee788,0x48,0x0,0x0
.long 0x8711e778,0xe8,0x0,0x0,0x8711e778,0xe8,0x0,0x0
.long 0x88e11877,0xb7,0x0,0x0,0x88e11877,0xb7,0x0,0x0
.long 0x331ee788,0x3c,0x0,0x0,0x331ee788,0x3c,0x0,0x0
.long 0xc311e778,0x1c,0x0,0x0,0xc3e1e878,0xd3,0x0,0x0
.long 0xcce11877,0xc3,0x0,0x0,0x3cee1887,0xe3,0x0,0x0
.long 0x3cee1887,0xe3,0x0,0x0,0x331ee788,0x3c,0x0,0x0
.long 0x331ee788,0x3c,0x0,0x0,0xc311e778,0x1c,0x0,0x0
.long 0xc3e1e878,0xd3,0x0,0x0,0xcce11877,0xc3,0x0,0x0
.long 0x3cee1887,0xe3,0x0,0x0,0x3cee1887,0xe3,0x0,0x0
.long 0x331ee788,0x3c,0x0,0x0,0x331ee788,0x3c,0x0,0x0
.long 0xccf00c33,0x33,0x0,0x0,0xccf00c33,0x33,0x0,0x0
.long 0x3cff0cc3,0x13,0x0,0x0,0x3c0f03c3,0x5c,0x0,0x0
.long 0x330ff3cc,0x4c,0x0,0x0,0xc300f33c,0x6c,0x0,0x0
.long 0xc300f33c,0x6c,0x0,0x0,0xccf00c33,0x33,0x0,0x0
.long 0xccf00c33,0x33,0x0,0x0,0x3cff0cc3,0x13,0x0,0x0
.long 0x3c0f03c3,0x5c,0x0,0x0,0x330ff3cc,0x4c,0x0,0x0
.long 0xc300f33c,0x6c,0x0,0x0,0xc300f33c,0x6c,0x0,0x0
.long 0xccf00c33,0x33,0x0,0x0,0xccf00c33,0x33,0x0,0x0
.long 0xfffccf00,0xb8,0x0,0x0,0xfffccf00,0xb8,0x0,0x0
.long 0xfff3cff0,0xb8,0x0,0x0,0xfff3cff0,0xf7,0x0,0x0
.long 0xfff33fff,0xf7,0x0,0x0,0xfffc3f0f,0xf7,0x0,0x0
.long 0xfffc3f0f,0xf7,0x0,0x0,0xfffccf00,0xb8,0x0,0x0
.long 0xfffccf00,0xb8,0x0,0x0,0xfff3cff0,0xb8,0x0,0x0
.long 0xfff3cff0,0xf7,0x0,0x0,0xfff33fff,0xf7,0x0,0x0
.long 0x7fff3fff,0xf7,0x0,0x0,0x7fff3fff,0xf7,0x0,0x0
.long 0x7fffcff0,0xb8,0x0,0x0,0x7fffcff0,0xb8,0x0,0x0
.long 0xfff11f77,0xb7,0x0,0x0,0xfff11f77,0xb7,0x0,0x0
.long 0xfffe1f87,0xb7,0x0,0x0,0xfffe1f87,0xf8,0x0,0x0
.long 0xfffeef88,0xf8,0x0,0x0,0xfff1ef78,0xf8,0x0,0x0
.long 0xfff1ef78,0xf8,0x0,0x0,0xfff11f77,0xb7,0x0,0x0
.long 0xfff11f77,0xb7,0x0,0x0,0xfffe1f87,0xb7,0x0,0x0
.long 0xfffe1f87,0xf8,0x0,0x0,0xfffeef88,0xf8,0x0,0x0
.long 0x8fffeff8,0xf8,0x0,0x0,0x8fffeff8,0xf8,0x0,0x0
.long 0x8fff1ff7,0xb7,0x0,0x0,0x8fff1ff7,0xb7,0x0,0x0
.long 0xfffeef88,0x3c,0x0,0x0,0xfffeef88,0x3c,0x0,0x0
.long 0xfff1ef78,0x3c,0x0,0x0,0xfff1ef78,0xf3,0x0,0x0
.long 0xfff11f77,0xf3,0x0,0x0,0xfffe1f87,0xf3,0x0,0x0
.long 0xfffe1f87,0xf3,0x0,0x0,0xfffeef88,0x3c,0x0,0x0
.long 0xfffeef88,0x3c,0x0,0x0,0xfff1ef78,0x3c,0x0,0x0
.long 0xfff1ef78,0xf3,0x0,0x0,0xfff11f77,0xf3,0x0,0x0
.long 0x3fff1ff7,0xf3,0x0,0x0,0x3fff1ff7,0xf3,0x0,0x0
.long 0x3fffeff8,0x3c,0x0,0x0,0x3fffeff8,0x3c,0x0,0x0
.long 0xffffff33,0x33,0x0,0x0,0xffffff33,0x33,0x0,0x0
.long 0xffffffc3,0x33,0x0,0x0,0xff0fffc3,0x7c,0x0,0x0
.long 0xff0fffcc,0x7c,0x0,0x0,0xff0fff3c,0x7c,0x0,0x0
.long 0xff0fff3c,0x7c,0x0,0x0,0xffffff33,0x33,0x0,0x0
.long 0xffffff33,0x33,0x0,0x0,0xffffffc3,0x33,0x0,0x0
.long 0xff0fffc3,0x7c,0x0,0x0,0xff0fffcc,0x7c,0x0,0x0
.long 0xcf00fffc,0x7c,0x0,0x0,0xcf00fffc,0x7c,0x0,0x0
.long 0xcff0fff3,0x33,0x0,0x0,0xcff0fff3,0x33,0x0,0x0
.size L_TABLE, 58368
.section .rodata,"a"
.p2align 6
.amdhsa_kernel standalone__window_attn_swin_v2__vision_kernel
  .amdhsa_next_free_vgpr 256
  .amdhsa_next_free_sgpr 100
  .amdhsa_accum_offset 256
  .amdhsa_group_segment_fixed_size 0
  .amdhsa_kernarg_size 96
  .amdhsa_user_sgpr_count 2
  .amdhsa_user_sgpr_kernarg_segment_ptr 1
  .amdhsa_system_sgpr_workgroup_id_x 1
.end_amdhsa_kernel
```
